```python
import torch

def _softmax(x, axis=-1):
    return torch.softmax(x, dim=axis)
def _gelu(x):
    return torch.nn.functional.gelu(x, approximate="tanh")
def _silu(x):
    return torch.nn.functional.silu(x)
def _sigmoid(x):
    return torch.sigmoid(x)
def _layernorm(x, axis=-1, eps=1e-5):
    m = x.mean(dim=axis, keepdim=True)
    v = x.var(dim=axis, keepdim=True, unbiased=False)
    return (x - m) / torch.sqrt(v + eps)
def _scatter_add(tgt, idx, src, axis=0):
    return tgt.clone().index_add_(axis, idx, src)
def _segment_sum(src, seg, n):
    out = torch.zeros((n,) + src.shape[1:], dtype=src.dtype)
    return out.index_add_(0, seg, src)
def _pad(x, pw):
    flat = tuple(v for pair in reversed(pw) for v in pair)
    return torch.nn.functional.pad(x, flat)

kernel_name = 'parallel_sum__compressed_kv_cla__swiglu_ffn__prompt'

def setup_inputs():

    _w = (lambda a: (lambda t: t.to(torch.bfloat16) if t.is_floating_point() else t)(torch.as_tensor(a)))
    def _A_setup():
        B, H, Sq, Sk, D, M = 1, 32, 2048, 2048, 128, 512
        Dc = 4 * D
        return {
            "x": _w((lambda *s: torch.randn(*s, dtype=torch.bfloat16) * 0.05)(B, Sq, M)),
            "c_kv": _w((lambda *s: torch.randn(*s, dtype=torch.bfloat16) * 1.6)(B, Sk, Dc)),
            "w_q": _w((lambda *s: torch.randn(*s, dtype=torch.bfloat16) * 0.8)(M, H, D) * (M ** -0.5)),
            "w_uk": _w((lambda *s: torch.randn(*s, dtype=torch.bfloat16) * 0.8)(Dc, H, D) * (Dc ** -0.5)),
            "w_uv": _w((lambda *s: torch.randn(*s, dtype=torch.bfloat16) * 1.6)(Dc, H, D) * (Dc ** -0.5)),
            "w_o": _w((lambda *s: torch.randn(*s, dtype=torch.bfloat16) * 1.6)(H, D, M) * ((H * D) ** -0.5)),
        }
    _A_in = _A_setup()

    def _B_setup():
        B, S, D, F = 1, 2048, 512, 1792
        return {
            "x": _w((lambda *s: torch.randn(*s, dtype=torch.bfloat16) * 0.05)(B, S, D)),
            "w_gate": _w((lambda *s: torch.randn(*s, dtype=torch.bfloat16) * 0.05)(D, F)),
            "w_up": _w((lambda *s: torch.randn(*s, dtype=torch.bfloat16) * 0.05)(D, F)),
            "w_down": _w((lambda *s: torch.randn(*s, dtype=torch.bfloat16) * 0.05)(F, D)),
        }
    _B_in = _B_setup()

    return {
        "A_x": _A_in["x"],
        "A_c_kv": _A_in["c_kv"],
        "A_w_q": _A_in["w_q"],
        "A_w_uk": _A_in["w_uk"],
        "A_w_uv": _A_in["w_uv"],
        "A_w_o": _A_in["w_o"],
        "B_x": _B_in["x"],
        "B_w_gate": _B_in["w_gate"],
        "B_w_up": _B_in["w_up"],
        "B_w_down": _B_in["w_down"],
    }

def reference(A_x, A_c_kv, A_w_q, A_w_uk, A_w_uv, A_w_o, B_x, B_w_gate, B_w_up, B_w_down):
    def _A_ref(x, c_kv, w_q, w_uk, w_uv, w_o):
        B, Sq, M = x.shape[0], x.shape[1], x.shape[2]
        Sk = c_kv.shape[1]
        H, D = w_q.shape[1], w_q.shape[2]
        q = torch.einsum("bqm,mhd->bhqd", x, w_q)
        k = torch.einsum("bkc,chd->bhkd", c_kv, w_uk)
        v = torch.einsum("bkc,chd->bhkd", c_kv, w_uv)
        scores = torch.einsum("bhqd,bhkd->bhqk", q, k) * (D ** -0.5)
        off = Sk - Sq
        qi = torch.arange(Sq)[:, None]
        kj = torch.arange(Sk)[None, :]
        cmask = kj <= (qi + off)
        scores = torch.where(cmask[None, None], scores, -1e9)
        p = _softmax(scores, axis=-1)
        ctx = torch.einsum("bhqk,bhkd->bhqd", p, v)
        return torch.einsum("bhqd,hdm->bqm", ctx, w_o)

    def _B_ref(x, w_gate, w_up, w_down):
        g = _silu(x @ w_gate)
        u = x @ w_up
        return (g * u) @ w_down

    x = A_x
    xn = _layernorm(x, axis=-1)
    return x + _A_ref(xn, A_c_kv, A_w_q, A_w_uk, A_w_uv, A_w_o) + _B_ref(xn, B_w_gate, B_w_up, B_w_down)
```

```asm
; @launch grid=(256,1,1) block=(512,1,1) lds=163840
.amdgcn_target "amdgcn-amd-amdhsa--gfx950"
.text
.globl parallel_sum__compressed_kv_cla__swiglu_ffn__prompt_kernel
.p2align 8
.type parallel_sum__compressed_kv_cla__swiglu_ffn__prompt_kernel,@function
parallel_sum__compressed_kv_cla__swiglu_ffn__prompt_kernel:
  s_cmp_ge_u32 s2, 256
  s_cbranch_scc1 .Lend
  s_load_dwordx16 s[4:19], s[0:1], 0
  s_load_dwordx8 s[20:27], s[0:1], 64
  s_load_dwordx2 s[28:29], s[0:1], 96
  v_and_b32 v255, 63, v0
  s_getpc_b64 s[32:33]
.Lpc:
  s_lshr_b32 s34, s2, 3
  s_lshl_b32 s34, s34, 12
  v_and_b32 v3, 31, v0
  v_lshlrev_b32 v3, 7, v3
  v_add_u32 v3, s34, v3
  v_min_u32 v3, .Lcode_end-.Lpc-4, v3
  v_cmp_gt_u32 vcc, 32, v0
  s_nop 0
  s_and_saveexec_b64 s[34:35], vcc
  s_cbranch_execz .Lnocode
  global_load_dword v248, v3, s[32:33]
.Lnocode:
  s_mov_b64 exec, s[34:35]
  v_lshrrev_b32 v1, 6, v0
  v_lshlrev_b32 v2, 4, v0
  v_readfirstlane_b32 s3, v1
  v_lshlrev_b32 v254, 4, v255
  v_lshlrev_b32 v252, 7, v255
  s_lshl_b32 s58, s2, 13
  s_waitcnt lgkmcnt(0)
  s_mov_b32 s52, s4
  s_mov_b32 s53, s5
  s_mov_b32 s54, 0x200000
  s_mov_b32 s55, 0x00020000
  buffer_load_dwordx4 v[4:7], v2, s[52:55], s58 offen
  s_and_b32 s56, s3, 3
  s_lshr_b32 s57, s3, 2
  s_lshl_b32 s66, s3, 12
  v_lshrrev_b32 v190, 3, v255
  s_lshl_b32 s58, s3, 5
  v_add_u32 v190, s58, v190
  v_lshlrev_b32 v190, 10, v190
  v_lshrrev_b32 v191, 4, v255
  v_and_b32 v192, 7, v255
  v_xor_b32 v192, v192, v191
  v_xor_b32 v193, 0, v192
  v_lshl_add_u32 v176, v193, 4, v190
  v_xor_b32 v193, 4, v192
  v_lshl_add_u32 v177, v193, 4, v190
  v_add_u32 v177, 7168, v177
  v_xor_b32 v193, 0, v192
  v_lshl_add_u32 v178, v193, 4, v190
  v_add_u32 v178, 14336, v178
  v_xor_b32 v193, 4, v192
  v_lshl_add_u32 v179, v193, 4, v190
  v_add_u32 v179, 21504, v179
  s_lshl_b32 s58, s56, 4
  v_add_u32 v222, s58, v191
  v_and_b32 v192, 15, v255
  v_lshlrev_b32 v193, 2, v191
  v_xor_b32 v192, v192, v193
  v_lshlrev_b32 v223, 4, v192
  v_lshl_add_u32 v180, v222, 13, v223
  v_add_u32 v181, 31744, v180
  v_add_u32 v182, 63488, v180
  v_add_u32 v183, 95232, v180
  s_and_b32 s58, s2, 7
  s_lshr_b32 s59, s2, 3
  s_lshr_b32 s60, s59, 3
  s_lshl_b32 s61, s58, 2
  s_add_u32 s60, s60, s61
  s_and_b32 s30, s59, 3
  s_add_u32 s30, s30, s61
  s_lshr_b32 s31, s59, 2
  s_and_b32 s61, s59, 7
  s_lshr_b32 s68, s60, 4
  s_and_b32 s60, s60, 15
  s_mov_b32 s32, s6
  s_mov_b32 s33, s7
  s_mov_b32 s34, 0x200000
  s_mov_b32 s35, 0x00020000
  s_cmp_lg_u32 s68, 0
  s_cselect_b32 s36, s12, s10
  s_cselect_b32 s37, s13, s11
  s_mov_b32 s38, 0x400000
  s_mov_b32 s39, 0x00020000
  s_mov_b32 s67, 0x1200000
  s_cselect_b32 s67, 0x2200000, s67
  s_lshl_b32 s64, s61, 18
  v_add_u32 v176, s64, v176
  v_add_u32 v177, s64, v177
  v_add_u32 v178, s64, v178
  v_add_u32 v179, s64, v179
  s_lshl_b32 s65, s60, 9
  s_lshl_b32 s62, s57, 8
  s_add_u32 s65, s65, s62
  s_lshl_b32 s64, s58, 7
  s_lshl_b32 s62, s58, 19
  s_add_u32 s65, s65, s62
  s_add_u32 m0, s66, 0x0
  s_nop 0
  buffer_load_dwordx4 v176, s[32:35], s64 offen offset:0 lds
  buffer_load_dwordx4 v177, s[32:35], s64 offen offset:1024 lds
  buffer_load_dwordx4 v178, s[32:35], s64 offen offset:2048 lds
  buffer_load_dwordx4 v179, s[32:35], s64 offen offset:3072 lds
  s_add_u32 m0, s66, 0x10000
  s_nop 0
  buffer_load_dwordx4 v180, s[36:39], s65 offen offset:0 lds
  buffer_load_dwordx4 v181, s[36:39], s65 offen offset:1024 lds
  buffer_load_dwordx4 v182, s[36:39], s65 offen offset:2048 lds
  buffer_load_dwordx4 v183, s[36:39], s65 offen offset:3072 lds
  s_add_u32 s64, s64, 128
  s_and_b32 s64, s64, 0x3ff
  s_add_u32 s65, s65, 0x80000
  s_and_b32 s65, s65, 0x3fffff
  s_lshl_b32 s63, s60, 20
  s_add_u32 s67, s67, s63
  s_lshr_b32 s63, s56, 1
  s_lshl_b32 s63, s63, 19
  s_add_u32 s67, s67, s63
  s_lshl_b32 s63, s61, 16
  s_add_u32 s67, s67, s63
  s_lshl_b32 s63, s57, 15
  s_add_u32 s67, s67, s63
  s_and_b32 s63, s56, 1
  s_lshl_b32 s63, s63, 12
  s_add_u32 s67, s67, s63
  s_add_u32 s79, s60, 0
  s_mov_b32 s40, s28
  s_mov_b32 s41, s29
  s_mov_b32 s42, 0x4900000
  s_mov_b32 s43, 0x00020000
  v_and_b32 v190, 31, v255
  s_lshl_b32 s62, s57, 7
  v_add_u32 v190, s62, v190
  v_lshlrev_b32 v190, 7, v190
  v_bfe_u32 v191, v255, 1, 3
  v_lshrrev_b32 v192, 5, v255
  v_xor_b32 v191, v191, v192
  v_xor_b32 v192, 0, v191
  v_lshl_add_u32 v184, v192, 4, v190
  v_xor_b32 v192, 2, v191
  v_lshl_add_u32 v185, v192, 4, v190
  v_xor_b32 v192, 4, v191
  v_lshl_add_u32 v186, v192, 4, v190
  v_xor_b32 v192, 6, v191
  v_lshl_add_u32 v187, v192, 4, v190
  v_bfe_u32 v219, v255, 2, 2
  v_lshrrev_b32 v190, 5, v255
  v_lshl_add_u32 v221, v190, 3, v219
  v_lshlrev_b32 v221, 8, v221
  v_and_b32 v190, 1, v255
  v_lshl_add_u32 v221, v190, 3, v221
  v_bfe_u32 v190, v255, 4, 1
  v_bfe_u32 v191, v255, 1, 1
  v_lshl_add_u32 v220, v190, 1, v191
  v_lshlrev_b32 v219, 2, v219
  s_lshr_b32 s63, s56, 1
  s_lshl_b32 s63, s63, 14
  s_add_u32 s63, s63, 0x10000
  s_and_b32 s62, s56, 1
  s_lshl_b32 s62, s62, 3
  v_add_u32 v190, s62, v220
  v_xor_b32 v190, v190, v219
  v_lshl_add_u32 v190, v190, 4, v221
  v_add_u32 v188, s63, v190
  s_add_u32 s62, s62, 4
  v_add_u32 v190, s62, v220
  v_xor_b32 v190, v190, v219
  v_lshl_add_u32 v190, v190, 4, v221
  v_add_u32 v189, s63, v190
  s_add_u32 s16, s28, 0x4900000
  s_addc_u32 s17, s29, 0
  v_mov_b32 v249, 0
  s_lshr_b32 s62, s2, 4
  s_or_b32 s62, s62, s3
  s_cmp_lg_u32 s62, 0
  s_cbranch_scc1 .Lnozero
  s_lshl_b32 s62, s2, 7
  v_lshlrev_b32 v190, 11, v255
  v_add_u32 v190, s62, v190
  s_mov_b64 exec, 0x3ff
  global_store_dword v190, v249, s[16:17] sc1
  s_mov_b64 exec, -1
.Lnozero:
  s_waitcnt vmcnt(8)
  v_lshlrev_b32 v8, 16, v4
  v_and_b32 v9, 0xffff0000, v4
  v_lshlrev_b32 v10, 16, v5
  v_and_b32 v11, 0xffff0000, v5
  v_lshlrev_b32 v12, 16, v6
  v_and_b32 v13, 0xffff0000, v6
  v_lshlrev_b32 v14, 16, v7
  v_and_b32 v15, 0xffff0000, v7
  v_add_f32 v16, v8, v9
  v_add_f32 v16, v16, v10
  v_add_f32 v16, v16, v11
  v_add_f32 v16, v16, v12
  v_add_f32 v16, v16, v13
  v_add_f32 v16, v16, v14
  v_add_f32 v16, v16, v15
  s_nop 1
  v_add_f32 v16, v16, v16 row_ror:8
  s_nop 1
  v_add_f32 v16, v16, v16 row_ror:4
  s_nop 1
  v_add_f32 v16, v16, v16 row_ror:2
  s_nop 1
  v_add_f32 v16, v16, v16 row_ror:1
  s_nop 0
  v_readlane_b32 s60, v16, 0
  v_readlane_b32 s61, v16, 16
  v_readlane_b32 s62, v16, 32
  v_readlane_b32 s63, v16, 48
  v_mov_b32 v16, s60
  v_add_f32 v16, s61, v16
  v_add_f32 v16, s62, v16
  v_add_f32 v16, s63, v16
  v_mul_f32 v16, 0x3b000000, v16
  v_sub_f32 v4, v8, v16
  v_mul_f32 v17, v4, v4
  v_sub_f32 v4, v9, v16
  v_fmac_f32 v17, v4, v4
  v_sub_f32 v4, v10, v16
  v_fmac_f32 v17, v4, v4
  v_sub_f32 v4, v11, v16
  v_fmac_f32 v17, v4, v4
  v_sub_f32 v4, v12, v16
  v_fmac_f32 v17, v4, v4
  v_sub_f32 v4, v13, v16
  v_fmac_f32 v17, v4, v4
  v_sub_f32 v4, v14, v16
  v_fmac_f32 v17, v4, v4
  v_sub_f32 v4, v15, v16
  v_fmac_f32 v17, v4, v4
  s_nop 1
  v_add_f32 v17, v17, v17 row_ror:8
  s_nop 1
  v_add_f32 v17, v17, v17 row_ror:4
  s_nop 1
  v_add_f32 v17, v17, v17 row_ror:2
  s_nop 1
  v_add_f32 v17, v17, v17 row_ror:1
  s_nop 0
  v_readlane_b32 s60, v17, 0
  v_readlane_b32 s61, v17, 16
  v_readlane_b32 s62, v17, 32
  v_readlane_b32 s63, v17, 48
  v_mov_b32 v17, s60
  v_add_f32 v17, s61, v17
  v_add_f32 v17, s62, v17
  v_add_f32 v17, s63, v17
  v_mul_f32 v17, 0x3b000000, v17
  v_cvt_pk_bf16_f32 v17, v17, v17
  v_lshlrev_b32 v17, 16, v17
  v_add_f32 v17, 0x3727c5ac, v17
  v_cvt_pk_bf16_f32 v17, v17, v17
  v_lshlrev_b32 v17, 16, v17
  v_sqrt_f32 v17, v17
  s_nop 0
  v_cvt_pk_bf16_f32 v17, v17, v17
  v_lshlrev_b32 v17, 16, v17
  v_rcp_f32 v17, v17
  v_cvt_pk_bf16_f32 v16, v16, v16
  v_lshlrev_b32 v16, 16, v16
  v_sub_f32 v8, v8, v16
  v_sub_f32 v9, v9, v16
  v_cvt_pk_bf16_f32 v4, v8, v9
  v_sub_f32 v10, v10, v16
  v_sub_f32 v11, v11, v16
  v_cvt_pk_bf16_f32 v5, v10, v11
  v_sub_f32 v12, v12, v16
  v_sub_f32 v13, v13, v16
  v_cvt_pk_bf16_f32 v6, v12, v13
  v_sub_f32 v14, v14, v16
  v_sub_f32 v15, v15, v16
  v_cvt_pk_bf16_f32 v7, v14, v15
  v_lshlrev_b32 v8, 16, v4
  v_and_b32 v9, 0xffff0000, v4
  v_mul_f32 v8, v8, v17
  v_mul_f32 v9, v9, v17
  v_cvt_pk_bf16_f32 v20, v8, v9
  v_lshlrev_b32 v10, 16, v5
  v_and_b32 v11, 0xffff0000, v5
  v_mul_f32 v10, v10, v17
  v_mul_f32 v11, v11, v17
  v_cvt_pk_bf16_f32 v21, v10, v11
  v_lshlrev_b32 v12, 16, v6
  v_and_b32 v13, 0xffff0000, v6
  v_mul_f32 v12, v12, v17
  v_mul_f32 v13, v13, v17
  v_cvt_pk_bf16_f32 v22, v12, v13
  v_lshlrev_b32 v14, 16, v7
  v_and_b32 v15, 0xffff0000, v7
  v_mul_f32 v14, v14, v17
  v_mul_f32 v15, v15, v17
  v_cvt_pk_bf16_f32 v23, v14, v15
  s_lshl_b32 s60, s3, 4
  s_add_u32 s60, s60, 0x20000
  v_add_u32 v190, s60, v252
  ds_write_b128 v190, v[20:23]
  s_lshl_b32 s60, s3, 10
  s_add_u32 s60, s60, 0x20000
  v_add_u32 v210, s60, v254
  v_lshrrev_b32 v190, 3, v255
  v_lshlrev_b32 v190, 9, v190
  v_and_b32 v191, 7, v255
  v_lshl_add_u32 v211, v191, 4, v190
  s_lshr_b32 s81, s2, 2
  s_lshl_b32 s81, s81, 15
  s_and_b32 s61, s2, 3
  s_lshl_b32 s61, s61, 7
  s_add_u32 s81, s81, s61
  s_add_u32 s81, s81, s66
  s_add_u32 m0, s66, 0x8000
  s_nop 0
  buffer_load_dwordx4 v176, s[32:35], s64 offen offset:0 lds
  buffer_load_dwordx4 v177, s[32:35], s64 offen offset:1024 lds
  buffer_load_dwordx4 v178, s[32:35], s64 offen offset:2048 lds
  buffer_load_dwordx4 v179, s[32:35], s64 offen offset:3072 lds
  s_add_u32 m0, s66, 0x18000
  s_nop 0
  buffer_load_dwordx4 v180, s[36:39], s65 offen offset:0 lds
  buffer_load_dwordx4 v181, s[36:39], s65 offen offset:1024 lds
  buffer_load_dwordx4 v182, s[36:39], s65 offen offset:2048 lds
  buffer_load_dwordx4 v183, s[36:39], s65 offen offset:3072 lds
  s_add_u32 s64, s64, 128
  s_and_b32 s64, s64, 0x3ff
  s_add_u32 s65, s65, 0x80000
  s_and_b32 s65, s65, 0x3fffff
  v_mov_b32 v253, 1
  v_mov_b32 v251, 0
  s_bfe_u32 s60, s2, 0x20001
  s_mul_i32 s60, s60, 56
  s_lshr_b32 s61, s2, 3
  s_add_u32 s60, s60, s61
  s_and_b32 s62, s2, 1
  s_mul_i32 s63, s62, 24
  s_add_u32 s60, s60, s63
  s_lshl_b32 s62, s62, 3
  s_and_b32 s76, s60, 15
  s_cmp_ge_u32 s61, s62
  s_cselect_b32 s62, 1, 0
  s_bfe_u32 s61, s60, 0x40004
  s_cmp_lg_u32 s62, 0
  s_cselect_b32 s71, 1, 0
  s_cselect_b32 s46, 0x200000, 0
  s_cselect_b32 s50, 1835008, 0
  s_mov_b32 s44, s28
  s_mov_b32 s45, s29
  s_mov_b32 s47, 0x00020000
  s_cmp_lg_u32 s57, 0
  s_cselect_b32 s48, s20, s18
  s_cselect_b32 s49, s21, s19
  s_mov_b32 s51, 0x00020000
  s_and_b32 s70, s76, 0
  s_lshl_b32 s69, s70, 12
  s_mul_i32 s70, s70, 229376
  s_lshl_b32 s73, s3, 11
  s_lshr_b32 s62, s3, 1
  s_lshl_b32 s62, s62, 15
  s_and_b32 s63, s3, 1
  s_lshl_b32 s63, s63, 11
  s_add_u32 s62, s62, s63
  s_lshl_b32 s63, s76, 17
  s_add_u32 s62, s62, s63
  v_add_u32 v224, s62, v254
  s_movk_i32 s62, 3584
  v_mad_u32_u24 v225, v222, s62, v223
  s_lshl_b32 s62, s61, 8
  v_add_u32 v225, s62, v225
  v_add_u32 v226, 13312, v225
  v_add_u32 v227, 26624, v225
  v_add_u32 v228, 39936, v225
  s_lshl_b32 s62, s57, 13
  v_add_u32 v229, s62, v254
  s_lshl_b32 s62, s56, 2
  s_mov_b32 s63, 0x10000
  v_add_u32 v190, s62, v220
  v_xor_b32 v190, v190, v219
  v_lshl_add_u32 v190, v190, 4, v221
  v_add_u32 v230, s63, v190
  v_add_u32 v231, 0x10000, v230
  v_add_u32 v232, 0x4000, v230
  v_add_u32 v233, 0x14000, v230
  s_lshl_b32 s62, s76, 2
  s_lshl_b32 s63, s57, 1
  s_add_u32 s62, s62, s63
  s_mul_i32 s62, s62, 368
  s_lshl_b32 s63, s61, 3
  s_add_u32 s62, s62, s63
  s_lshl_b32 s63, s56, 1
  s_add_u32 s62, s62, s63
  s_add_u32 s62, s62, 256
  s_lshl_b32 s62, s62, 10
  s_add_u32 s80, s62, 0x3200000
  s_cmp_lg_u32 s71, 0
  s_cselect_b32 s80, s80, 0x7f000000
  s_add_u32 s76, s76, 16
  s_mov_b32 s74, 0xbfb8aa3b
  s_mov_b32 s75, 0xbfb8aa3b
  s_lshl_b32 s60, s3, 4
  v_lshrrev_b32 v240, 4, v255
  v_add_u32 v240, s60, v240
  v_lshlrev_b32 v240, 13, v240
  v_add_u32 v244, v240, v223
  v_add_u32 v245, 31744, v244
  v_add_u32 v246, 63488, v244
  v_add_u32 v247, 95232, v244
  v_add_u32 v240, 0, v220
  v_xor_b32 v240, v240, v219
  v_lshl_add_u32 v240, v240, 4, v221
  v_add_u32 v240, 0x10000, v240
  v_add_u32 v241, 4, v220
  v_xor_b32 v241, v241, v219
  v_lshl_add_u32 v241, v241, 4, v221
  v_add_u32 v241, 0x10000, v241
  v_add_u32 v242, 8, v220
  v_xor_b32 v242, v242, v219
  v_lshl_add_u32 v242, v242, 4, v221
  v_add_u32 v242, 0x10000, v242
  v_add_u32 v243, 12, v220
  v_xor_b32 v243, v243, v219
  v_lshl_add_u32 v243, v243, 4, v221
  v_add_u32 v243, 0x10000, v243
  s_mov_b32 s82, 0
  s_waitcnt vmcnt(8) lgkmcnt(0)
  s_barrier
  ds_read_b64_tr_b16 v[144:145], v188 offset:0
  ds_read_b64_tr_b16 v[146:147], v188 offset:1024
  ds_read_b128 v[128:131], v184 offset:0
  ds_read_b64_tr_b16 v[148:149], v189 offset:0
  ds_read_b64_tr_b16 v[150:151], v189 offset:1024
  ds_read_b128 v[132:135], v184 offset:4096
  ds_read_b128 v[136:139], v184 offset:8192
  ds_read_b128 v[140:143], v184 offset:12288
  s_cmp_lg_u32 s68, 0
  s_cbranch_scc1 .Lp1_s
.Lp1_n:
  s_waitcnt lgkmcnt(5)
  v_mfma_f32_32x32x16_bf16 v[0:15], v[144:147], v[128:131], 0
  ds_read_b64_tr_b16 v[168:169], v188 offset:4096
  ds_read_b64_tr_b16 v[170:171], v188 offset:5120
  ds_read_b128 v[212:215], v210
  s_cmp_ge_u32 s3, 5
  s_cbranch_scc1 .Lmt0n
  s_lshl_b32 s86, s2, 14
  s_and_b32 s87, s3, 1
  s_lshl_b32 s87, s87, 13
  s_add_u32 s86, s86, s87
  s_cmp_ge_u32 s3, 3
  s_cselect_b32 s84, s12, s10
  s_cselect_b32 s85, s13, s11
  s_lshl_b32 s87, s2, 13
  s_cmp_eq_u32 s3, 0
  s_cselect_b32 s84, s6, s84
  s_cselect_b32 s85, s7, s85
  s_cselect_b32 s86, s87, s86
  v_add_u32 v208, s86, v252
  global_load_dword v248, v208, s[84:85]
.Lmt0n:
  s_waitcnt lgkmcnt(6)
  v_mfma_f32_32x32x16_bf16 v[64:79], v[148:151], v[128:131], 0
  ds_read_b128 v[152:155], v185 offset:0
  s_waitcnt lgkmcnt(6)
  v_mfma_f32_32x32x16_bf16 v[16:31], v[144:147], v[132:135], 0
  ds_read_b64_tr_b16 v[172:173], v189 offset:4096
  v_mfma_f32_32x32x16_bf16 v[80:95], v[148:151], v[132:135], 0
  ds_read_b64_tr_b16 v[174:175], v189 offset:5120
  ds_read_b128 v[156:159], v185 offset:4096
  s_waitcnt lgkmcnt(8)
  v_mfma_f32_32x32x16_bf16 v[32:47], v[144:147], v[136:139], 0
  ds_read_b128 v[160:163], v185 offset:8192
  v_mfma_f32_32x32x16_bf16 v[96:111], v[148:151], v[136:139], 0
  ds_read_b128 v[164:167], v185 offset:12288
  s_waitcnt lgkmcnt(9)
  v_mfma_f32_32x32x16_bf16 v[48:63], v[144:147], v[140:143], 0
  v_mfma_f32_32x32x16_bf16 v[112:127], v[148:151], v[140:143], 0
  s_waitcnt lgkmcnt(6)
  buffer_store_dwordx4 v[212:215], v211, s[40:43], s81 offen sc1
  s_waitcnt lgkmcnt(5)
  v_mfma_f32_32x32x16_bf16 v[0:15], v[168:171], v[152:155], v[0:15]
  ds_read_b64_tr_b16 v[144:145], v188 offset:8192
  ds_read_b64_tr_b16 v[146:147], v188 offset:9216
  s_waitcnt lgkmcnt(5)
  v_mfma_f32_32x32x16_bf16 v[64:79], v[172:175], v[152:155], v[64:79]
  ds_read_b128 v[128:131], v186 offset:0
  s_waitcnt lgkmcnt(5)
  v_mfma_f32_32x32x16_bf16 v[16:31], v[168:171], v[156:159], v[16:31]
  ds_read_b64_tr_b16 v[148:149], v189 offset:8192
  v_mfma_f32_32x32x16_bf16 v[80:95], v[172:175], v[156:159], v[80:95]
  ds_read_b64_tr_b16 v[150:151], v189 offset:9216
  ds_read_b128 v[132:135], v186 offset:4096
  s_waitcnt lgkmcnt(7)
  v_mfma_f32_32x32x16_bf16 v[32:47], v[168:171], v[160:163], v[32:47]
  ds_read_b128 v[136:139], v186 offset:8192
  v_mfma_f32_32x32x16_bf16 v[96:111], v[172:175], v[160:163], v[96:111]
  ds_read_b128 v[140:143], v186 offset:12288
  s_waitcnt lgkmcnt(8)
  v_mfma_f32_32x32x16_bf16 v[48:63], v[168:171], v[164:167], v[48:63]
  v_mfma_f32_32x32x16_bf16 v[112:127], v[172:175], v[164:167], v[112:127]
  s_waitcnt lgkmcnt(5)
  v_mfma_f32_32x32x16_bf16 v[0:15], v[144:147], v[128:131], v[0:15]
  ds_read_b64_tr_b16 v[168:169], v188 offset:12288
  ds_read_b64_tr_b16 v[170:171], v188 offset:13312
  s_waitcnt lgkmcnt(5)
  v_mfma_f32_32x32x16_bf16 v[64:79], v[148:151], v[128:131], v[64:79]
  ds_read_b128 v[152:155], v187 offset:0
  s_waitcnt lgkmcnt(5)
  v_mfma_f32_32x32x16_bf16 v[16:31], v[144:147], v[132:135], v[16:31]
  ds_read_b64_tr_b16 v[172:173], v189 offset:12288
  v_mfma_f32_32x32x16_bf16 v[80:95], v[148:151], v[132:135], v[80:95]
  ds_read_b64_tr_b16 v[174:175], v189 offset:13312
  ds_read_b128 v[156:159], v187 offset:4096
  s_waitcnt lgkmcnt(7)
  v_mfma_f32_32x32x16_bf16 v[32:47], v[144:147], v[136:139], v[32:47]
  ds_read_b128 v[160:163], v187 offset:8192
  v_mfma_f32_32x32x16_bf16 v[96:111], v[148:151], v[136:139], v[96:111]
  ds_read_b128 v[164:167], v187 offset:12288
  s_waitcnt lgkmcnt(8)
  v_mfma_f32_32x32x16_bf16 v[48:63], v[144:147], v[140:143], v[48:63]
  v_mfma_f32_32x32x16_bf16 v[112:127], v[148:151], v[140:143], v[112:127]
  s_waitcnt vmcnt(1) lgkmcnt(0)
  v_mfma_f32_32x32x16_bf16 v[0:15], v[168:171], v[152:155], v[0:15]
  s_barrier
  ds_read_b64_tr_b16 v[144:145], v188 offset:32768
  ds_read_b64_tr_b16 v[146:147], v188 offset:33792
  ds_read_b128 v[128:131], v184 offset:32768
  v_mfma_f32_32x32x16_bf16 v[64:79], v[172:175], v[152:155], v[64:79]
  ds_read_b64_tr_b16 v[148:149], v189 offset:32768
  ds_read_b64_tr_b16 v[150:151], v189 offset:33792
  ds_read_b128 v[132:135], v184 offset:36864
  v_mfma_f32_32x32x16_bf16 v[16:31], v[168:171], v[156:159], v[16:31]
  ds_read_b128 v[136:139], v184 offset:40960
  ds_read_b128 v[140:143], v184 offset:45056
  s_add_u32 m0, s66, 0x0
  v_mfma_f32_32x32x16_bf16 v[80:95], v[172:175], v[156:159], v[80:95]
  buffer_load_dwordx4 v176, s[32:35], s64 offen offset:0 lds
  buffer_load_dwordx4 v177, s[32:35], s64 offen offset:1024 lds
  v_mfma_f32_32x32x16_bf16 v[32:47], v[168:171], v[160:163], v[32:47]
  buffer_load_dwordx4 v178, s[32:35], s64 offen offset:2048 lds
  buffer_load_dwordx4 v179, s[32:35], s64 offen offset:3072 lds
  s_add_u32 m0, s66, 0x10000
  v_mfma_f32_32x32x16_bf16 v[96:111], v[172:175], v[160:163], v[96:111]
  buffer_load_dwordx4 v180, s[36:39], s65 offen offset:0 lds
  buffer_load_dwordx4 v181, s[36:39], s65 offen offset:1024 lds
  v_mfma_f32_32x32x16_bf16 v[48:63], v[168:171], v[164:167], v[48:63]
  buffer_load_dwordx4 v182, s[36:39], s65 offen offset:2048 lds
  buffer_load_dwordx4 v183, s[36:39], s65 offen offset:3072 lds
  v_mfma_f32_32x32x16_bf16 v[112:127], v[172:175], v[164:167], v[112:127]
  s_add_u32 s64, s64, 128
  s_and_b32 s64, s64, 0x3ff
  s_add_u32 s65, s65, 0x80000
  s_and_b32 s65, s65, 0x3fffff
  s_waitcnt lgkmcnt(5)
  v_mfma_f32_32x32x16_bf16 v[0:15], v[144:147], v[128:131], v[0:15]
  ds_read_b64_tr_b16 v[168:169], v188 offset:36864
  ds_read_b64_tr_b16 v[170:171], v188 offset:37888
  s_waitcnt lgkmcnt(5)
  v_mfma_f32_32x32x16_bf16 v[64:79], v[148:151], v[128:131], v[64:79]
  ds_read_b128 v[152:155], v185 offset:32768
  s_waitcnt lgkmcnt(5)
  v_mfma_f32_32x32x16_bf16 v[16:31], v[144:147], v[132:135], v[16:31]
  ds_read_b64_tr_b16 v[172:173], v189 offset:36864
  v_mfma_f32_32x32x16_bf16 v[80:95], v[148:151], v[132:135], v[80:95]
  ds_read_b64_tr_b16 v[174:175], v189 offset:37888
  ds_read_b128 v[156:159], v185 offset:36864
  s_waitcnt lgkmcnt(7)
  v_mfma_f32_32x32x16_bf16 v[32:47], v[144:147], v[136:139], v[32:47]
  ds_read_b128 v[160:163], v185 offset:40960
  v_mfma_f32_32x32x16_bf16 v[96:111], v[148:151], v[136:139], v[96:111]
  ds_read_b128 v[164:167], v185 offset:45056
  s_waitcnt lgkmcnt(8)
  v_mfma_f32_32x32x16_bf16 v[48:63], v[144:147], v[140:143], v[48:63]
  v_mfma_f32_32x32x16_bf16 v[112:127], v[148:151], v[140:143], v[112:127]
  s_waitcnt lgkmcnt(5)
  v_mfma_f32_32x32x16_bf16 v[0:15], v[168:171], v[152:155], v[0:15]
  ds_read_b64_tr_b16 v[144:145], v188 offset:40960
  ds_read_b64_tr_b16 v[146:147], v188 offset:41984
  s_waitcnt lgkmcnt(5)
  v_mfma_f32_32x32x16_bf16 v[64:79], v[172:175], v[152:155], v[64:79]
  ds_read_b128 v[128:131], v186 offset:32768
  s_waitcnt lgkmcnt(5)
  v_mfma_f32_32x32x16_bf16 v[16:31], v[168:171], v[156:159], v[16:31]
  ds_read_b64_tr_b16 v[148:149], v189 offset:40960
  v_mfma_f32_32x32x16_bf16 v[80:95], v[172:175], v[156:159], v[80:95]
  ds_read_b64_tr_b16 v[150:151], v189 offset:41984
  ds_read_b128 v[132:135], v186 offset:36864
  s_waitcnt lgkmcnt(7)
  v_mfma_f32_32x32x16_bf16 v[32:47], v[168:171], v[160:163], v[32:47]
  ds_read_b128 v[136:139], v186 offset:40960
  v_mfma_f32_32x32x16_bf16 v[96:111], v[172:175], v[160:163], v[96:111]
  ds_read_b128 v[140:143], v186 offset:45056
  s_waitcnt lgkmcnt(8)
  v_mfma_f32_32x32x16_bf16 v[48:63], v[168:171], v[164:167], v[48:63]
  v_mfma_f32_32x32x16_bf16 v[112:127], v[172:175], v[164:167], v[112:127]
  s_waitcnt lgkmcnt(5)
  v_mfma_f32_32x32x16_bf16 v[0:15], v[144:147], v[128:131], v[0:15]
  ds_read_b64_tr_b16 v[168:169], v188 offset:45056
  ds_read_b64_tr_b16 v[170:171], v188 offset:46080
  s_waitcnt lgkmcnt(5)
  v_mfma_f32_32x32x16_bf16 v[64:79], v[148:151], v[128:131], v[64:79]
  ds_read_b128 v[152:155], v187 offset:32768
  s_waitcnt lgkmcnt(5)
  v_mfma_f32_32x32x16_bf16 v[16:31], v[144:147], v[132:135], v[16:31]
  ds_read_b64_tr_b16 v[172:173], v189 offset:45056
  v_mfma_f32_32x32x16_bf16 v[80:95], v[148:151], v[132:135], v[80:95]
  ds_read_b64_tr_b16 v[174:175], v189 offset:46080
  ds_read_b128 v[156:159], v187 offset:36864
  s_waitcnt lgkmcnt(7)
  v_mfma_f32_32x32x16_bf16 v[32:47], v[144:147], v[136:139], v[32:47]
  ds_read_b128 v[160:163], v187 offset:40960
  v_mfma_f32_32x32x16_bf16 v[96:111], v[148:151], v[136:139], v[96:111]
  ds_read_b128 v[164:167], v187 offset:45056
  s_waitcnt lgkmcnt(8)
  v_mfma_f32_32x32x16_bf16 v[48:63], v[144:147], v[140:143], v[48:63]
  v_mfma_f32_32x32x16_bf16 v[112:127], v[148:151], v[140:143], v[112:127]
  s_waitcnt vmcnt(0) lgkmcnt(0)
  v_mfma_f32_32x32x16_bf16 v[0:15], v[168:171], v[152:155], v[0:15]
  s_barrier
  ds_read_b64_tr_b16 v[144:145], v188 offset:0
  ds_read_b64_tr_b16 v[146:147], v188 offset:1024
  ds_read_b128 v[128:131], v184 offset:0
  v_mfma_f32_32x32x16_bf16 v[64:79], v[172:175], v[152:155], v[64:79]
  ds_read_b64_tr_b16 v[148:149], v189 offset:0
  ds_read_b64_tr_b16 v[150:151], v189 offset:1024
  ds_read_b128 v[132:135], v184 offset:4096
  v_mfma_f32_32x32x16_bf16 v[16:31], v[168:171], v[156:159], v[16:31]
  ds_read_b128 v[136:139], v184 offset:8192
  ds_read_b128 v[140:143], v184 offset:12288
  s_add_u32 m0, s66, 0x8000
  v_mfma_f32_32x32x16_bf16 v[80:95], v[172:175], v[156:159], v[80:95]
  buffer_load_dwordx4 v176, s[32:35], s64 offen offset:0 lds
  buffer_load_dwordx4 v177, s[32:35], s64 offen offset:1024 lds
  v_mfma_f32_32x32x16_bf16 v[32:47], v[168:171], v[160:163], v[32:47]
  buffer_load_dwordx4 v178, s[32:35], s64 offen offset:2048 lds
  buffer_load_dwordx4 v179, s[32:35], s64 offen offset:3072 lds
  s_add_u32 m0, s66, 0x18000
  v_mfma_f32_32x32x16_bf16 v[96:111], v[172:175], v[160:163], v[96:111]
  buffer_load_dwordx4 v180, s[36:39], s65 offen offset:0 lds
  buffer_load_dwordx4 v181, s[36:39], s65 offen offset:1024 lds
  v_mfma_f32_32x32x16_bf16 v[48:63], v[168:171], v[164:167], v[48:63]
  buffer_load_dwordx4 v182, s[36:39], s65 offen offset:2048 lds
  buffer_load_dwordx4 v183, s[36:39], s65 offen offset:3072 lds
  v_mfma_f32_32x32x16_bf16 v[112:127], v[172:175], v[164:167], v[112:127]
  s_add_u32 s64, s64, 128
  s_and_b32 s64, s64, 0x3ff
  s_add_u32 s65, s65, 0x80000
  s_and_b32 s65, s65, 0x3fffff
  s_cmp_lg_u32 s3, 0
  s_cbranch_scc1 .Lsig_lnn
  s_lshl_b32 s88, s82, 2
  v_mov_b32 v234, s88
  s_mov_b64 exec, 1
  global_atomic_add v234, v253, s[26:27]
  s_mov_b64 exec, -1
.Lsig_lnn:
  s_waitcnt lgkmcnt(5)
  v_mfma_f32_32x32x16_bf16 v[0:15], v[144:147], v[128:131], v[0:15]
  ds_read_b64_tr_b16 v[168:169], v188 offset:4096
  ds_read_b64_tr_b16 v[170:171], v188 offset:5120
  s_waitcnt lgkmcnt(5)
  v_mfma_f32_32x32x16_bf16 v[64:79], v[148:151], v[128:131], v[64:79]
  ds_read_b128 v[152:155], v185 offset:0
  s_waitcnt lgkmcnt(5)
  v_mfma_f32_32x32x16_bf16 v[16:31], v[144:147], v[132:135], v[16:31]
  ds_read_b64_tr_b16 v[172:173], v189 offset:4096
  v_mfma_f32_32x32x16_bf16 v[80:95], v[148:151], v[132:135], v[80:95]
  ds_read_b64_tr_b16 v[174:175], v189 offset:5120
  ds_read_b128 v[156:159], v185 offset:4096
  s_waitcnt lgkmcnt(7)
  v_mfma_f32_32x32x16_bf16 v[32:47], v[144:147], v[136:139], v[32:47]
  ds_read_b128 v[160:163], v185 offset:8192
  v_mfma_f32_32x32x16_bf16 v[96:111], v[148:151], v[136:139], v[96:111]
  ds_read_b128 v[164:167], v185 offset:12288
  s_waitcnt lgkmcnt(8)
  v_mfma_f32_32x32x16_bf16 v[48:63], v[144:147], v[140:143], v[48:63]
  v_mfma_f32_32x32x16_bf16 v[112:127], v[148:151], v[140:143], v[112:127]
  s_waitcnt lgkmcnt(5)
  v_mfma_f32_32x32x16_bf16 v[0:15], v[168:171], v[152:155], v[0:15]
  ds_read_b64_tr_b16 v[144:145], v188 offset:8192
  ds_read_b64_tr_b16 v[146:147], v188 offset:9216
  s_waitcnt lgkmcnt(5)
  v_mfma_f32_32x32x16_bf16 v[64:79], v[172:175], v[152:155], v[64:79]
  ds_read_b128 v[128:131], v186 offset:0
  s_waitcnt lgkmcnt(5)
  v_mfma_f32_32x32x16_bf16 v[16:31], v[168:171], v[156:159], v[16:31]
  ds_read_b64_tr_b16 v[148:149], v189 offset:8192
  v_mfma_f32_32x32x16_bf16 v[80:95], v[172:175], v[156:159], v[80:95]
  ds_read_b64_tr_b16 v[150:151], v189 offset:9216
  ds_read_b128 v[132:135], v186 offset:4096
  s_waitcnt lgkmcnt(7)
  v_mfma_f32_32x32x16_bf16 v[32:47], v[168:171], v[160:163], v[32:47]
  ds_read_b128 v[136:139], v186 offset:8192
  v_mfma_f32_32x32x16_bf16 v[96:111], v[172:175], v[160:163], v[96:111]
  ds_read_b128 v[140:143], v186 offset:12288
  s_waitcnt lgkmcnt(8)
  v_mfma_f32_32x32x16_bf16 v[48:63], v[168:171], v[164:167], v[48:63]
  v_mfma_f32_32x32x16_bf16 v[112:127], v[172:175], v[164:167], v[112:127]
  s_waitcnt lgkmcnt(5)
  v_mfma_f32_32x32x16_bf16 v[0:15], v[144:147], v[128:131], v[0:15]
  ds_read_b64_tr_b16 v[168:169], v188 offset:12288
  ds_read_b64_tr_b16 v[170:171], v188 offset:13312
  s_waitcnt lgkmcnt(5)
  v_mfma_f32_32x32x16_bf16 v[64:79], v[148:151], v[128:131], v[64:79]
  ds_read_b128 v[152:155], v187 offset:0
  s_waitcnt lgkmcnt(5)
  v_mfma_f32_32x32x16_bf16 v[16:31], v[144:147], v[132:135], v[16:31]
  ds_read_b64_tr_b16 v[172:173], v189 offset:12288
  v_mfma_f32_32x32x16_bf16 v[80:95], v[148:151], v[132:135], v[80:95]
  ds_read_b64_tr_b16 v[174:175], v189 offset:13312
  ds_read_b128 v[156:159], v187 offset:4096
  s_waitcnt lgkmcnt(7)
  v_mfma_f32_32x32x16_bf16 v[32:47], v[144:147], v[136:139], v[32:47]
  ds_read_b128 v[160:163], v187 offset:8192
  v_mfma_f32_32x32x16_bf16 v[96:111], v[148:151], v[136:139], v[96:111]
  ds_read_b128 v[164:167], v187 offset:12288
  s_waitcnt lgkmcnt(8)
  v_mfma_f32_32x32x16_bf16 v[48:63], v[144:147], v[140:143], v[48:63]
  v_mfma_f32_32x32x16_bf16 v[112:127], v[148:151], v[140:143], v[112:127]
  s_waitcnt vmcnt(0) lgkmcnt(0)
  v_mfma_f32_32x32x16_bf16 v[0:15], v[168:171], v[152:155], v[0:15]
  s_barrier
  ds_read_b64_tr_b16 v[144:145], v188 offset:32768
  ds_read_b64_tr_b16 v[146:147], v188 offset:33792
  ds_read_b128 v[128:131], v184 offset:32768
  v_mfma_f32_32x32x16_bf16 v[64:79], v[172:175], v[152:155], v[64:79]
  ds_read_b64_tr_b16 v[148:149], v189 offset:32768
  ds_read_b64_tr_b16 v[150:151], v189 offset:33792
  ds_read_b128 v[132:135], v184 offset:36864
  v_mfma_f32_32x32x16_bf16 v[16:31], v[168:171], v[156:159], v[16:31]
  ds_read_b128 v[136:139], v184 offset:40960
  ds_read_b128 v[140:143], v184 offset:45056
  s_add_u32 m0, s66, 0x0
  v_mfma_f32_32x32x16_bf16 v[80:95], v[172:175], v[156:159], v[80:95]
  buffer_load_dwordx4 v176, s[32:35], s64 offen offset:0 lds
  buffer_load_dwordx4 v177, s[32:35], s64 offen offset:1024 lds
  v_mfma_f32_32x32x16_bf16 v[32:47], v[168:171], v[160:163], v[32:47]
  buffer_load_dwordx4 v178, s[32:35], s64 offen offset:2048 lds
  buffer_load_dwordx4 v179, s[32:35], s64 offen offset:3072 lds
  s_add_u32 m0, s66, 0x10000
  v_mfma_f32_32x32x16_bf16 v[96:111], v[172:175], v[160:163], v[96:111]
  buffer_load_dwordx4 v180, s[36:39], s65 offen offset:0 lds
  buffer_load_dwordx4 v181, s[36:39], s65 offen offset:1024 lds
  v_mfma_f32_32x32x16_bf16 v[48:63], v[168:171], v[164:167], v[48:63]
  buffer_load_dwordx4 v182, s[36:39], s65 offen offset:2048 lds
  buffer_load_dwordx4 v183, s[36:39], s65 offen offset:3072 lds
  v_mfma_f32_32x32x16_bf16 v[112:127], v[172:175], v[164:167], v[112:127]
  s_add_u32 s64, s64, 128
  s_and_b32 s64, s64, 0x3ff
  s_add_u32 s65, s65, 0x80000
  s_and_b32 s65, s65, 0x3fffff
  s_waitcnt lgkmcnt(5)
  v_mfma_f32_32x32x16_bf16 v[0:15], v[144:147], v[128:131], v[0:15]
  ds_read_b64_tr_b16 v[168:169], v188 offset:36864
  ds_read_b64_tr_b16 v[170:171], v188 offset:37888
  s_waitcnt lgkmcnt(5)
  v_mfma_f32_32x32x16_bf16 v[64:79], v[148:151], v[128:131], v[64:79]
  ds_read_b128 v[152:155], v185 offset:32768
  s_waitcnt lgkmcnt(5)
  v_mfma_f32_32x32x16_bf16 v[16:31], v[144:147], v[132:135], v[16:31]
  ds_read_b64_tr_b16 v[172:173], v189 offset:36864
  v_mfma_f32_32x32x16_bf16 v[80:95], v[148:151], v[132:135], v[80:95]
  ds_read_b64_tr_b16 v[174:175], v189 offset:37888
  ds_read_b128 v[156:159], v185 offset:36864
  s_waitcnt lgkmcnt(7)
  v_mfma_f32_32x32x16_bf16 v[32:47], v[144:147], v[136:139], v[32:47]
  ds_read_b128 v[160:163], v185 offset:40960
  v_mfma_f32_32x32x16_bf16 v[96:111], v[148:151], v[136:139], v[96:111]
  ds_read_b128 v[164:167], v185 offset:45056
  s_waitcnt lgkmcnt(8)
  v_mfma_f32_32x32x16_bf16 v[48:63], v[144:147], v[140:143], v[48:63]
  v_mfma_f32_32x32x16_bf16 v[112:127], v[148:151], v[140:143], v[112:127]
  s_waitcnt lgkmcnt(5)
  v_mfma_f32_32x32x16_bf16 v[0:15], v[168:171], v[152:155], v[0:15]
  ds_read_b64_tr_b16 v[144:145], v188 offset:40960
  ds_read_b64_tr_b16 v[146:147], v188 offset:41984
  s_waitcnt lgkmcnt(5)
  v_mfma_f32_32x32x16_bf16 v[64:79], v[172:175], v[152:155], v[64:79]
  ds_read_b128 v[128:131], v186 offset:32768
  s_waitcnt lgkmcnt(5)
  v_mfma_f32_32x32x16_bf16 v[16:31], v[168:171], v[156:159], v[16:31]
  ds_read_b64_tr_b16 v[148:149], v189 offset:40960
  v_mfma_f32_32x32x16_bf16 v[80:95], v[172:175], v[156:159], v[80:95]
  ds_read_b64_tr_b16 v[150:151], v189 offset:41984
  ds_read_b128 v[132:135], v186 offset:36864
  s_waitcnt lgkmcnt(7)
  v_mfma_f32_32x32x16_bf16 v[32:47], v[168:171], v[160:163], v[32:47]
  ds_read_b128 v[136:139], v186 offset:40960
  v_mfma_f32_32x32x16_bf16 v[96:111], v[172:175], v[160:163], v[96:111]
  ds_read_b128 v[140:143], v186 offset:45056
  s_waitcnt lgkmcnt(8)
  v_mfma_f32_32x32x16_bf16 v[48:63], v[168:171], v[164:167], v[48:63]
  v_mfma_f32_32x32x16_bf16 v[112:127], v[172:175], v[164:167], v[112:127]
  s_waitcnt lgkmcnt(5)
  v_mfma_f32_32x32x16_bf16 v[0:15], v[144:147], v[128:131], v[0:15]
  ds_read_b64_tr_b16 v[168:169], v188 offset:45056
  ds_read_b64_tr_b16 v[170:171], v188 offset:46080
  s_waitcnt lgkmcnt(5)
  v_mfma_f32_32x32x16_bf16 v[64:79], v[148:151], v[128:131], v[64:79]
  ds_read_b128 v[152:155], v187 offset:32768
  s_waitcnt lgkmcnt(5)
  v_mfma_f32_32x32x16_bf16 v[16:31], v[144:147], v[132:135], v[16:31]
  ds_read_b64_tr_b16 v[172:173], v189 offset:45056
  v_mfma_f32_32x32x16_bf16 v[80:95], v[148:151], v[132:135], v[80:95]
  ds_read_b64_tr_b16 v[174:175], v189 offset:46080
  ds_read_b128 v[156:159], v187 offset:36864
  s_waitcnt lgkmcnt(7)
  v_mfma_f32_32x32x16_bf16 v[32:47], v[144:147], v[136:139], v[32:47]
  ds_read_b128 v[160:163], v187 offset:40960
  v_mfma_f32_32x32x16_bf16 v[96:111], v[148:151], v[136:139], v[96:111]
  ds_read_b128 v[164:167], v187 offset:45056
  s_waitcnt lgkmcnt(8)
  v_mfma_f32_32x32x16_bf16 v[48:63], v[144:147], v[140:143], v[48:63]
  v_mfma_f32_32x32x16_bf16 v[112:127], v[148:151], v[140:143], v[112:127]
  s_waitcnt vmcnt(0) lgkmcnt(0)
  v_mfma_f32_32x32x16_bf16 v[0:15], v[168:171], v[152:155], v[0:15]
  s_barrier
  ds_read_b64_tr_b16 v[144:145], v188 offset:0
  ds_read_b64_tr_b16 v[146:147], v188 offset:1024
  ds_read_b128 v[128:131], v184 offset:0
  v_mfma_f32_32x32x16_bf16 v[64:79], v[172:175], v[152:155], v[64:79]
  ds_read_b64_tr_b16 v[148:149], v189 offset:0
  ds_read_b64_tr_b16 v[150:151], v189 offset:1024
  ds_read_b128 v[132:135], v184 offset:4096
  v_mfma_f32_32x32x16_bf16 v[16:31], v[168:171], v[156:159], v[16:31]
  ds_read_b128 v[136:139], v184 offset:8192
  ds_read_b128 v[140:143], v184 offset:12288
  s_add_u32 m0, s66, 0x8000
  v_mfma_f32_32x32x16_bf16 v[80:95], v[172:175], v[156:159], v[80:95]
  buffer_load_dwordx4 v176, s[32:35], s64 offen offset:0 lds
  buffer_load_dwordx4 v177, s[32:35], s64 offen offset:1024 lds
  v_mfma_f32_32x32x16_bf16 v[32:47], v[168:171], v[160:163], v[32:47]
  buffer_load_dwordx4 v178, s[32:35], s64 offen offset:2048 lds
  buffer_load_dwordx4 v179, s[32:35], s64 offen offset:3072 lds
  s_add_u32 m0, s66, 0x18000
  v_mfma_f32_32x32x16_bf16 v[96:111], v[172:175], v[160:163], v[96:111]
  buffer_load_dwordx4 v180, s[36:39], s65 offen offset:0 lds
  buffer_load_dwordx4 v181, s[36:39], s65 offen offset:1024 lds
  v_mfma_f32_32x32x16_bf16 v[48:63], v[168:171], v[164:167], v[48:63]
  buffer_load_dwordx4 v182, s[36:39], s65 offen offset:2048 lds
  buffer_load_dwordx4 v183, s[36:39], s65 offen offset:3072 lds
  v_mfma_f32_32x32x16_bf16 v[112:127], v[172:175], v[164:167], v[112:127]
  s_add_u32 s64, s64, 128
  s_and_b32 s64, s64, 0x3ff
  s_add_u32 s65, s65, 0x80000
  s_and_b32 s65, s65, 0x3fffff
  s_cmp_lt_u32 s3, 5
  s_cbranch_scc1 .Lmt1n
  s_lshl_b32 s86, s2, 14
  s_and_b32 s87, s3, 1
  s_lshl_b32 s87, s87, 13
  s_add_u32 s86, s86, s87
  s_mul_i32 s87, s2, 7168
  s_cmp_eq_u32 s3, 7
  s_cselect_b32 s84, s18, s8
  s_cselect_b32 s85, s19, s9
  s_cselect_b32 s86, s87, s86
  v_add_u32 v208, s86, v252
  v_min_u32 v207, 1834880, v208
  s_cbranch_scc0 .Lmt1n_q
  global_load_dword v248, v207, s[18:19]
  global_load_dword v248, v207, s[20:21]
  s_branch .Lmt1n
.Lmt1n_q:
  global_load_dword v248, v208, s[8:9]
.Lmt1n:
  s_waitcnt lgkmcnt(5)
  v_mfma_f32_32x32x16_bf16 v[0:15], v[144:147], v[128:131], v[0:15]
  ds_read_b64_tr_b16 v[168:169], v188 offset:4096
  ds_read_b64_tr_b16 v[170:171], v188 offset:5120
  s_waitcnt lgkmcnt(5)
  v_mfma_f32_32x32x16_bf16 v[64:79], v[148:151], v[128:131], v[64:79]
  ds_read_b128 v[152:155], v185 offset:0
  s_waitcnt lgkmcnt(5)
  v_mfma_f32_32x32x16_bf16 v[16:31], v[144:147], v[132:135], v[16:31]
  ds_read_b64_tr_b16 v[172:173], v189 offset:4096
  v_mfma_f32_32x32x16_bf16 v[80:95], v[148:151], v[132:135], v[80:95]
  ds_read_b64_tr_b16 v[174:175], v189 offset:5120
  ds_read_b128 v[156:159], v185 offset:4096
  s_waitcnt lgkmcnt(7)
  v_mfma_f32_32x32x16_bf16 v[32:47], v[144:147], v[136:139], v[32:47]
  ds_read_b128 v[160:163], v185 offset:8192
  v_mfma_f32_32x32x16_bf16 v[96:111], v[148:151], v[136:139], v[96:111]
  ds_read_b128 v[164:167], v185 offset:12288
  s_waitcnt lgkmcnt(8)
  v_mfma_f32_32x32x16_bf16 v[48:63], v[144:147], v[140:143], v[48:63]
  v_mfma_f32_32x32x16_bf16 v[112:127], v[148:151], v[140:143], v[112:127]
  s_waitcnt lgkmcnt(5)
  v_mfma_f32_32x32x16_bf16 v[0:15], v[168:171], v[152:155], v[0:15]
  ds_read_b64_tr_b16 v[144:145], v188 offset:8192
  ds_read_b64_tr_b16 v[146:147], v188 offset:9216
  s_waitcnt lgkmcnt(5)
  v_mfma_f32_32x32x16_bf16 v[64:79], v[172:175], v[152:155], v[64:79]
  ds_read_b128 v[128:131], v186 offset:0
  s_waitcnt lgkmcnt(5)
  v_mfma_f32_32x32x16_bf16 v[16:31], v[168:171], v[156:159], v[16:31]
  ds_read_b64_tr_b16 v[148:149], v189 offset:8192
  v_mfma_f32_32x32x16_bf16 v[80:95], v[172:175], v[156:159], v[80:95]
  ds_read_b64_tr_b16 v[150:151], v189 offset:9216
  ds_read_b128 v[132:135], v186 offset:4096
  s_waitcnt lgkmcnt(7)
  v_mfma_f32_32x32x16_bf16 v[32:47], v[168:171], v[160:163], v[32:47]
  ds_read_b128 v[136:139], v186 offset:8192
  v_mfma_f32_32x32x16_bf16 v[96:111], v[172:175], v[160:163], v[96:111]
  ds_read_b128 v[140:143], v186 offset:12288
  s_waitcnt lgkmcnt(8)
  v_mfma_f32_32x32x16_bf16 v[48:63], v[168:171], v[164:167], v[48:63]
  v_mfma_f32_32x32x16_bf16 v[112:127], v[172:175], v[164:167], v[112:127]
  s_waitcnt lgkmcnt(5)
  v_mfma_f32_32x32x16_bf16 v[0:15], v[144:147], v[128:131], v[0:15]
  ds_read_b64_tr_b16 v[168:169], v188 offset:12288
  ds_read_b64_tr_b16 v[170:171], v188 offset:13312
  s_waitcnt lgkmcnt(5)
  v_mfma_f32_32x32x16_bf16 v[64:79], v[148:151], v[128:131], v[64:79]
  ds_read_b128 v[152:155], v187 offset:0
  s_waitcnt lgkmcnt(5)
  v_mfma_f32_32x32x16_bf16 v[16:31], v[144:147], v[132:135], v[16:31]
  ds_read_b64_tr_b16 v[172:173], v189 offset:12288
  v_mfma_f32_32x32x16_bf16 v[80:95], v[148:151], v[132:135], v[80:95]
  ds_read_b64_tr_b16 v[174:175], v189 offset:13312
  ds_read_b128 v[156:159], v187 offset:4096
  s_waitcnt lgkmcnt(7)
  v_mfma_f32_32x32x16_bf16 v[32:47], v[144:147], v[136:139], v[32:47]
  ds_read_b128 v[160:163], v187 offset:8192
  v_mfma_f32_32x32x16_bf16 v[96:111], v[148:151], v[136:139], v[96:111]
  ds_read_b128 v[164:167], v187 offset:12288
  s_waitcnt lgkmcnt(8)
  v_mfma_f32_32x32x16_bf16 v[48:63], v[144:147], v[140:143], v[48:63]
  v_mfma_f32_32x32x16_bf16 v[112:127], v[148:151], v[140:143], v[112:127]
  s_waitcnt vmcnt(0) lgkmcnt(0)
  v_mfma_f32_32x32x16_bf16 v[0:15], v[168:171], v[152:155], v[0:15]
  s_barrier
  ds_read_b64_tr_b16 v[144:145], v188 offset:32768
  ds_read_b64_tr_b16 v[146:147], v188 offset:33792
  ds_read_b128 v[128:131], v184 offset:32768
  v_mfma_f32_32x32x16_bf16 v[64:79], v[172:175], v[152:155], v[64:79]
  ds_read_b64_tr_b16 v[148:149], v189 offset:32768
  ds_read_b64_tr_b16 v[150:151], v189 offset:33792
  ds_read_b128 v[132:135], v184 offset:36864
  v_mfma_f32_32x32x16_bf16 v[16:31], v[168:171], v[156:159], v[16:31]
  ds_read_b128 v[136:139], v184 offset:40960
  ds_read_b128 v[140:143], v184 offset:45056
  s_add_u32 m0, s66, 0x0
  v_mfma_f32_32x32x16_bf16 v[80:95], v[172:175], v[156:159], v[80:95]
  buffer_load_dwordx4 v176, s[32:35], s64 offen offset:0 lds
  buffer_load_dwordx4 v177, s[32:35], s64 offen offset:1024 lds
  v_mfma_f32_32x32x16_bf16 v[32:47], v[168:171], v[160:163], v[32:47]
  buffer_load_dwordx4 v178, s[32:35], s64 offen offset:2048 lds
  buffer_load_dwordx4 v179, s[32:35], s64 offen offset:3072 lds
  s_add_u32 m0, s66, 0x10000
  v_mfma_f32_32x32x16_bf16 v[96:111], v[172:175], v[160:163], v[96:111]
  buffer_load_dwordx4 v180, s[36:39], s65 offen offset:0 lds
  buffer_load_dwordx4 v181, s[36:39], s65 offen offset:1024 lds
  v_mfma_f32_32x32x16_bf16 v[48:63], v[168:171], v[164:167], v[48:63]
  buffer_load_dwordx4 v182, s[36:39], s65 offen offset:2048 lds
  buffer_load_dwordx4 v183, s[36:39], s65 offen offset:3072 lds
  v_mfma_f32_32x32x16_bf16 v[112:127], v[172:175], v[164:167], v[112:127]
  s_add_u32 s64, s64, 128
  s_and_b32 s64, s64, 0x3ff
  s_add_u32 s65, s65, 0x80000
  s_and_b32 s65, s65, 0x3fffff
  s_cmp_lg_u32 s3, 0
  s_cbranch_scc1 .Lpi_lnn
  v_mov_b32 v251, 0
  s_mov_b64 exec, 1
  global_atomic_add v250, v251, v249, s[26:27] sc0
  s_mov_b64 exec, -1
.Lpi_lnn:
  s_waitcnt lgkmcnt(5)
  v_mfma_f32_32x32x16_bf16 v[0:15], v[144:147], v[128:131], v[0:15]
  ds_read_b64_tr_b16 v[168:169], v188 offset:36864
  ds_read_b64_tr_b16 v[170:171], v188 offset:37888
  s_waitcnt lgkmcnt(5)
  v_mfma_f32_32x32x16_bf16 v[64:79], v[148:151], v[128:131], v[64:79]
  ds_read_b128 v[152:155], v185 offset:32768
  s_waitcnt lgkmcnt(5)
  v_mfma_f32_32x32x16_bf16 v[16:31], v[144:147], v[132:135], v[16:31]
  ds_read_b64_tr_b16 v[172:173], v189 offset:36864
  v_mfma_f32_32x32x16_bf16 v[80:95], v[148:151], v[132:135], v[80:95]
  ds_read_b64_tr_b16 v[174:175], v189 offset:37888
  ds_read_b128 v[156:159], v185 offset:36864
  s_waitcnt lgkmcnt(7)
  v_mfma_f32_32x32x16_bf16 v[32:47], v[144:147], v[136:139], v[32:47]
  ds_read_b128 v[160:163], v185 offset:40960
  v_mfma_f32_32x32x16_bf16 v[96:111], v[148:151], v[136:139], v[96:111]
  ds_read_b128 v[164:167], v185 offset:45056
  s_waitcnt lgkmcnt(8)
  v_mfma_f32_32x32x16_bf16 v[48:63], v[144:147], v[140:143], v[48:63]
  v_mfma_f32_32x32x16_bf16 v[112:127], v[148:151], v[140:143], v[112:127]
  s_waitcnt lgkmcnt(5)
  v_mfma_f32_32x32x16_bf16 v[0:15], v[168:171], v[152:155], v[0:15]
  ds_read_b64_tr_b16 v[144:145], v188 offset:40960
  ds_read_b64_tr_b16 v[146:147], v188 offset:41984
  s_waitcnt lgkmcnt(5)
  v_mfma_f32_32x32x16_bf16 v[64:79], v[172:175], v[152:155], v[64:79]
  ds_read_b128 v[128:131], v186 offset:32768
  s_waitcnt lgkmcnt(5)
  v_mfma_f32_32x32x16_bf16 v[16:31], v[168:171], v[156:159], v[16:31]
  ds_read_b64_tr_b16 v[148:149], v189 offset:40960
  v_mfma_f32_32x32x16_bf16 v[80:95], v[172:175], v[156:159], v[80:95]
  ds_read_b64_tr_b16 v[150:151], v189 offset:41984
  ds_read_b128 v[132:135], v186 offset:36864
  s_waitcnt lgkmcnt(7)
  v_mfma_f32_32x32x16_bf16 v[32:47], v[168:171], v[160:163], v[32:47]
  ds_read_b128 v[136:139], v186 offset:40960
  v_mfma_f32_32x32x16_bf16 v[96:111], v[172:175], v[160:163], v[96:111]
  ds_read_b128 v[140:143], v186 offset:45056
  s_waitcnt lgkmcnt(8)
  v_mfma_f32_32x32x16_bf16 v[48:63], v[168:171], v[164:167], v[48:63]
  v_mfma_f32_32x32x16_bf16 v[112:127], v[172:175], v[164:167], v[112:127]
  s_waitcnt lgkmcnt(5)
  v_mfma_f32_32x32x16_bf16 v[0:15], v[144:147], v[128:131], v[0:15]
  ds_read_b64_tr_b16 v[168:169], v188 offset:45056
  ds_read_b64_tr_b16 v[170:171], v188 offset:46080
  s_waitcnt lgkmcnt(5)
  v_mfma_f32_32x32x16_bf16 v[64:79], v[148:151], v[128:131], v[64:79]
  ds_read_b128 v[152:155], v187 offset:32768
  s_waitcnt lgkmcnt(5)
  v_mfma_f32_32x32x16_bf16 v[16:31], v[144:147], v[132:135], v[16:31]
  ds_read_b64_tr_b16 v[172:173], v189 offset:45056
  v_mfma_f32_32x32x16_bf16 v[80:95], v[148:151], v[132:135], v[80:95]
  ds_read_b64_tr_b16 v[174:175], v189 offset:46080
  ds_read_b128 v[156:159], v187 offset:36864
  s_waitcnt lgkmcnt(7)
  v_mfma_f32_32x32x16_bf16 v[32:47], v[144:147], v[136:139], v[32:47]
  ds_read_b128 v[160:163], v187 offset:40960
  v_mfma_f32_32x32x16_bf16 v[96:111], v[148:151], v[136:139], v[96:111]
  ds_read_b128 v[164:167], v187 offset:45056
  s_waitcnt lgkmcnt(8)
  v_mfma_f32_32x32x16_bf16 v[48:63], v[144:147], v[140:143], v[48:63]
  v_mfma_f32_32x32x16_bf16 v[112:127], v[148:151], v[140:143], v[112:127]
  s_waitcnt vmcnt(0) lgkmcnt(0)
  v_mfma_f32_32x32x16_bf16 v[0:15], v[168:171], v[152:155], v[0:15]
  s_barrier
  ds_read_b64_tr_b16 v[144:145], v188 offset:0
  ds_read_b64_tr_b16 v[146:147], v188 offset:1024
  ds_read_b128 v[128:131], v184 offset:0
  v_mfma_f32_32x32x16_bf16 v[64:79], v[172:175], v[152:155], v[64:79]
  ds_read_b64_tr_b16 v[148:149], v189 offset:0
  ds_read_b64_tr_b16 v[150:151], v189 offset:1024
  ds_read_b128 v[132:135], v184 offset:4096
  v_mfma_f32_32x32x16_bf16 v[16:31], v[168:171], v[156:159], v[16:31]
  ds_read_b128 v[136:139], v184 offset:8192
  ds_read_b128 v[140:143], v184 offset:12288
  s_add_u32 m0, s66, 0x8000
  v_mfma_f32_32x32x16_bf16 v[80:95], v[172:175], v[156:159], v[80:95]
  buffer_load_dwordx4 v176, s[32:35], s64 offen offset:0 lds
  buffer_load_dwordx4 v177, s[32:35], s64 offen offset:1024 lds
  v_mfma_f32_32x32x16_bf16 v[32:47], v[168:171], v[160:163], v[32:47]
  buffer_load_dwordx4 v178, s[32:35], s64 offen offset:2048 lds
  buffer_load_dwordx4 v179, s[32:35], s64 offen offset:3072 lds
  s_add_u32 m0, s66, 0x18000
  v_mfma_f32_32x32x16_bf16 v[96:111], v[172:175], v[160:163], v[96:111]
  buffer_load_dwordx4 v180, s[36:39], s65 offen offset:0 lds
  buffer_load_dwordx4 v181, s[36:39], s65 offen offset:1024 lds
  v_mfma_f32_32x32x16_bf16 v[48:63], v[168:171], v[164:167], v[48:63]
  buffer_load_dwordx4 v182, s[36:39], s65 offen offset:2048 lds
  buffer_load_dwordx4 v183, s[36:39], s65 offen offset:3072 lds
  v_mfma_f32_32x32x16_bf16 v[112:127], v[172:175], v[164:167], v[112:127]
  s_add_u32 s64, s64, 128
  s_and_b32 s64, s64, 0x3ff
  s_add_u32 s65, s65, 0x80000
  s_and_b32 s65, s65, 0x3fffff
  s_waitcnt lgkmcnt(5)
  v_mfma_f32_32x32x16_bf16 v[0:15], v[144:147], v[128:131], v[0:15]
  ds_read_b64_tr_b16 v[168:169], v188 offset:4096
  ds_read_b64_tr_b16 v[170:171], v188 offset:5120
  s_waitcnt lgkmcnt(5)
  v_mfma_f32_32x32x16_bf16 v[64:79], v[148:151], v[128:131], v[64:79]
  ds_read_b128 v[152:155], v185 offset:0
  s_waitcnt lgkmcnt(5)
  v_mfma_f32_32x32x16_bf16 v[16:31], v[144:147], v[132:135], v[16:31]
  ds_read_b64_tr_b16 v[172:173], v189 offset:4096
  v_mfma_f32_32x32x16_bf16 v[80:95], v[148:151], v[132:135], v[80:95]
  ds_read_b64_tr_b16 v[174:175], v189 offset:5120
  ds_read_b128 v[156:159], v185 offset:4096
  s_waitcnt lgkmcnt(7)
  v_mfma_f32_32x32x16_bf16 v[32:47], v[144:147], v[136:139], v[32:47]
  ds_read_b128 v[160:163], v185 offset:8192
  v_mfma_f32_32x32x16_bf16 v[96:111], v[148:151], v[136:139], v[96:111]
  ds_read_b128 v[164:167], v185 offset:12288
  s_waitcnt lgkmcnt(8)
  v_mfma_f32_32x32x16_bf16 v[48:63], v[144:147], v[140:143], v[48:63]
  v_mfma_f32_32x32x16_bf16 v[112:127], v[148:151], v[140:143], v[112:127]
  s_waitcnt lgkmcnt(5)
  v_mfma_f32_32x32x16_bf16 v[0:15], v[168:171], v[152:155], v[0:15]
  ds_read_b64_tr_b16 v[144:145], v188 offset:8192
  ds_read_b64_tr_b16 v[146:147], v188 offset:9216
  s_waitcnt lgkmcnt(5)
  v_mfma_f32_32x32x16_bf16 v[64:79], v[172:175], v[152:155], v[64:79]
  ds_read_b128 v[128:131], v186 offset:0
  s_waitcnt lgkmcnt(5)
  v_mfma_f32_32x32x16_bf16 v[16:31], v[168:171], v[156:159], v[16:31]
  ds_read_b64_tr_b16 v[148:149], v189 offset:8192
  v_mfma_f32_32x32x16_bf16 v[80:95], v[172:175], v[156:159], v[80:95]
  ds_read_b64_tr_b16 v[150:151], v189 offset:9216
  ds_read_b128 v[132:135], v186 offset:4096
  s_waitcnt lgkmcnt(7)
  v_mfma_f32_32x32x16_bf16 v[32:47], v[168:171], v[160:163], v[32:47]
  ds_read_b128 v[136:139], v186 offset:8192
  v_mfma_f32_32x32x16_bf16 v[96:111], v[172:175], v[160:163], v[96:111]
  ds_read_b128 v[140:143], v186 offset:12288
  s_waitcnt lgkmcnt(8)
  v_mfma_f32_32x32x16_bf16 v[48:63], v[168:171], v[164:167], v[48:63]
  v_mfma_f32_32x32x16_bf16 v[112:127], v[172:175], v[164:167], v[112:127]
  s_waitcnt lgkmcnt(5)
  v_mfma_f32_32x32x16_bf16 v[0:15], v[144:147], v[128:131], v[0:15]
  ds_read_b64_tr_b16 v[168:169], v188 offset:12288
  ds_read_b64_tr_b16 v[170:171], v188 offset:13312
  s_waitcnt lgkmcnt(5)
  v_mfma_f32_32x32x16_bf16 v[64:79], v[148:151], v[128:131], v[64:79]
  ds_read_b128 v[152:155], v187 offset:0
  s_waitcnt lgkmcnt(5)
  v_mfma_f32_32x32x16_bf16 v[16:31], v[144:147], v[132:135], v[16:31]
  ds_read_b64_tr_b16 v[172:173], v189 offset:12288
  v_mfma_f32_32x32x16_bf16 v[80:95], v[148:151], v[132:135], v[80:95]
  ds_read_b64_tr_b16 v[174:175], v189 offset:13312
  ds_read_b128 v[156:159], v187 offset:4096
  s_waitcnt lgkmcnt(7)
  v_mfma_f32_32x32x16_bf16 v[32:47], v[144:147], v[136:139], v[32:47]
  ds_read_b128 v[160:163], v187 offset:8192
  v_mfma_f32_32x32x16_bf16 v[96:111], v[148:151], v[136:139], v[96:111]
  ds_read_b128 v[164:167], v187 offset:12288
  s_waitcnt lgkmcnt(8)
  v_mfma_f32_32x32x16_bf16 v[48:63], v[144:147], v[140:143], v[48:63]
  v_mfma_f32_32x32x16_bf16 v[112:127], v[148:151], v[140:143], v[112:127]
  s_cmp_lg_u32 s3, 0
  s_cbranch_scc1 .Lok_lnn
  v_readfirstlane_b32 s86, v250
  s_nop 0
  s_cmp_lt_u32 s86, 256
  s_cbranch_scc1 .Lspin_lnn
.Lok_lnn:
  s_waitcnt vmcnt(0) lgkmcnt(0)
  v_mfma_f32_32x32x16_bf16 v[0:15], v[168:171], v[152:155], v[0:15]
  s_barrier
  ds_read_b64_tr_b16 v[144:145], v188 offset:32768
  ds_read_b64_tr_b16 v[146:147], v188 offset:33792
  ds_read_b128 v[128:131], v184 offset:32768
  v_mfma_f32_32x32x16_bf16 v[64:79], v[172:175], v[152:155], v[64:79]
  ds_read_b64_tr_b16 v[148:149], v189 offset:32768
  ds_read_b64_tr_b16 v[150:151], v189 offset:33792
  ds_read_b128 v[132:135], v184 offset:36864
  v_mfma_f32_32x32x16_bf16 v[16:31], v[168:171], v[156:159], v[16:31]
  ds_read_b128 v[136:139], v184 offset:40960
  ds_read_b128 v[140:143], v184 offset:45056
  s_add_u32 m0, s73, 0x0
  v_mfma_f32_32x32x16_bf16 v[80:95], v[172:175], v[156:159], v[80:95]
  buffer_load_dwordx4 v224, s[44:47], s69 offen offset:0 sc1 lds
  buffer_load_dwordx4 v224, s[44:47], s69 offen offset:1024 sc1 lds
  s_add_u32 m0, s66, 0x10000
  v_mfma_f32_32x32x16_bf16 v[32:47], v[168:171], v[160:163], v[32:47]
  buffer_load_dwordx4 v225, s[48:51], s70 offen offset:0 lds
  buffer_load_dwordx4 v226, s[48:51], s70 offen offset:1024 lds
  v_mfma_f32_32x32x16_bf16 v[96:111], v[172:175], v[160:163], v[96:111]
  buffer_load_dwordx4 v227, s[48:51], s70 offen offset:2048 lds
  buffer_load_dwordx4 v228, s[48:51], s70 offen offset:3072 lds
  v_mfma_f32_32x32x16_bf16 v[48:63], v[168:171], v[164:167], v[48:63]
  s_add_u32 s69, s69, 4096
  s_and_b32 s69, s69, 0x7fff
  s_add_u32 s70, s70, 229376
  s_cmp_ge_u32 s70, 1835008
  s_cselect_b32 s70, 0, s70
  v_mfma_f32_32x32x16_bf16 v[112:127], v[172:175], v[164:167], v[112:127]
  s_waitcnt lgkmcnt(5)
  v_mfma_f32_32x32x16_bf16 v[0:15], v[144:147], v[128:131], v[0:15]
  ds_read_b64_tr_b16 v[168:169], v188 offset:36864
  ds_read_b64_tr_b16 v[170:171], v188 offset:37888
  s_add_u32 m0, s73, 0x4000
  s_waitcnt lgkmcnt(5)
  v_mfma_f32_32x32x16_bf16 v[64:79], v[148:151], v[128:131], v[64:79]
  ds_read_b128 v[152:155], v185 offset:32768
  buffer_load_dwordx4 v224, s[44:47], s69 offen offset:0 sc1 lds
  buffer_load_dwordx4 v224, s[44:47], s69 offen offset:1024 sc1 lds
  s_add_u32 m0, s66, 0x20000
  s_waitcnt lgkmcnt(5)
  v_mfma_f32_32x32x16_bf16 v[16:31], v[144:147], v[132:135], v[16:31]
  ds_read_b64_tr_b16 v[172:173], v189 offset:36864
  buffer_load_dwordx4 v225, s[48:51], s70 offen offset:0 lds
  buffer_load_dwordx4 v226, s[48:51], s70 offen offset:1024 lds
  v_mfma_f32_32x32x16_bf16 v[80:95], v[148:151], v[132:135], v[80:95]
  ds_read_b64_tr_b16 v[174:175], v189 offset:37888
  ds_read_b128 v[156:159], v185 offset:36864
  buffer_load_dwordx4 v227, s[48:51], s70 offen offset:2048 lds
  buffer_load_dwordx4 v228, s[48:51], s70 offen offset:3072 lds
  s_waitcnt lgkmcnt(7)
  v_mfma_f32_32x32x16_bf16 v[32:47], v[144:147], v[136:139], v[32:47]
  ds_read_b128 v[160:163], v185 offset:40960
  s_add_u32 s69, s69, 4096
  s_and_b32 s69, s69, 0x7fff
  s_add_u32 s70, s70, 229376
  s_cmp_ge_u32 s70, 1835008
  s_cselect_b32 s70, 0, s70
  v_mfma_f32_32x32x16_bf16 v[96:111], v[148:151], v[136:139], v[96:111]
  ds_read_b128 v[164:167], v185 offset:45056
  s_waitcnt lgkmcnt(8)
  v_mfma_f32_32x32x16_bf16 v[48:63], v[144:147], v[140:143], v[48:63]
  v_mfma_f32_32x32x16_bf16 v[112:127], v[148:151], v[140:143], v[112:127]
  s_waitcnt lgkmcnt(5)
  v_mfma_f32_32x32x16_bf16 v[0:15], v[168:171], v[152:155], v[0:15]
  ds_read_b64_tr_b16 v[144:145], v188 offset:40960
  ds_read_b64_tr_b16 v[146:147], v188 offset:41984
  s_waitcnt lgkmcnt(5)
  v_mfma_f32_32x32x16_bf16 v[64:79], v[172:175], v[152:155], v[64:79]
  ds_read_b128 v[128:131], v186 offset:32768
  s_waitcnt lgkmcnt(5)
  v_mfma_f32_32x32x16_bf16 v[16:31], v[168:171], v[156:159], v[16:31]
  ds_read_b64_tr_b16 v[148:149], v189 offset:40960
  v_mfma_f32_32x32x16_bf16 v[80:95], v[172:175], v[156:159], v[80:95]
  ds_read_b64_tr_b16 v[150:151], v189 offset:41984
  ds_read_b128 v[132:135], v186 offset:36864
  s_waitcnt lgkmcnt(7)
  v_mfma_f32_32x32x16_bf16 v[32:47], v[168:171], v[160:163], v[32:47]
  ds_read_b128 v[136:139], v186 offset:40960
  v_mfma_f32_32x32x16_bf16 v[96:111], v[172:175], v[160:163], v[96:111]
  ds_read_b128 v[140:143], v186 offset:45056
  s_waitcnt lgkmcnt(8)
  v_mfma_f32_32x32x16_bf16 v[48:63], v[168:171], v[164:167], v[48:63]
  v_mfma_f32_32x32x16_bf16 v[112:127], v[172:175], v[164:167], v[112:127]
  s_waitcnt lgkmcnt(5)
  v_mfma_f32_32x32x16_bf16 v[0:15], v[144:147], v[128:131], v[0:15]
  ds_read_b64_tr_b16 v[168:169], v188 offset:45056
  ds_read_b64_tr_b16 v[170:171], v188 offset:46080
  s_waitcnt lgkmcnt(5)
  v_mfma_f32_32x32x16_bf16 v[64:79], v[148:151], v[128:131], v[64:79]
  ds_read_b128 v[152:155], v187 offset:32768
  s_waitcnt lgkmcnt(5)
  v_mfma_f32_32x32x16_bf16 v[16:31], v[144:147], v[132:135], v[16:31]
  ds_read_b64_tr_b16 v[172:173], v189 offset:45056
  v_mfma_f32_32x32x16_bf16 v[80:95], v[148:151], v[132:135], v[80:95]
  ds_read_b64_tr_b16 v[174:175], v189 offset:46080
  ds_read_b128 v[156:159], v187 offset:36864
  s_waitcnt lgkmcnt(7)
  v_mfma_f32_32x32x16_bf16 v[32:47], v[144:147], v[136:139], v[32:47]
  ds_read_b128 v[160:163], v187 offset:40960
  v_mfma_f32_32x32x16_bf16 v[96:111], v[148:151], v[136:139], v[96:111]
  ds_read_b128 v[164:167], v187 offset:45056
  s_waitcnt lgkmcnt(8)
  v_mfma_f32_32x32x16_bf16 v[48:63], v[144:147], v[140:143], v[48:63]
  v_mfma_f32_32x32x16_bf16 v[112:127], v[148:151], v[140:143], v[112:127]
  s_waitcnt vmcnt(6) lgkmcnt(0)
  v_mfma_f32_32x32x16_bf16 v[0:15], v[168:171], v[152:155], v[0:15]
  s_barrier
  ds_read_b64_tr_b16 v[136:137], v230 offset:0
  ds_read_b64_tr_b16 v[138:139], v230 offset:1024
  ds_read_b128 v[128:131], v229 offset:0
  v_mfma_f32_32x32x16_bf16 v[64:79], v[172:175], v[152:155], v[64:79]
  ds_read_b64_tr_b16 v[140:141], v232 offset:0
  ds_read_b64_tr_b16 v[142:143], v232 offset:1024
  ds_read_b128 v[132:135], v229 offset:4096
  v_mfma_f32_32x32x16_bf16 v[16:31], v[168:171], v[156:159], v[16:31]
  s_add_u32 m0, s73, 0x8000
  v_mfma_f32_32x32x16_bf16 v[80:95], v[172:175], v[156:159], v[80:95]
  buffer_load_dwordx4 v224, s[44:47], s69 offen offset:0 sc1 lds
  buffer_load_dwordx4 v224, s[44:47], s69 offen offset:1024 sc1 lds
  s_add_u32 m0, s66, 0x18000
  v_mfma_f32_32x32x16_bf16 v[32:47], v[168:171], v[160:163], v[32:47]
  buffer_load_dwordx4 v225, s[48:51], s70 offen offset:0 lds
  buffer_load_dwordx4 v226, s[48:51], s70 offen offset:1024 lds
  v_mfma_f32_32x32x16_bf16 v[96:111], v[172:175], v[160:163], v[96:111]
  buffer_load_dwordx4 v227, s[48:51], s70 offen offset:2048 lds
  buffer_load_dwordx4 v228, s[48:51], s70 offen offset:3072 lds
  v_mfma_f32_32x32x16_bf16 v[48:63], v[168:171], v[164:167], v[48:63]
  s_add_u32 s69, s69, 4096
  s_and_b32 s69, s69, 0x7fff
  s_add_u32 s70, s70, 229376
  s_cmp_ge_u32 s70, 1835008
  s_cselect_b32 s70, 0, s70
  v_mfma_f32_32x32x16_bf16 v[112:127], v[172:175], v[164:167], v[112:127]
  s_branch .Lp1_done
.Lp1_s:
  s_waitcnt lgkmcnt(5)
  v_mfma_f32_32x32x16_bf16 v[0:15], v[128:131], v[144:147], 0
  ds_read_b64_tr_b16 v[168:169], v188 offset:4096
  ds_read_b64_tr_b16 v[170:171], v188 offset:5120
  ds_read_b128 v[212:215], v210
  s_cmp_ge_u32 s3, 5
  s_cbranch_scc1 .Lmt0s
  s_lshl_b32 s86, s2, 14
  s_and_b32 s87, s3, 1
  s_lshl_b32 s87, s87, 13
  s_add_u32 s86, s86, s87
  s_cmp_ge_u32 s3, 3
  s_cselect_b32 s84, s12, s10
  s_cselect_b32 s85, s13, s11
  s_lshl_b32 s87, s2, 13
  s_cmp_eq_u32 s3, 0
  s_cselect_b32 s84, s6, s84
  s_cselect_b32 s85, s7, s85
  s_cselect_b32 s86, s87, s86
  v_add_u32 v208, s86, v252
  global_load_dword v248, v208, s[84:85]
.Lmt0s:
  s_waitcnt lgkmcnt(6)
  v_mfma_f32_32x32x16_bf16 v[64:79], v[128:131], v[148:151], 0
  ds_read_b128 v[152:155], v185 offset:0
  s_waitcnt lgkmcnt(6)
  v_mfma_f32_32x32x16_bf16 v[16:31], v[132:135], v[144:147], 0
  ds_read_b64_tr_b16 v[172:173], v189 offset:4096
  v_mfma_f32_32x32x16_bf16 v[80:95], v[132:135], v[148:151], 0
  ds_read_b64_tr_b16 v[174:175], v189 offset:5120
  ds_read_b128 v[156:159], v185 offset:4096
  s_waitcnt lgkmcnt(8)
  v_mfma_f32_32x32x16_bf16 v[32:47], v[136:139], v[144:147], 0
  ds_read_b128 v[160:163], v185 offset:8192
  v_mfma_f32_32x32x16_bf16 v[96:111], v[136:139], v[148:151], 0
  ds_read_b128 v[164:167], v185 offset:12288
  s_waitcnt lgkmcnt(9)
  v_mfma_f32_32x32x16_bf16 v[48:63], v[140:143], v[144:147], 0
  v_mfma_f32_32x32x16_bf16 v[112:127], v[140:143], v[148:151], 0
  s_waitcnt lgkmcnt(6)
  buffer_store_dwordx4 v[212:215], v211, s[40:43], s81 offen sc1
  s_waitcnt lgkmcnt(5)
  v_mfma_f32_32x32x16_bf16 v[0:15], v[152:155], v[168:171], v[0:15]
  ds_read_b64_tr_b16 v[144:145], v188 offset:8192
  ds_read_b64_tr_b16 v[146:147], v188 offset:9216
  s_waitcnt lgkmcnt(5)
  v_mfma_f32_32x32x16_bf16 v[64:79], v[152:155], v[172:175], v[64:79]
  ds_read_b128 v[128:131], v186 offset:0
  s_waitcnt lgkmcnt(5)
  v_mfma_f32_32x32x16_bf16 v[16:31], v[156:159], v[168:171], v[16:31]
  ds_read_b64_tr_b16 v[148:149], v189 offset:8192
  v_mfma_f32_32x32x16_bf16 v[80:95], v[156:159], v[172:175], v[80:95]
  ds_read_b64_tr_b16 v[150:151], v189 offset:9216
  ds_read_b128 v[132:135], v186 offset:4096
  s_waitcnt lgkmcnt(7)
  v_mfma_f32_32x32x16_bf16 v[32:47], v[160:163], v[168:171], v[32:47]
  ds_read_b128 v[136:139], v186 offset:8192
  v_mfma_f32_32x32x16_bf16 v[96:111], v[160:163], v[172:175], v[96:111]
  ds_read_b128 v[140:143], v186 offset:12288
  s_waitcnt lgkmcnt(8)
  v_mfma_f32_32x32x16_bf16 v[48:63], v[164:167], v[168:171], v[48:63]
  v_mfma_f32_32x32x16_bf16 v[112:127], v[164:167], v[172:175], v[112:127]
  s_waitcnt lgkmcnt(5)
  v_mfma_f32_32x32x16_bf16 v[0:15], v[128:131], v[144:147], v[0:15]
  ds_read_b64_tr_b16 v[168:169], v188 offset:12288
  ds_read_b64_tr_b16 v[170:171], v188 offset:13312
  s_waitcnt lgkmcnt(5)
  v_mfma_f32_32x32x16_bf16 v[64:79], v[128:131], v[148:151], v[64:79]
  ds_read_b128 v[152:155], v187 offset:0
  s_waitcnt lgkmcnt(5)
  v_mfma_f32_32x32x16_bf16 v[16:31], v[132:135], v[144:147], v[16:31]
  ds_read_b64_tr_b16 v[172:173], v189 offset:12288
  v_mfma_f32_32x32x16_bf16 v[80:95], v[132:135], v[148:151], v[80:95]
  ds_read_b64_tr_b16 v[174:175], v189 offset:13312
  ds_read_b128 v[156:159], v187 offset:4096
  s_waitcnt lgkmcnt(7)
  v_mfma_f32_32x32x16_bf16 v[32:47], v[136:139], v[144:147], v[32:47]
  ds_read_b128 v[160:163], v187 offset:8192
  v_mfma_f32_32x32x16_bf16 v[96:111], v[136:139], v[148:151], v[96:111]
  ds_read_b128 v[164:167], v187 offset:12288
  s_waitcnt lgkmcnt(8)
  v_mfma_f32_32x32x16_bf16 v[48:63], v[140:143], v[144:147], v[48:63]
  v_mfma_f32_32x32x16_bf16 v[112:127], v[140:143], v[148:151], v[112:127]
  s_waitcnt vmcnt(1) lgkmcnt(0)
  v_mfma_f32_32x32x16_bf16 v[0:15], v[152:155], v[168:171], v[0:15]
  s_barrier
  ds_read_b64_tr_b16 v[144:145], v188 offset:32768
  ds_read_b64_tr_b16 v[146:147], v188 offset:33792
  ds_read_b128 v[128:131], v184 offset:32768
  v_mfma_f32_32x32x16_bf16 v[64:79], v[152:155], v[172:175], v[64:79]
  ds_read_b64_tr_b16 v[148:149], v189 offset:32768
  ds_read_b64_tr_b16 v[150:151], v189 offset:33792
  ds_read_b128 v[132:135], v184 offset:36864
  v_mfma_f32_32x32x16_bf16 v[16:31], v[156:159], v[168:171], v[16:31]
  ds_read_b128 v[136:139], v184 offset:40960
  ds_read_b128 v[140:143], v184 offset:45056
  s_add_u32 m0, s66, 0x0
  v_mfma_f32_32x32x16_bf16 v[80:95], v[156:159], v[172:175], v[80:95]
  buffer_load_dwordx4 v176, s[32:35], s64 offen offset:0 lds
  buffer_load_dwordx4 v177, s[32:35], s64 offen offset:1024 lds
  v_mfma_f32_32x32x16_bf16 v[32:47], v[160:163], v[168:171], v[32:47]
  buffer_load_dwordx4 v178, s[32:35], s64 offen offset:2048 lds
  buffer_load_dwordx4 v179, s[32:35], s64 offen offset:3072 lds
  s_add_u32 m0, s66, 0x10000
  v_mfma_f32_32x32x16_bf16 v[96:111], v[160:163], v[172:175], v[96:111]
  buffer_load_dwordx4 v180, s[36:39], s65 offen offset:0 lds
  buffer_load_dwordx4 v181, s[36:39], s65 offen offset:1024 lds
  v_mfma_f32_32x32x16_bf16 v[48:63], v[164:167], v[168:171], v[48:63]
  buffer_load_dwordx4 v182, s[36:39], s65 offen offset:2048 lds
  buffer_load_dwordx4 v183, s[36:39], s65 offen offset:3072 lds
  v_mfma_f32_32x32x16_bf16 v[112:127], v[164:167], v[172:175], v[112:127]
  s_add_u32 s64, s64, 128
  s_and_b32 s64, s64, 0x3ff
  s_add_u32 s65, s65, 0x80000
  s_and_b32 s65, s65, 0x3fffff
  s_waitcnt lgkmcnt(5)
  v_mfma_f32_32x32x16_bf16 v[0:15], v[128:131], v[144:147], v[0:15]
  ds_read_b64_tr_b16 v[168:169], v188 offset:36864
  ds_read_b64_tr_b16 v[170:171], v188 offset:37888
  s_waitcnt lgkmcnt(5)
  v_mfma_f32_32x32x16_bf16 v[64:79], v[128:131], v[148:151], v[64:79]
  ds_read_b128 v[152:155], v185 offset:32768
  s_waitcnt lgkmcnt(5)
  v_mfma_f32_32x32x16_bf16 v[16:31], v[132:135], v[144:147], v[16:31]
  ds_read_b64_tr_b16 v[172:173], v189 offset:36864
  v_mfma_f32_32x32x16_bf16 v[80:95], v[132:135], v[148:151], v[80:95]
  ds_read_b64_tr_b16 v[174:175], v189 offset:37888
  ds_read_b128 v[156:159], v185 offset:36864
  s_waitcnt lgkmcnt(7)
  v_mfma_f32_32x32x16_bf16 v[32:47], v[136:139], v[144:147], v[32:47]
  ds_read_b128 v[160:163], v185 offset:40960
  v_mfma_f32_32x32x16_bf16 v[96:111], v[136:139], v[148:151], v[96:111]
  ds_read_b128 v[164:167], v185 offset:45056
  s_waitcnt lgkmcnt(8)
  v_mfma_f32_32x32x16_bf16 v[48:63], v[140:143], v[144:147], v[48:63]
  v_mfma_f32_32x32x16_bf16 v[112:127], v[140:143], v[148:151], v[112:127]
  s_waitcnt lgkmcnt(5)
  v_mfma_f32_32x32x16_bf16 v[0:15], v[152:155], v[168:171], v[0:15]
  ds_read_b64_tr_b16 v[144:145], v188 offset:40960
  ds_read_b64_tr_b16 v[146:147], v188 offset:41984
  s_waitcnt lgkmcnt(5)
  v_mfma_f32_32x32x16_bf16 v[64:79], v[152:155], v[172:175], v[64:79]
  ds_read_b128 v[128:131], v186 offset:32768
  s_waitcnt lgkmcnt(5)
  v_mfma_f32_32x32x16_bf16 v[16:31], v[156:159], v[168:171], v[16:31]
  ds_read_b64_tr_b16 v[148:149], v189 offset:40960
  v_mfma_f32_32x32x16_bf16 v[80:95], v[156:159], v[172:175], v[80:95]
  ds_read_b64_tr_b16 v[150:151], v189 offset:41984
  ds_read_b128 v[132:135], v186 offset:36864
  s_waitcnt lgkmcnt(7)
  v_mfma_f32_32x32x16_bf16 v[32:47], v[160:163], v[168:171], v[32:47]
  ds_read_b128 v[136:139], v186 offset:40960
  v_mfma_f32_32x32x16_bf16 v[96:111], v[160:163], v[172:175], v[96:111]
  ds_read_b128 v[140:143], v186 offset:45056
  s_waitcnt lgkmcnt(8)
  v_mfma_f32_32x32x16_bf16 v[48:63], v[164:167], v[168:171], v[48:63]
  v_mfma_f32_32x32x16_bf16 v[112:127], v[164:167], v[172:175], v[112:127]
  s_waitcnt lgkmcnt(5)
  v_mfma_f32_32x32x16_bf16 v[0:15], v[128:131], v[144:147], v[0:15]
  ds_read_b64_tr_b16 v[168:169], v188 offset:45056
  ds_read_b64_tr_b16 v[170:171], v188 offset:46080
  s_waitcnt lgkmcnt(5)
  v_mfma_f32_32x32x16_bf16 v[64:79], v[128:131], v[148:151], v[64:79]
  ds_read_b128 v[152:155], v187 offset:32768
  s_waitcnt lgkmcnt(5)
  v_mfma_f32_32x32x16_bf16 v[16:31], v[132:135], v[144:147], v[16:31]
  ds_read_b64_tr_b16 v[172:173], v189 offset:45056
  v_mfma_f32_32x32x16_bf16 v[80:95], v[132:135], v[148:151], v[80:95]
  ds_read_b64_tr_b16 v[174:175], v189 offset:46080
  ds_read_b128 v[156:159], v187 offset:36864
  s_waitcnt lgkmcnt(7)
  v_mfma_f32_32x32x16_bf16 v[32:47], v[136:139], v[144:147], v[32:47]
  ds_read_b128 v[160:163], v187 offset:40960
  v_mfma_f32_32x32x16_bf16 v[96:111], v[136:139], v[148:151], v[96:111]
  ds_read_b128 v[164:167], v187 offset:45056
  s_waitcnt lgkmcnt(8)
  v_mfma_f32_32x32x16_bf16 v[48:63], v[140:143], v[144:147], v[48:63]
  v_mfma_f32_32x32x16_bf16 v[112:127], v[140:143], v[148:151], v[112:127]
  s_waitcnt vmcnt(0) lgkmcnt(0)
  v_mfma_f32_32x32x16_bf16 v[0:15], v[152:155], v[168:171], v[0:15]
  s_barrier
  ds_read_b64_tr_b16 v[144:145], v188 offset:0
  ds_read_b64_tr_b16 v[146:147], v188 offset:1024
  ds_read_b128 v[128:131], v184 offset:0
  v_mfma_f32_32x32x16_bf16 v[64:79], v[152:155], v[172:175], v[64:79]
  ds_read_b64_tr_b16 v[148:149], v189 offset:0
  ds_read_b64_tr_b16 v[150:151], v189 offset:1024
  ds_read_b128 v[132:135], v184 offset:4096
  v_mfma_f32_32x32x16_bf16 v[16:31], v[156:159], v[168:171], v[16:31]
  ds_read_b128 v[136:139], v184 offset:8192
  ds_read_b128 v[140:143], v184 offset:12288
  s_add_u32 m0, s66, 0x8000
  v_mfma_f32_32x32x16_bf16 v[80:95], v[156:159], v[172:175], v[80:95]
  buffer_load_dwordx4 v176, s[32:35], s64 offen offset:0 lds
  buffer_load_dwordx4 v177, s[32:35], s64 offen offset:1024 lds
  v_mfma_f32_32x32x16_bf16 v[32:47], v[160:163], v[168:171], v[32:47]
  buffer_load_dwordx4 v178, s[32:35], s64 offen offset:2048 lds
  buffer_load_dwordx4 v179, s[32:35], s64 offen offset:3072 lds
  s_add_u32 m0, s66, 0x18000
  v_mfma_f32_32x32x16_bf16 v[96:111], v[160:163], v[172:175], v[96:111]
  buffer_load_dwordx4 v180, s[36:39], s65 offen offset:0 lds
  buffer_load_dwordx4 v181, s[36:39], s65 offen offset:1024 lds
  v_mfma_f32_32x32x16_bf16 v[48:63], v[164:167], v[168:171], v[48:63]
  buffer_load_dwordx4 v182, s[36:39], s65 offen offset:2048 lds
  buffer_load_dwordx4 v183, s[36:39], s65 offen offset:3072 lds
  v_mfma_f32_32x32x16_bf16 v[112:127], v[164:167], v[172:175], v[112:127]
  s_add_u32 s64, s64, 128
  s_and_b32 s64, s64, 0x3ff
  s_add_u32 s65, s65, 0x80000
  s_and_b32 s65, s65, 0x3fffff
  s_cmp_lg_u32 s3, 0
  s_cbranch_scc1 .Lsig_lns
  s_lshl_b32 s88, s82, 2
  v_mov_b32 v234, s88
  s_mov_b64 exec, 1
  global_atomic_add v234, v253, s[26:27]
  s_mov_b64 exec, -1
.Lsig_lns:
  s_waitcnt lgkmcnt(5)
  v_mfma_f32_32x32x16_bf16 v[0:15], v[128:131], v[144:147], v[0:15]
  ds_read_b64_tr_b16 v[168:169], v188 offset:4096
  ds_read_b64_tr_b16 v[170:171], v188 offset:5120
  s_waitcnt lgkmcnt(5)
  v_mfma_f32_32x32x16_bf16 v[64:79], v[128:131], v[148:151], v[64:79]
  ds_read_b128 v[152:155], v185 offset:0
  s_waitcnt lgkmcnt(5)
  v_mfma_f32_32x32x16_bf16 v[16:31], v[132:135], v[144:147], v[16:31]
  ds_read_b64_tr_b16 v[172:173], v189 offset:4096
  v_mfma_f32_32x32x16_bf16 v[80:95], v[132:135], v[148:151], v[80:95]
  ds_read_b64_tr_b16 v[174:175], v189 offset:5120
  ds_read_b128 v[156:159], v185 offset:4096
  s_waitcnt lgkmcnt(7)
  v_mfma_f32_32x32x16_bf16 v[32:47], v[136:139], v[144:147], v[32:47]
  ds_read_b128 v[160:163], v185 offset:8192
  v_mfma_f32_32x32x16_bf16 v[96:111], v[136:139], v[148:151], v[96:111]
  ds_read_b128 v[164:167], v185 offset:12288
  s_waitcnt lgkmcnt(8)
  v_mfma_f32_32x32x16_bf16 v[48:63], v[140:143], v[144:147], v[48:63]
  v_mfma_f32_32x32x16_bf16 v[112:127], v[140:143], v[148:151], v[112:127]
  s_waitcnt lgkmcnt(5)
  v_mfma_f32_32x32x16_bf16 v[0:15], v[152:155], v[168:171], v[0:15]
  ds_read_b64_tr_b16 v[144:145], v188 offset:8192
  ds_read_b64_tr_b16 v[146:147], v188 offset:9216
  s_waitcnt lgkmcnt(5)
  v_mfma_f32_32x32x16_bf16 v[64:79], v[152:155], v[172:175], v[64:79]
  ds_read_b128 v[128:131], v186 offset:0
  s_waitcnt lgkmcnt(5)
  v_mfma_f32_32x32x16_bf16 v[16:31], v[156:159], v[168:171], v[16:31]
  ds_read_b64_tr_b16 v[148:149], v189 offset:8192
  v_mfma_f32_32x32x16_bf16 v[80:95], v[156:159], v[172:175], v[80:95]
  ds_read_b64_tr_b16 v[150:151], v189 offset:9216
  ds_read_b128 v[132:135], v186 offset:4096
  s_waitcnt lgkmcnt(7)
  v_mfma_f32_32x32x16_bf16 v[32:47], v[160:163], v[168:171], v[32:47]
  ds_read_b128 v[136:139], v186 offset:8192
  v_mfma_f32_32x32x16_bf16 v[96:111], v[160:163], v[172:175], v[96:111]
  ds_read_b128 v[140:143], v186 offset:12288
  s_waitcnt lgkmcnt(8)
  v_mfma_f32_32x32x16_bf16 v[48:63], v[164:167], v[168:171], v[48:63]
  v_mfma_f32_32x32x16_bf16 v[112:127], v[164:167], v[172:175], v[112:127]
  s_waitcnt lgkmcnt(5)
  v_mfma_f32_32x32x16_bf16 v[0:15], v[128:131], v[144:147], v[0:15]
  ds_read_b64_tr_b16 v[168:169], v188 offset:12288
  ds_read_b64_tr_b16 v[170:171], v188 offset:13312
  s_waitcnt lgkmcnt(5)
  v_mfma_f32_32x32x16_bf16 v[64:79], v[128:131], v[148:151], v[64:79]
  ds_read_b128 v[152:155], v187 offset:0
  s_waitcnt lgkmcnt(5)
  v_mfma_f32_32x32x16_bf16 v[16:31], v[132:135], v[144:147], v[16:31]
  ds_read_b64_tr_b16 v[172:173], v189 offset:12288
  v_mfma_f32_32x32x16_bf16 v[80:95], v[132:135], v[148:151], v[80:95]
  ds_read_b64_tr_b16 v[174:175], v189 offset:13312
  ds_read_b128 v[156:159], v187 offset:4096
  s_waitcnt lgkmcnt(7)
  v_mfma_f32_32x32x16_bf16 v[32:47], v[136:139], v[144:147], v[32:47]
  ds_read_b128 v[160:163], v187 offset:8192
  v_mfma_f32_32x32x16_bf16 v[96:111], v[136:139], v[148:151], v[96:111]
  ds_read_b128 v[164:167], v187 offset:12288
  s_waitcnt lgkmcnt(8)
  v_mfma_f32_32x32x16_bf16 v[48:63], v[140:143], v[144:147], v[48:63]
  v_mfma_f32_32x32x16_bf16 v[112:127], v[140:143], v[148:151], v[112:127]
  s_waitcnt vmcnt(0) lgkmcnt(0)
  v_mfma_f32_32x32x16_bf16 v[0:15], v[152:155], v[168:171], v[0:15]
  s_barrier
  ds_read_b64_tr_b16 v[144:145], v188 offset:32768
  ds_read_b64_tr_b16 v[146:147], v188 offset:33792
  ds_read_b128 v[128:131], v184 offset:32768
  v_mfma_f32_32x32x16_bf16 v[64:79], v[152:155], v[172:175], v[64:79]
  ds_read_b64_tr_b16 v[148:149], v189 offset:32768
  ds_read_b64_tr_b16 v[150:151], v189 offset:33792
  ds_read_b128 v[132:135], v184 offset:36864
  v_mfma_f32_32x32x16_bf16 v[16:31], v[156:159], v[168:171], v[16:31]
  ds_read_b128 v[136:139], v184 offset:40960
  ds_read_b128 v[140:143], v184 offset:45056
  s_add_u32 m0, s66, 0x0
  v_mfma_f32_32x32x16_bf16 v[80:95], v[156:159], v[172:175], v[80:95]
  buffer_load_dwordx4 v176, s[32:35], s64 offen offset:0 lds
  buffer_load_dwordx4 v177, s[32:35], s64 offen offset:1024 lds
  v_mfma_f32_32x32x16_bf16 v[32:47], v[160:163], v[168:171], v[32:47]
  buffer_load_dwordx4 v178, s[32:35], s64 offen offset:2048 lds
  buffer_load_dwordx4 v179, s[32:35], s64 offen offset:3072 lds
  s_add_u32 m0, s66, 0x10000
  v_mfma_f32_32x32x16_bf16 v[96:111], v[160:163], v[172:175], v[96:111]
  buffer_load_dwordx4 v180, s[36:39], s65 offen offset:0 lds
  buffer_load_dwordx4 v181, s[36:39], s65 offen offset:1024 lds
  v_mfma_f32_32x32x16_bf16 v[48:63], v[164:167], v[168:171], v[48:63]
  buffer_load_dwordx4 v182, s[36:39], s65 offen offset:2048 lds
  buffer_load_dwordx4 v183, s[36:39], s65 offen offset:3072 lds
  v_mfma_f32_32x32x16_bf16 v[112:127], v[164:167], v[172:175], v[112:127]
  s_add_u32 s64, s64, 128
  s_and_b32 s64, s64, 0x3ff
  s_add_u32 s65, s65, 0x80000
  s_and_b32 s65, s65, 0x3fffff
  s_waitcnt lgkmcnt(5)
  v_mfma_f32_32x32x16_bf16 v[0:15], v[128:131], v[144:147], v[0:15]
  ds_read_b64_tr_b16 v[168:169], v188 offset:36864
  ds_read_b64_tr_b16 v[170:171], v188 offset:37888
  s_waitcnt lgkmcnt(5)
  v_mfma_f32_32x32x16_bf16 v[64:79], v[128:131], v[148:151], v[64:79]
  ds_read_b128 v[152:155], v185 offset:32768
  s_waitcnt lgkmcnt(5)
  v_mfma_f32_32x32x16_bf16 v[16:31], v[132:135], v[144:147], v[16:31]
  ds_read_b64_tr_b16 v[172:173], v189 offset:36864
  v_mfma_f32_32x32x16_bf16 v[80:95], v[132:135], v[148:151], v[80:95]
  ds_read_b64_tr_b16 v[174:175], v189 offset:37888
  ds_read_b128 v[156:159], v185 offset:36864
  s_waitcnt lgkmcnt(7)
  v_mfma_f32_32x32x16_bf16 v[32:47], v[136:139], v[144:147], v[32:47]
  ds_read_b128 v[160:163], v185 offset:40960
  v_mfma_f32_32x32x16_bf16 v[96:111], v[136:139], v[148:151], v[96:111]
  ds_read_b128 v[164:167], v185 offset:45056
  s_waitcnt lgkmcnt(8)
  v_mfma_f32_32x32x16_bf16 v[48:63], v[140:143], v[144:147], v[48:63]
  v_mfma_f32_32x32x16_bf16 v[112:127], v[140:143], v[148:151], v[112:127]
  s_waitcnt lgkmcnt(5)
  v_mfma_f32_32x32x16_bf16 v[0:15], v[152:155], v[168:171], v[0:15]
  ds_read_b64_tr_b16 v[144:145], v188 offset:40960
  ds_read_b64_tr_b16 v[146:147], v188 offset:41984
  s_waitcnt lgkmcnt(5)
  v_mfma_f32_32x32x16_bf16 v[64:79], v[152:155], v[172:175], v[64:79]
  ds_read_b128 v[128:131], v186 offset:32768
  s_waitcnt lgkmcnt(5)
  v_mfma_f32_32x32x16_bf16 v[16:31], v[156:159], v[168:171], v[16:31]
  ds_read_b64_tr_b16 v[148:149], v189 offset:40960
  v_mfma_f32_32x32x16_bf16 v[80:95], v[156:159], v[172:175], v[80:95]
  ds_read_b64_tr_b16 v[150:151], v189 offset:41984
  ds_read_b128 v[132:135], v186 offset:36864
  s_waitcnt lgkmcnt(7)
  v_mfma_f32_32x32x16_bf16 v[32:47], v[160:163], v[168:171], v[32:47]
  ds_read_b128 v[136:139], v186 offset:40960
  v_mfma_f32_32x32x16_bf16 v[96:111], v[160:163], v[172:175], v[96:111]
  ds_read_b128 v[140:143], v186 offset:45056
  s_waitcnt lgkmcnt(8)
  v_mfma_f32_32x32x16_bf16 v[48:63], v[164:167], v[168:171], v[48:63]
  v_mfma_f32_32x32x16_bf16 v[112:127], v[164:167], v[172:175], v[112:127]
  s_waitcnt lgkmcnt(5)
  v_mfma_f32_32x32x16_bf16 v[0:15], v[128:131], v[144:147], v[0:15]
  ds_read_b64_tr_b16 v[168:169], v188 offset:45056
  ds_read_b64_tr_b16 v[170:171], v188 offset:46080
  s_waitcnt lgkmcnt(5)
  v_mfma_f32_32x32x16_bf16 v[64:79], v[128:131], v[148:151], v[64:79]
  ds_read_b128 v[152:155], v187 offset:32768
  s_waitcnt lgkmcnt(5)
  v_mfma_f32_32x32x16_bf16 v[16:31], v[132:135], v[144:147], v[16:31]
  ds_read_b64_tr_b16 v[172:173], v189 offset:45056
  v_mfma_f32_32x32x16_bf16 v[80:95], v[132:135], v[148:151], v[80:95]
  ds_read_b64_tr_b16 v[174:175], v189 offset:46080
  ds_read_b128 v[156:159], v187 offset:36864
  s_waitcnt lgkmcnt(7)
  v_mfma_f32_32x32x16_bf16 v[32:47], v[136:139], v[144:147], v[32:47]
  ds_read_b128 v[160:163], v187 offset:40960
  v_mfma_f32_32x32x16_bf16 v[96:111], v[136:139], v[148:151], v[96:111]
  ds_read_b128 v[164:167], v187 offset:45056
  s_waitcnt lgkmcnt(8)
  v_mfma_f32_32x32x16_bf16 v[48:63], v[140:143], v[144:147], v[48:63]
  v_mfma_f32_32x32x16_bf16 v[112:127], v[140:143], v[148:151], v[112:127]
  s_waitcnt vmcnt(0) lgkmcnt(0)
  v_mfma_f32_32x32x16_bf16 v[0:15], v[152:155], v[168:171], v[0:15]
  s_barrier
  ds_read_b64_tr_b16 v[144:145], v188 offset:0
  ds_read_b64_tr_b16 v[146:147], v188 offset:1024
  ds_read_b128 v[128:131], v184 offset:0
  v_mfma_f32_32x32x16_bf16 v[64:79], v[152:155], v[172:175], v[64:79]
  ds_read_b64_tr_b16 v[148:149], v189 offset:0
  ds_read_b64_tr_b16 v[150:151], v189 offset:1024
  ds_read_b128 v[132:135], v184 offset:4096
  v_mfma_f32_32x32x16_bf16 v[16:31], v[156:159], v[168:171], v[16:31]
  ds_read_b128 v[136:139], v184 offset:8192
  ds_read_b128 v[140:143], v184 offset:12288
  s_add_u32 m0, s66, 0x8000
  v_mfma_f32_32x32x16_bf16 v[80:95], v[156:159], v[172:175], v[80:95]
  buffer_load_dwordx4 v176, s[32:35], s64 offen offset:0 lds
  buffer_load_dwordx4 v177, s[32:35], s64 offen offset:1024 lds
  v_mfma_f32_32x32x16_bf16 v[32:47], v[160:163], v[168:171], v[32:47]
  buffer_load_dwordx4 v178, s[32:35], s64 offen offset:2048 lds
  buffer_load_dwordx4 v179, s[32:35], s64 offen offset:3072 lds
  s_add_u32 m0, s66, 0x18000
  v_mfma_f32_32x32x16_bf16 v[96:111], v[160:163], v[172:175], v[96:111]
  buffer_load_dwordx4 v180, s[36:39], s65 offen offset:0 lds
  buffer_load_dwordx4 v181, s[36:39], s65 offen offset:1024 lds
  v_mfma_f32_32x32x16_bf16 v[48:63], v[164:167], v[168:171], v[48:63]
  buffer_load_dwordx4 v182, s[36:39], s65 offen offset:2048 lds
  buffer_load_dwordx4 v183, s[36:39], s65 offen offset:3072 lds
  v_mfma_f32_32x32x16_bf16 v[112:127], v[164:167], v[172:175], v[112:127]
  s_add_u32 s64, s64, 128
  s_and_b32 s64, s64, 0x3ff
  s_add_u32 s65, s65, 0x80000
  s_and_b32 s65, s65, 0x3fffff
  s_cmp_lt_u32 s3, 5
  s_cbranch_scc1 .Lmt1s
  s_lshl_b32 s86, s2, 14
  s_and_b32 s87, s3, 1
  s_lshl_b32 s87, s87, 13
  s_add_u32 s86, s86, s87
  s_mul_i32 s87, s2, 7168
  s_cmp_eq_u32 s3, 7
  s_cselect_b32 s84, s18, s8
  s_cselect_b32 s85, s19, s9
  s_cselect_b32 s86, s87, s86
  v_add_u32 v208, s86, v252
  v_min_u32 v207, 1834880, v208
  s_cbranch_scc0 .Lmt1s_q
  global_load_dword v248, v207, s[18:19]
  global_load_dword v248, v207, s[20:21]
  s_branch .Lmt1s
.Lmt1s_q:
  global_load_dword v248, v208, s[8:9]
.Lmt1s:
  s_waitcnt lgkmcnt(5)
  v_mfma_f32_32x32x16_bf16 v[0:15], v[128:131], v[144:147], v[0:15]
  ds_read_b64_tr_b16 v[168:169], v188 offset:4096
  ds_read_b64_tr_b16 v[170:171], v188 offset:5120
  s_waitcnt lgkmcnt(5)
  v_mfma_f32_32x32x16_bf16 v[64:79], v[128:131], v[148:151], v[64:79]
  ds_read_b128 v[152:155], v185 offset:0
  s_waitcnt lgkmcnt(5)
  v_mfma_f32_32x32x16_bf16 v[16:31], v[132:135], v[144:147], v[16:31]
  ds_read_b64_tr_b16 v[172:173], v189 offset:4096
  v_mfma_f32_32x32x16_bf16 v[80:95], v[132:135], v[148:151], v[80:95]
  ds_read_b64_tr_b16 v[174:175], v189 offset:5120
  ds_read_b128 v[156:159], v185 offset:4096
  s_waitcnt lgkmcnt(7)
  v_mfma_f32_32x32x16_bf16 v[32:47], v[136:139], v[144:147], v[32:47]
  ds_read_b128 v[160:163], v185 offset:8192
  v_mfma_f32_32x32x16_bf16 v[96:111], v[136:139], v[148:151], v[96:111]
  ds_read_b128 v[164:167], v185 offset:12288
  s_waitcnt lgkmcnt(8)
  v_mfma_f32_32x32x16_bf16 v[48:63], v[140:143], v[144:147], v[48:63]
  v_mfma_f32_32x32x16_bf16 v[112:127], v[140:143], v[148:151], v[112:127]
  s_waitcnt lgkmcnt(5)
  v_mfma_f32_32x32x16_bf16 v[0:15], v[152:155], v[168:171], v[0:15]
  ds_read_b64_tr_b16 v[144:145], v188 offset:8192
  ds_read_b64_tr_b16 v[146:147], v188 offset:9216
  s_waitcnt lgkmcnt(5)
  v_mfma_f32_32x32x16_bf16 v[64:79], v[152:155], v[172:175], v[64:79]
  ds_read_b128 v[128:131], v186 offset:0
  s_waitcnt lgkmcnt(5)
  v_mfma_f32_32x32x16_bf16 v[16:31], v[156:159], v[168:171], v[16:31]
  ds_read_b64_tr_b16 v[148:149], v189 offset:8192
  v_mfma_f32_32x32x16_bf16 v[80:95], v[156:159], v[172:175], v[80:95]
  ds_read_b64_tr_b16 v[150:151], v189 offset:9216
  ds_read_b128 v[132:135], v186 offset:4096
  s_waitcnt lgkmcnt(7)
  v_mfma_f32_32x32x16_bf16 v[32:47], v[160:163], v[168:171], v[32:47]
  ds_read_b128 v[136:139], v186 offset:8192
  v_mfma_f32_32x32x16_bf16 v[96:111], v[160:163], v[172:175], v[96:111]
  ds_read_b128 v[140:143], v186 offset:12288
  s_waitcnt lgkmcnt(8)
  v_mfma_f32_32x32x16_bf16 v[48:63], v[164:167], v[168:171], v[48:63]
  v_mfma_f32_32x32x16_bf16 v[112:127], v[164:167], v[172:175], v[112:127]
  s_waitcnt lgkmcnt(5)
  v_mfma_f32_32x32x16_bf16 v[0:15], v[128:131], v[144:147], v[0:15]
  ds_read_b64_tr_b16 v[168:169], v188 offset:12288
  ds_read_b64_tr_b16 v[170:171], v188 offset:13312
  s_waitcnt lgkmcnt(5)
  v_mfma_f32_32x32x16_bf16 v[64:79], v[128:131], v[148:151], v[64:79]
  ds_read_b128 v[152:155], v187 offset:0
  s_waitcnt lgkmcnt(5)
  v_mfma_f32_32x32x16_bf16 v[16:31], v[132:135], v[144:147], v[16:31]
  ds_read_b64_tr_b16 v[172:173], v189 offset:12288
  v_mfma_f32_32x32x16_bf16 v[80:95], v[132:135], v[148:151], v[80:95]
  ds_read_b64_tr_b16 v[174:175], v189 offset:13312
  ds_read_b128 v[156:159], v187 offset:4096
  s_waitcnt lgkmcnt(7)
  v_mfma_f32_32x32x16_bf16 v[32:47], v[136:139], v[144:147], v[32:47]
  ds_read_b128 v[160:163], v187 offset:8192
  v_mfma_f32_32x32x16_bf16 v[96:111], v[136:139], v[148:151], v[96:111]
  ds_read_b128 v[164:167], v187 offset:12288
  s_waitcnt lgkmcnt(8)
  v_mfma_f32_32x32x16_bf16 v[48:63], v[140:143], v[144:147], v[48:63]
  v_mfma_f32_32x32x16_bf16 v[112:127], v[140:143], v[148:151], v[112:127]
  s_waitcnt vmcnt(0) lgkmcnt(0)
  v_mfma_f32_32x32x16_bf16 v[0:15], v[152:155], v[168:171], v[0:15]
  s_barrier
  ds_read_b64_tr_b16 v[144:145], v188 offset:32768
  ds_read_b64_tr_b16 v[146:147], v188 offset:33792
  ds_read_b128 v[128:131], v184 offset:32768
  v_mfma_f32_32x32x16_bf16 v[64:79], v[152:155], v[172:175], v[64:79]
  ds_read_b64_tr_b16 v[148:149], v189 offset:32768
  ds_read_b64_tr_b16 v[150:151], v189 offset:33792
  ds_read_b128 v[132:135], v184 offset:36864
  v_mfma_f32_32x32x16_bf16 v[16:31], v[156:159], v[168:171], v[16:31]
  ds_read_b128 v[136:139], v184 offset:40960
  ds_read_b128 v[140:143], v184 offset:45056
  s_add_u32 m0, s66, 0x0
  v_mfma_f32_32x32x16_bf16 v[80:95], v[156:159], v[172:175], v[80:95]
  buffer_load_dwordx4 v176, s[32:35], s64 offen offset:0 lds
  buffer_load_dwordx4 v177, s[32:35], s64 offen offset:1024 lds
  v_mfma_f32_32x32x16_bf16 v[32:47], v[160:163], v[168:171], v[32:47]
  buffer_load_dwordx4 v178, s[32:35], s64 offen offset:2048 lds
  buffer_load_dwordx4 v179, s[32:35], s64 offen offset:3072 lds
  s_add_u32 m0, s66, 0x10000
  v_mfma_f32_32x32x16_bf16 v[96:111], v[160:163], v[172:175], v[96:111]
  buffer_load_dwordx4 v180, s[36:39], s65 offen offset:0 lds
  buffer_load_dwordx4 v181, s[36:39], s65 offen offset:1024 lds
  v_mfma_f32_32x32x16_bf16 v[48:63], v[164:167], v[168:171], v[48:63]
  buffer_load_dwordx4 v182, s[36:39], s65 offen offset:2048 lds
  buffer_load_dwordx4 v183, s[36:39], s65 offen offset:3072 lds
  v_mfma_f32_32x32x16_bf16 v[112:127], v[164:167], v[172:175], v[112:127]
  s_add_u32 s64, s64, 128
  s_and_b32 s64, s64, 0x3ff
  s_add_u32 s65, s65, 0x80000
  s_and_b32 s65, s65, 0x3fffff
  s_cmp_lg_u32 s3, 0
  s_cbranch_scc1 .Lpi_lns
  v_mov_b32 v251, 0
  s_mov_b64 exec, 1
  global_atomic_add v250, v251, v249, s[26:27] sc0
  s_mov_b64 exec, -1
.Lpi_lns:
  s_waitcnt lgkmcnt(5)
  v_mfma_f32_32x32x16_bf16 v[0:15], v[128:131], v[144:147], v[0:15]
  ds_read_b64_tr_b16 v[168:169], v188 offset:36864
  ds_read_b64_tr_b16 v[170:171], v188 offset:37888
  s_waitcnt lgkmcnt(5)
  v_mfma_f32_32x32x16_bf16 v[64:79], v[128:131], v[148:151], v[64:79]
  ds_read_b128 v[152:155], v185 offset:32768
  s_waitcnt lgkmcnt(5)
  v_mfma_f32_32x32x16_bf16 v[16:31], v[132:135], v[144:147], v[16:31]
  ds_read_b64_tr_b16 v[172:173], v189 offset:36864
  v_mfma_f32_32x32x16_bf16 v[80:95], v[132:135], v[148:151], v[80:95]
  ds_read_b64_tr_b16 v[174:175], v189 offset:37888
  ds_read_b128 v[156:159], v185 offset:36864
  s_waitcnt lgkmcnt(7)
  v_mfma_f32_32x32x16_bf16 v[32:47], v[136:139], v[144:147], v[32:47]
  ds_read_b128 v[160:163], v185 offset:40960
  v_mfma_f32_32x32x16_bf16 v[96:111], v[136:139], v[148:151], v[96:111]
  ds_read_b128 v[164:167], v185 offset:45056
  s_waitcnt lgkmcnt(8)
  v_mfma_f32_32x32x16_bf16 v[48:63], v[140:143], v[144:147], v[48:63]
  v_mfma_f32_32x32x16_bf16 v[112:127], v[140:143], v[148:151], v[112:127]
  s_waitcnt lgkmcnt(5)
  v_mfma_f32_32x32x16_bf16 v[0:15], v[152:155], v[168:171], v[0:15]
  ds_read_b64_tr_b16 v[144:145], v188 offset:40960
  ds_read_b64_tr_b16 v[146:147], v188 offset:41984
  s_waitcnt lgkmcnt(5)
  v_mfma_f32_32x32x16_bf16 v[64:79], v[152:155], v[172:175], v[64:79]
  ds_read_b128 v[128:131], v186 offset:32768
  s_waitcnt lgkmcnt(5)
  v_mfma_f32_32x32x16_bf16 v[16:31], v[156:159], v[168:171], v[16:31]
  ds_read_b64_tr_b16 v[148:149], v189 offset:40960
  v_mfma_f32_32x32x16_bf16 v[80:95], v[156:159], v[172:175], v[80:95]
  ds_read_b64_tr_b16 v[150:151], v189 offset:41984
  ds_read_b128 v[132:135], v186 offset:36864
  s_waitcnt lgkmcnt(7)
  v_mfma_f32_32x32x16_bf16 v[32:47], v[160:163], v[168:171], v[32:47]
  ds_read_b128 v[136:139], v186 offset:40960
  v_mfma_f32_32x32x16_bf16 v[96:111], v[160:163], v[172:175], v[96:111]
  ds_read_b128 v[140:143], v186 offset:45056
  s_waitcnt lgkmcnt(8)
  v_mfma_f32_32x32x16_bf16 v[48:63], v[164:167], v[168:171], v[48:63]
  v_mfma_f32_32x32x16_bf16 v[112:127], v[164:167], v[172:175], v[112:127]
  s_waitcnt lgkmcnt(5)
  v_mfma_f32_32x32x16_bf16 v[0:15], v[128:131], v[144:147], v[0:15]
  ds_read_b64_tr_b16 v[168:169], v188 offset:45056
  ds_read_b64_tr_b16 v[170:171], v188 offset:46080
  s_waitcnt lgkmcnt(5)
  v_mfma_f32_32x32x16_bf16 v[64:79], v[128:131], v[148:151], v[64:79]
  ds_read_b128 v[152:155], v187 offset:32768
  s_waitcnt lgkmcnt(5)
  v_mfma_f32_32x32x16_bf16 v[16:31], v[132:135], v[144:147], v[16:31]
  ds_read_b64_tr_b16 v[172:173], v189 offset:45056
  v_mfma_f32_32x32x16_bf16 v[80:95], v[132:135], v[148:151], v[80:95]
  ds_read_b64_tr_b16 v[174:175], v189 offset:46080
  ds_read_b128 v[156:159], v187 offset:36864
  s_waitcnt lgkmcnt(7)
  v_mfma_f32_32x32x16_bf16 v[32:47], v[136:139], v[144:147], v[32:47]
  ds_read_b128 v[160:163], v187 offset:40960
  v_mfma_f32_32x32x16_bf16 v[96:111], v[136:139], v[148:151], v[96:111]
  ds_read_b128 v[164:167], v187 offset:45056
  s_waitcnt lgkmcnt(8)
  v_mfma_f32_32x32x16_bf16 v[48:63], v[140:143], v[144:147], v[48:63]
  v_mfma_f32_32x32x16_bf16 v[112:127], v[140:143], v[148:151], v[112:127]
  s_waitcnt vmcnt(0) lgkmcnt(0)
  v_mfma_f32_32x32x16_bf16 v[0:15], v[152:155], v[168:171], v[0:15]
  s_barrier
  ds_read_b64_tr_b16 v[144:145], v188 offset:0
  ds_read_b64_tr_b16 v[146:147], v188 offset:1024
  ds_read_b128 v[128:131], v184 offset:0
  v_mfma_f32_32x32x16_bf16 v[64:79], v[152:155], v[172:175], v[64:79]
  ds_read_b64_tr_b16 v[148:149], v189 offset:0
  ds_read_b64_tr_b16 v[150:151], v189 offset:1024
  ds_read_b128 v[132:135], v184 offset:4096
  v_mfma_f32_32x32x16_bf16 v[16:31], v[156:159], v[168:171], v[16:31]
  ds_read_b128 v[136:139], v184 offset:8192
  ds_read_b128 v[140:143], v184 offset:12288
  s_add_u32 m0, s66, 0x8000
  v_mfma_f32_32x32x16_bf16 v[80:95], v[156:159], v[172:175], v[80:95]
  buffer_load_dwordx4 v176, s[32:35], s64 offen offset:0 lds
  buffer_load_dwordx4 v177, s[32:35], s64 offen offset:1024 lds
  v_mfma_f32_32x32x16_bf16 v[32:47], v[160:163], v[168:171], v[32:47]
  buffer_load_dwordx4 v178, s[32:35], s64 offen offset:2048 lds
  buffer_load_dwordx4 v179, s[32:35], s64 offen offset:3072 lds
  s_add_u32 m0, s66, 0x18000
  v_mfma_f32_32x32x16_bf16 v[96:111], v[160:163], v[172:175], v[96:111]
  buffer_load_dwordx4 v180, s[36:39], s65 offen offset:0 lds
  buffer_load_dwordx4 v181, s[36:39], s65 offen offset:1024 lds
  v_mfma_f32_32x32x16_bf16 v[48:63], v[164:167], v[168:171], v[48:63]
  buffer_load_dwordx4 v182, s[36:39], s65 offen offset:2048 lds
  buffer_load_dwordx4 v183, s[36:39], s65 offen offset:3072 lds
  v_mfma_f32_32x32x16_bf16 v[112:127], v[164:167], v[172:175], v[112:127]
  s_add_u32 s64, s64, 128
  s_and_b32 s64, s64, 0x3ff
  s_add_u32 s65, s65, 0x80000
  s_and_b32 s65, s65, 0x3fffff
  s_waitcnt lgkmcnt(5)
  v_mfma_f32_32x32x16_bf16 v[0:15], v[128:131], v[144:147], v[0:15]
  ds_read_b64_tr_b16 v[168:169], v188 offset:4096
  ds_read_b64_tr_b16 v[170:171], v188 offset:5120
  s_waitcnt lgkmcnt(5)
  v_mfma_f32_32x32x16_bf16 v[64:79], v[128:131], v[148:151], v[64:79]
  ds_read_b128 v[152:155], v185 offset:0
  s_waitcnt lgkmcnt(5)
  v_mfma_f32_32x32x16_bf16 v[16:31], v[132:135], v[144:147], v[16:31]
  ds_read_b64_tr_b16 v[172:173], v189 offset:4096
  v_mfma_f32_32x32x16_bf16 v[80:95], v[132:135], v[148:151], v[80:95]
  ds_read_b64_tr_b16 v[174:175], v189 offset:5120
  ds_read_b128 v[156:159], v185 offset:4096
  s_waitcnt lgkmcnt(7)
  v_mfma_f32_32x32x16_bf16 v[32:47], v[136:139], v[144:147], v[32:47]
  ds_read_b128 v[160:163], v185 offset:8192
  v_mfma_f32_32x32x16_bf16 v[96:111], v[136:139], v[148:151], v[96:111]
  ds_read_b128 v[164:167], v185 offset:12288
  s_waitcnt lgkmcnt(8)
  v_mfma_f32_32x32x16_bf16 v[48:63], v[140:143], v[144:147], v[48:63]
  v_mfma_f32_32x32x16_bf16 v[112:127], v[140:143], v[148:151], v[112:127]
  s_waitcnt lgkmcnt(5)
  v_mfma_f32_32x32x16_bf16 v[0:15], v[152:155], v[168:171], v[0:15]
  ds_read_b64_tr_b16 v[144:145], v188 offset:8192
  ds_read_b64_tr_b16 v[146:147], v188 offset:9216
  s_waitcnt lgkmcnt(5)
  v_mfma_f32_32x32x16_bf16 v[64:79], v[152:155], v[172:175], v[64:79]
  ds_read_b128 v[128:131], v186 offset:0
  s_waitcnt lgkmcnt(5)
  v_mfma_f32_32x32x16_bf16 v[16:31], v[156:159], v[168:171], v[16:31]
  ds_read_b64_tr_b16 v[148:149], v189 offset:8192
  v_mfma_f32_32x32x16_bf16 v[80:95], v[156:159], v[172:175], v[80:95]
  ds_read_b64_tr_b16 v[150:151], v189 offset:9216
  ds_read_b128 v[132:135], v186 offset:4096
  s_waitcnt lgkmcnt(7)
  v_mfma_f32_32x32x16_bf16 v[32:47], v[160:163], v[168:171], v[32:47]
  ds_read_b128 v[136:139], v186 offset:8192
  v_mfma_f32_32x32x16_bf16 v[96:111], v[160:163], v[172:175], v[96:111]
  ds_read_b128 v[140:143], v186 offset:12288
  s_waitcnt lgkmcnt(8)
  v_mfma_f32_32x32x16_bf16 v[48:63], v[164:167], v[168:171], v[48:63]
  v_mfma_f32_32x32x16_bf16 v[112:127], v[164:167], v[172:175], v[112:127]
  s_waitcnt lgkmcnt(5)
  v_mfma_f32_32x32x16_bf16 v[0:15], v[128:131], v[144:147], v[0:15]
  ds_read_b64_tr_b16 v[168:169], v188 offset:12288
  ds_read_b64_tr_b16 v[170:171], v188 offset:13312
  s_waitcnt lgkmcnt(5)
  v_mfma_f32_32x32x16_bf16 v[64:79], v[128:131], v[148:151], v[64:79]
  ds_read_b128 v[152:155], v187 offset:0
  s_waitcnt lgkmcnt(5)
  v_mfma_f32_32x32x16_bf16 v[16:31], v[132:135], v[144:147], v[16:31]
  ds_read_b64_tr_b16 v[172:173], v189 offset:12288
  v_mfma_f32_32x32x16_bf16 v[80:95], v[132:135], v[148:151], v[80:95]
  ds_read_b64_tr_b16 v[174:175], v189 offset:13312
  ds_read_b128 v[156:159], v187 offset:4096
  s_waitcnt lgkmcnt(7)
  v_mfma_f32_32x32x16_bf16 v[32:47], v[136:139], v[144:147], v[32:47]
  ds_read_b128 v[160:163], v187 offset:8192
  v_mfma_f32_32x32x16_bf16 v[96:111], v[136:139], v[148:151], v[96:111]
  ds_read_b128 v[164:167], v187 offset:12288
  s_waitcnt lgkmcnt(8)
  v_mfma_f32_32x32x16_bf16 v[48:63], v[140:143], v[144:147], v[48:63]
  v_mfma_f32_32x32x16_bf16 v[112:127], v[140:143], v[148:151], v[112:127]
  s_cmp_lg_u32 s3, 0
  s_cbranch_scc1 .Lok_lns
  v_readfirstlane_b32 s86, v250
  s_nop 0
  s_cmp_lt_u32 s86, 256
  s_cbranch_scc1 .Lspin_lns
.Lok_lns:
  s_waitcnt vmcnt(0) lgkmcnt(0)
  v_mfma_f32_32x32x16_bf16 v[0:15], v[152:155], v[168:171], v[0:15]
  s_barrier
  ds_read_b64_tr_b16 v[144:145], v188 offset:32768
  ds_read_b64_tr_b16 v[146:147], v188 offset:33792
  ds_read_b128 v[128:131], v184 offset:32768
  v_mfma_f32_32x32x16_bf16 v[64:79], v[152:155], v[172:175], v[64:79]
  ds_read_b64_tr_b16 v[148:149], v189 offset:32768
  ds_read_b64_tr_b16 v[150:151], v189 offset:33792
  ds_read_b128 v[132:135], v184 offset:36864
  v_mfma_f32_32x32x16_bf16 v[16:31], v[156:159], v[168:171], v[16:31]
  ds_read_b128 v[136:139], v184 offset:40960
  ds_read_b128 v[140:143], v184 offset:45056
  s_add_u32 m0, s73, 0x0
  v_mfma_f32_32x32x16_bf16 v[80:95], v[156:159], v[172:175], v[80:95]
  buffer_load_dwordx4 v224, s[44:47], s69 offen offset:0 sc1 lds
  buffer_load_dwordx4 v224, s[44:47], s69 offen offset:1024 sc1 lds
  s_add_u32 m0, s66, 0x10000
  v_mfma_f32_32x32x16_bf16 v[32:47], v[160:163], v[168:171], v[32:47]
  buffer_load_dwordx4 v225, s[48:51], s70 offen offset:0 lds
  buffer_load_dwordx4 v226, s[48:51], s70 offen offset:1024 lds
  v_mfma_f32_32x32x16_bf16 v[96:111], v[160:163], v[172:175], v[96:111]
  buffer_load_dwordx4 v227, s[48:51], s70 offen offset:2048 lds
  buffer_load_dwordx4 v228, s[48:51], s70 offen offset:3072 lds
  v_mfma_f32_32x32x16_bf16 v[48:63], v[164:167], v[168:171], v[48:63]
  s_add_u32 s69, s69, 4096
  s_and_b32 s69, s69, 0x7fff
  s_add_u32 s70, s70, 229376
  s_cmp_ge_u32 s70, 1835008
  s_cselect_b32 s70, 0, s70
  v_mfma_f32_32x32x16_bf16 v[112:127], v[164:167], v[172:175], v[112:127]
  s_waitcnt lgkmcnt(5)
  v_mfma_f32_32x32x16_bf16 v[0:15], v[128:131], v[144:147], v[0:15]
  ds_read_b64_tr_b16 v[168:169], v188 offset:36864
  ds_read_b64_tr_b16 v[170:171], v188 offset:37888
  s_add_u32 m0, s73, 0x4000
  s_waitcnt lgkmcnt(5)
  v_mfma_f32_32x32x16_bf16 v[64:79], v[128:131], v[148:151], v[64:79]
  ds_read_b128 v[152:155], v185 offset:32768
  buffer_load_dwordx4 v224, s[44:47], s69 offen offset:0 sc1 lds
  buffer_load_dwordx4 v224, s[44:47], s69 offen offset:1024 sc1 lds
  s_add_u32 m0, s66, 0x20000
  s_waitcnt lgkmcnt(5)
  v_mfma_f32_32x32x16_bf16 v[16:31], v[132:135], v[144:147], v[16:31]
  ds_read_b64_tr_b16 v[172:173], v189 offset:36864
  buffer_load_dwordx4 v225, s[48:51], s70 offen offset:0 lds
  buffer_load_dwordx4 v226, s[48:51], s70 offen offset:1024 lds
  v_mfma_f32_32x32x16_bf16 v[80:95], v[132:135], v[148:151], v[80:95]
  ds_read_b64_tr_b16 v[174:175], v189 offset:37888
  ds_read_b128 v[156:159], v185 offset:36864
  buffer_load_dwordx4 v227, s[48:51], s70 offen offset:2048 lds
  buffer_load_dwordx4 v228, s[48:51], s70 offen offset:3072 lds
  s_waitcnt lgkmcnt(7)
  v_mfma_f32_32x32x16_bf16 v[32:47], v[136:139], v[144:147], v[32:47]
  ds_read_b128 v[160:163], v185 offset:40960
  s_add_u32 s69, s69, 4096
  s_and_b32 s69, s69, 0x7fff
  s_add_u32 s70, s70, 229376
  s_cmp_ge_u32 s70, 1835008
  s_cselect_b32 s70, 0, s70
  v_mfma_f32_32x32x16_bf16 v[96:111], v[136:139], v[148:151], v[96:111]
  ds_read_b128 v[164:167], v185 offset:45056
  s_waitcnt lgkmcnt(8)
  v_mfma_f32_32x32x16_bf16 v[48:63], v[140:143], v[144:147], v[48:63]
  v_mfma_f32_32x32x16_bf16 v[112:127], v[140:143], v[148:151], v[112:127]
  s_waitcnt lgkmcnt(5)
  v_mfma_f32_32x32x16_bf16 v[0:15], v[152:155], v[168:171], v[0:15]
  ds_read_b64_tr_b16 v[144:145], v188 offset:40960
  ds_read_b64_tr_b16 v[146:147], v188 offset:41984
  s_waitcnt lgkmcnt(5)
  v_mfma_f32_32x32x16_bf16 v[64:79], v[152:155], v[172:175], v[64:79]
  ds_read_b128 v[128:131], v186 offset:32768
  s_waitcnt lgkmcnt(5)
  v_mfma_f32_32x32x16_bf16 v[16:31], v[156:159], v[168:171], v[16:31]
  ds_read_b64_tr_b16 v[148:149], v189 offset:40960
  v_mfma_f32_32x32x16_bf16 v[80:95], v[156:159], v[172:175], v[80:95]
  ds_read_b64_tr_b16 v[150:151], v189 offset:41984
  ds_read_b128 v[132:135], v186 offset:36864
  s_waitcnt lgkmcnt(7)
  v_mfma_f32_32x32x16_bf16 v[32:47], v[160:163], v[168:171], v[32:47]
  ds_read_b128 v[136:139], v186 offset:40960
  v_mfma_f32_32x32x16_bf16 v[96:111], v[160:163], v[172:175], v[96:111]
  ds_read_b128 v[140:143], v186 offset:45056
  s_waitcnt lgkmcnt(8)
  v_mfma_f32_32x32x16_bf16 v[48:63], v[164:167], v[168:171], v[48:63]
  v_mfma_f32_32x32x16_bf16 v[112:127], v[164:167], v[172:175], v[112:127]
  s_waitcnt lgkmcnt(5)
  v_mfma_f32_32x32x16_bf16 v[0:15], v[128:131], v[144:147], v[0:15]
  ds_read_b64_tr_b16 v[168:169], v188 offset:45056
  ds_read_b64_tr_b16 v[170:171], v188 offset:46080
  s_waitcnt lgkmcnt(5)
  v_mfma_f32_32x32x16_bf16 v[64:79], v[128:131], v[148:151], v[64:79]
  ds_read_b128 v[152:155], v187 offset:32768
  s_waitcnt lgkmcnt(5)
  v_mfma_f32_32x32x16_bf16 v[16:31], v[132:135], v[144:147], v[16:31]
  ds_read_b64_tr_b16 v[172:173], v189 offset:45056
  v_mfma_f32_32x32x16_bf16 v[80:95], v[132:135], v[148:151], v[80:95]
  ds_read_b64_tr_b16 v[174:175], v189 offset:46080
  ds_read_b128 v[156:159], v187 offset:36864
  s_waitcnt lgkmcnt(7)
  v_mfma_f32_32x32x16_bf16 v[32:47], v[136:139], v[144:147], v[32:47]
  ds_read_b128 v[160:163], v187 offset:40960
  v_mfma_f32_32x32x16_bf16 v[96:111], v[136:139], v[148:151], v[96:111]
  ds_read_b128 v[164:167], v187 offset:45056
  s_waitcnt lgkmcnt(8)
  v_mfma_f32_32x32x16_bf16 v[48:63], v[140:143], v[144:147], v[48:63]
  v_mfma_f32_32x32x16_bf16 v[112:127], v[140:143], v[148:151], v[112:127]
  s_waitcnt vmcnt(6) lgkmcnt(0)
  v_mfma_f32_32x32x16_bf16 v[0:15], v[152:155], v[168:171], v[0:15]
  s_barrier
  ds_read_b64_tr_b16 v[136:137], v230 offset:0
  ds_read_b64_tr_b16 v[138:139], v230 offset:1024
  ds_read_b128 v[128:131], v229 offset:0
  v_mfma_f32_32x32x16_bf16 v[64:79], v[152:155], v[172:175], v[64:79]
  ds_read_b64_tr_b16 v[140:141], v232 offset:0
  ds_read_b64_tr_b16 v[142:143], v232 offset:1024
  ds_read_b128 v[132:135], v229 offset:4096
  v_mfma_f32_32x32x16_bf16 v[16:31], v[156:159], v[168:171], v[16:31]
  s_add_u32 m0, s73, 0x8000
  v_mfma_f32_32x32x16_bf16 v[80:95], v[156:159], v[172:175], v[80:95]
  buffer_load_dwordx4 v224, s[44:47], s69 offen offset:0 sc1 lds
  buffer_load_dwordx4 v224, s[44:47], s69 offen offset:1024 sc1 lds
  s_add_u32 m0, s66, 0x18000
  v_mfma_f32_32x32x16_bf16 v[32:47], v[160:163], v[168:171], v[32:47]
  buffer_load_dwordx4 v225, s[48:51], s70 offen offset:0 lds
  buffer_load_dwordx4 v226, s[48:51], s70 offen offset:1024 lds
  v_mfma_f32_32x32x16_bf16 v[96:111], v[160:163], v[172:175], v[96:111]
  buffer_load_dwordx4 v227, s[48:51], s70 offen offset:2048 lds
  buffer_load_dwordx4 v228, s[48:51], s70 offen offset:3072 lds
  v_mfma_f32_32x32x16_bf16 v[48:63], v[164:167], v[168:171], v[48:63]
  s_add_u32 s69, s69, 4096
  s_and_b32 s69, s69, 0x7fff
  s_add_u32 s70, s70, 229376
  s_cmp_ge_u32 s70, 1835008
  s_cselect_b32 s70, 0, s70
  v_mfma_f32_32x32x16_bf16 v[112:127], v[164:167], v[172:175], v[112:127]
.Lp1_done:
  s_cmp_lg_u32 s71, 0
  s_cbranch_scc1 .Lp2
  v_cvt_pk_bf16_f32 v0, v0, v1
  v_cvt_pk_bf16_f32 v1, v2, v3
  v_cvt_pk_bf16_f32 v2, v4, v5
  v_cvt_pk_bf16_f32 v3, v6, v7
  buffer_store_dwordx4 v[0:3], v254, s[40:43], s67 offen offset:0 sc1
  v_cvt_pk_bf16_f32 v4, v8, v9
  v_cvt_pk_bf16_f32 v5, v10, v11
  v_cvt_pk_bf16_f32 v6, v12, v13
  v_cvt_pk_bf16_f32 v7, v14, v15
  buffer_store_dwordx4 v[4:7], v254, s[40:43], s67 offen offset:1024 sc1
  v_cvt_pk_bf16_f32 v64, v64, v65
  v_cvt_pk_bf16_f32 v65, v66, v67
  v_cvt_pk_bf16_f32 v66, v68, v69
  v_cvt_pk_bf16_f32 v67, v70, v71
  buffer_store_dwordx4 v[64:67], v254, s[40:43], s67 offen offset:2048 sc1
  v_cvt_pk_bf16_f32 v68, v72, v73
  v_cvt_pk_bf16_f32 v69, v74, v75
  v_cvt_pk_bf16_f32 v70, v76, v77
  v_cvt_pk_bf16_f32 v71, v78, v79
  buffer_store_dwordx4 v[68:71], v254, s[40:43], s67 offen offset:3072 sc1
  s_add_u32 s67, s67, 8192
  v_cvt_pk_bf16_f32 v16, v16, v17
  v_cvt_pk_bf16_f32 v17, v18, v19
  v_cvt_pk_bf16_f32 v18, v20, v21
  v_cvt_pk_bf16_f32 v19, v22, v23
  buffer_store_dwordx4 v[16:19], v254, s[40:43], s67 offen offset:0 sc1
  v_cvt_pk_bf16_f32 v20, v24, v25
  v_cvt_pk_bf16_f32 v21, v26, v27
  v_cvt_pk_bf16_f32 v22, v28, v29
  v_cvt_pk_bf16_f32 v23, v30, v31
  buffer_store_dwordx4 v[20:23], v254, s[40:43], s67 offen offset:1024 sc1
  v_cvt_pk_bf16_f32 v80, v80, v81
  v_cvt_pk_bf16_f32 v81, v82, v83
  v_cvt_pk_bf16_f32 v82, v84, v85
  v_cvt_pk_bf16_f32 v83, v86, v87
  buffer_store_dwordx4 v[80:83], v254, s[40:43], s67 offen offset:2048 sc1
  v_cvt_pk_bf16_f32 v84, v88, v89
  v_cvt_pk_bf16_f32 v85, v90, v91
  v_cvt_pk_bf16_f32 v86, v92, v93
  v_cvt_pk_bf16_f32 v87, v94, v95
  buffer_store_dwordx4 v[84:87], v254, s[40:43], s67 offen offset:3072 sc1
  s_add_u32 s67, s67, 8192
  v_cvt_pk_bf16_f32 v32, v32, v33
  v_cvt_pk_bf16_f32 v33, v34, v35
  v_cvt_pk_bf16_f32 v34, v36, v37
  v_cvt_pk_bf16_f32 v35, v38, v39
  buffer_store_dwordx4 v[32:35], v254, s[40:43], s67 offen offset:0 sc1
  v_cvt_pk_bf16_f32 v36, v40, v41
  v_cvt_pk_bf16_f32 v37, v42, v43
  v_cvt_pk_bf16_f32 v38, v44, v45
  v_cvt_pk_bf16_f32 v39, v46, v47
  buffer_store_dwordx4 v[36:39], v254, s[40:43], s67 offen offset:1024 sc1
  v_cvt_pk_bf16_f32 v96, v96, v97
  v_cvt_pk_bf16_f32 v97, v98, v99
  v_cvt_pk_bf16_f32 v98, v100, v101
  v_cvt_pk_bf16_f32 v99, v102, v103
  buffer_store_dwordx4 v[96:99], v254, s[40:43], s67 offen offset:2048 sc1
  v_cvt_pk_bf16_f32 v100, v104, v105
  v_cvt_pk_bf16_f32 v101, v106, v107
  v_cvt_pk_bf16_f32 v102, v108, v109
  v_cvt_pk_bf16_f32 v103, v110, v111
  buffer_store_dwordx4 v[100:103], v254, s[40:43], s67 offen offset:3072 sc1
  s_add_u32 s67, s67, 8192
  v_cvt_pk_bf16_f32 v48, v48, v49
  v_cvt_pk_bf16_f32 v49, v50, v51
  v_cvt_pk_bf16_f32 v50, v52, v53
  v_cvt_pk_bf16_f32 v51, v54, v55
  buffer_store_dwordx4 v[48:51], v254, s[40:43], s67 offen offset:0 sc1
  v_cvt_pk_bf16_f32 v52, v56, v57
  v_cvt_pk_bf16_f32 v53, v58, v59
  v_cvt_pk_bf16_f32 v54, v60, v61
  v_cvt_pk_bf16_f32 v55, v62, v63
  buffer_store_dwordx4 v[52:55], v254, s[40:43], s67 offen offset:1024 sc1
  v_cvt_pk_bf16_f32 v112, v112, v113
  v_cvt_pk_bf16_f32 v113, v114, v115
  v_cvt_pk_bf16_f32 v114, v116, v117
  v_cvt_pk_bf16_f32 v115, v118, v119
  buffer_store_dwordx4 v[112:115], v254, s[40:43], s67 offen offset:2048 sc1
  v_cvt_pk_bf16_f32 v116, v120, v121
  v_cvt_pk_bf16_f32 v117, v122, v123
  v_cvt_pk_bf16_f32 v118, v124, v125
  v_cvt_pk_bf16_f32 v119, v126, v127
  buffer_store_dwordx4 v[116:119], v254, s[40:43], s67 offen offset:3072 sc1
  s_waitcnt lgkmcnt(0)
  s_sub_u32 s60, 15, s31
  s_cmp_lg_u32 s57, 0
  s_cselect_b32 s64, s60, s31
  s_mov_b32 s46, 0x200000
  s_mov_b32 s48, s8
  s_mov_b32 s49, s9
  s_mov_b32 s50, 0x400000
  s_mov_b32 s51, 0x00020000
  s_and_b32 s83, s31, 1
  s_lshl_b32 s83, s83, 15
  s_lshl_b32 s84, s30, 8
  s_lshl_b32 s85, s64, 2
  s_add_u32 s85, s85, s56
  s_lshl_b32 s85, s85, 15
  v_add_u32 v227, s85, v254
  s_and_b32 s85, s31, 0
  s_lshl_b32 s60, s85, 20
  s_add_u32 s84, s84, s60
  s_lshl_b32 s85, s85, 13
  s_waitcnt vmcnt(0)
  s_barrier
  s_cmp_lg_u32 s3, 0
  s_cbranch_scc1 .Lsig_kv0
  s_lshl_b32 s88, s79, 7
  v_mov_b32 v234, s88
  s_mov_b64 exec, 1
  global_atomic_add v234, v253, s[16:17]
  s_mov_b64 exec, -1
.Lsig_kv0:
  s_add_u32 m0, s66, 0x18000
  s_nop 0
  buffer_load_dwordx4 v244, s[48:51], s84 offen offset:0 lds
  buffer_load_dwordx4 v245, s[48:51], s84 offen offset:1024 lds
  buffer_load_dwordx4 v246, s[48:51], s84 offen offset:2048 lds
  buffer_load_dwordx4 v247, s[48:51], s84 offen offset:3072 lds
  s_add_u32 s84, s84, 0x100000
  s_and_b32 s84, s84, 0x3fffff
  buffer_load_dwordx4 v[0:3], v227, s[44:47], s85 offen offset:0 sc1
  buffer_load_dwordx4 v[4:7], v227, s[44:47], s85 offen offset:1024 sc1
  buffer_load_dwordx4 v[8:11], v227, s[44:47], s85 offen offset:2048 sc1
  buffer_load_dwordx4 v[12:15], v227, s[44:47], s85 offen offset:3072 sc1
  s_add_u32 s85, s85, 4096
  s_and_b32 s85, s85, 0x7fff
  buffer_load_dwordx4 v[16:19], v227, s[44:47], s85 offen offset:0 sc1
  buffer_load_dwordx4 v[20:23], v227, s[44:47], s85 offen offset:1024 sc1
  buffer_load_dwordx4 v[24:27], v227, s[44:47], s85 offen offset:2048 sc1
  buffer_load_dwordx4 v[28:31], v227, s[44:47], s85 offen offset:3072 sc1
  s_add_u32 s85, s85, 4096
  s_and_b32 s85, s85, 0x7fff
  s_add_u32 m0, s66, 0x10000
  s_nop 0
  buffer_load_dwordx4 v244, s[48:51], s84 offen offset:0 lds
  buffer_load_dwordx4 v245, s[48:51], s84 offen offset:1024 lds
  buffer_load_dwordx4 v246, s[48:51], s84 offen offset:2048 lds
  buffer_load_dwordx4 v247, s[48:51], s84 offen offset:3072 lds
  s_add_u32 s84, s84, 0x100000
  s_and_b32 s84, s84, 0x3fffff
  buffer_load_dwordx4 v[32:35], v227, s[44:47], s85 offen offset:0 sc1
  buffer_load_dwordx4 v[36:39], v227, s[44:47], s85 offen offset:1024 sc1
  buffer_load_dwordx4 v[40:43], v227, s[44:47], s85 offen offset:2048 sc1
  buffer_load_dwordx4 v[44:47], v227, s[44:47], s85 offen offset:3072 sc1
  s_add_u32 s85, s85, 4096
  s_and_b32 s85, s85, 0x7fff
  buffer_load_dwordx4 v[48:51], v227, s[44:47], s85 offen offset:0 sc1
  buffer_load_dwordx4 v[52:55], v227, s[44:47], s85 offen offset:1024 sc1
  buffer_load_dwordx4 v[56:59], v227, s[44:47], s85 offen offset:2048 sc1
  buffer_load_dwordx4 v[60:63], v227, s[44:47], s85 offen offset:3072 sc1
  s_add_u32 s85, s85, 4096
  s_and_b32 s85, s85, 0x7fff
  s_waitcnt vmcnt(12)
  s_barrier
  ds_read_b64_tr_b16 v[128:129], v240 offset:32768
  ds_read_b64_tr_b16 v[130:131], v240 offset:33792
  ds_read_b64_tr_b16 v[132:133], v241 offset:32768
  ds_read_b64_tr_b16 v[134:135], v241 offset:33792
  ds_read_b64_tr_b16 v[136:137], v242 offset:32768
  ds_read_b64_tr_b16 v[138:139], v242 offset:33792
  ds_read_b64_tr_b16 v[140:141], v243 offset:32768
  ds_read_b64_tr_b16 v[142:143], v243 offset:33792
  s_branch .Lq
.Lp2:
  s_waitcnt lgkmcnt(3)
  v_mfma_f32_32x32x16_bf16 v[160:175], v[136:139], v[128:131], 0
  ds_read_b64_tr_b16 v[152:153], v230 offset:4096
  ds_read_b64_tr_b16 v[154:155], v230 offset:5120
  s_waitcnt lgkmcnt(3)
  v_mfma_f32_32x32x16_bf16 v[192:207], v[140:143], v[128:131], 0
  ds_read_b128 v[144:147], v229 offset:1024
  ds_read_b64_tr_b16 v[156:157], v232 offset:4096
  s_waitcnt lgkmcnt(4)
  v_mfma_f32_32x32x16_bf16 v[176:191], v[136:139], v[132:135], 0
  ds_read_b64_tr_b16 v[158:159], v232 offset:5120
  ds_read_b128 v[148:151], v229 offset:5120
  v_mfma_f32_32x32x16_bf16 v[208:223], v[140:143], v[132:135], 0
  s_waitcnt lgkmcnt(3)
  v_mfma_f32_32x32x16_bf16 v[160:175], v[152:155], v[144:147], v[160:175]
  ds_read_b64_tr_b16 v[136:137], v230 offset:8192
  ds_read_b64_tr_b16 v[138:139], v230 offset:9216
  v_cvt_pk_bf16_f32 v0, v0, v1
  v_cvt_pk_bf16_f32 v1, v2, v3
  s_waitcnt lgkmcnt(3)
  v_mfma_f32_32x32x16_bf16 v[192:207], v[156:159], v[144:147], v[192:207]
  ds_read_b128 v[128:131], v229 offset:2048
  ds_read_b64_tr_b16 v[140:141], v232 offset:8192
  v_cvt_pk_bf16_f32 v2, v4, v5
  v_cvt_pk_bf16_f32 v3, v6, v7
  s_waitcnt lgkmcnt(4)
  v_mfma_f32_32x32x16_bf16 v[176:191], v[152:155], v[148:151], v[176:191]
  ds_read_b64_tr_b16 v[142:143], v232 offset:9216
  ds_read_b128 v[132:135], v229 offset:6144
  buffer_store_dwordx4 v[0:3], v254, s[40:43], s67 offen offset:0 sc1
  v_mfma_f32_32x32x16_bf16 v[208:223], v[156:159], v[148:151], v[208:223]
  s_waitcnt lgkmcnt(3)
  v_mfma_f32_32x32x16_bf16 v[160:175], v[136:139], v[128:131], v[160:175]
  ds_read_b64_tr_b16 v[152:153], v230 offset:12288
  ds_read_b64_tr_b16 v[154:155], v230 offset:13312
  v_cvt_pk_bf16_f32 v4, v8, v9
  v_cvt_pk_bf16_f32 v5, v10, v11
  s_waitcnt lgkmcnt(3)
  v_mfma_f32_32x32x16_bf16 v[192:207], v[140:143], v[128:131], v[192:207]
  ds_read_b128 v[144:147], v229 offset:3072
  ds_read_b64_tr_b16 v[156:157], v232 offset:12288
  v_cvt_pk_bf16_f32 v6, v12, v13
  v_cvt_pk_bf16_f32 v7, v14, v15
  s_waitcnt lgkmcnt(4)
  v_mfma_f32_32x32x16_bf16 v[176:191], v[136:139], v[132:135], v[176:191]
  ds_read_b64_tr_b16 v[158:159], v232 offset:13312
  ds_read_b128 v[148:151], v229 offset:7168
  buffer_store_dwordx4 v[4:7], v254, s[40:43], s67 offen offset:1024 sc1
  s_add_u32 s67, s67, 8192
  v_mfma_f32_32x32x16_bf16 v[208:223], v[140:143], v[132:135], v[208:223]
  s_waitcnt vmcnt(8) lgkmcnt(0)
  v_mfma_f32_32x32x16_bf16 v[160:175], v[152:155], v[144:147], v[160:175]
  s_barrier
  ds_read_b64_tr_b16 v[136:137], v231 offset:0
  ds_read_b64_tr_b16 v[138:139], v231 offset:1024
  ds_read_b128 v[128:131], v229 offset:16384
  v_mfma_f32_32x32x16_bf16 v[192:207], v[156:159], v[144:147], v[192:207]
  ds_read_b64_tr_b16 v[140:141], v233 offset:0
  ds_read_b64_tr_b16 v[142:143], v233 offset:1024
  ds_read_b128 v[132:135], v229 offset:20480
  s_add_u32 m0, s73, 0x0
  s_nop 0
  buffer_load_dwordx4 v224, s[44:47], s69 offen offset:0 sc1 lds
  v_mfma_f32_32x32x16_bf16 v[176:191], v[152:155], v[148:151], v[176:191]
  buffer_load_dwordx4 v224, s[44:47], s69 offen offset:1024 sc1 lds
  s_add_u32 m0, s66, 0x10000
  s_nop 0
  buffer_load_dwordx4 v225, s[48:51], s70 offen offset:0 lds
  v_mfma_f32_32x32x16_bf16 v[208:223], v[156:159], v[148:151], v[208:223]
  buffer_load_dwordx4 v226, s[48:51], s70 offen offset:1024 lds
  s_waitcnt lgkmcnt(3)
  v_mfma_f32_32x32x16_bf16 v[160:175], v[136:139], v[128:131], v[160:175]
  ds_read_b64_tr_b16 v[152:153], v231 offset:4096
  ds_read_b64_tr_b16 v[154:155], v231 offset:5120
  s_waitcnt lgkmcnt(3)
  v_mfma_f32_32x32x16_bf16 v[192:207], v[140:143], v[128:131], v[192:207]
  ds_read_b128 v[144:147], v229 offset:17408
  ds_read_b64_tr_b16 v[156:157], v233 offset:4096
  buffer_load_dwordx4 v227, s[48:51], s70 offen offset:2048 lds
  s_waitcnt lgkmcnt(4)
  v_mfma_f32_32x32x16_bf16 v[176:191], v[136:139], v[132:135], v[176:191]
  ds_read_b64_tr_b16 v[158:159], v233 offset:5120
  ds_read_b128 v[148:151], v229 offset:21504
  v_mfma_f32_32x32x16_bf16 v[208:223], v[140:143], v[132:135], v[208:223]
  buffer_load_dwordx4 v228, s[48:51], s70 offen offset:3072 lds
  s_add_u32 s69, s69, 4096
  s_and_b32 s69, s69, 0x7fff
  s_add_u32 s70, s70, 229376
  s_cmp_ge_u32 s70, 1835008
  s_cselect_b32 s70, 0, s70
  s_waitcnt lgkmcnt(3)
  v_mfma_f32_32x32x16_bf16 v[160:175], v[152:155], v[144:147], v[160:175]
  ds_read_b64_tr_b16 v[136:137], v231 offset:8192
  ds_read_b64_tr_b16 v[138:139], v231 offset:9216
  v_cvt_pk_bf16_f32 v16, v16, v17
  v_cvt_pk_bf16_f32 v17, v18, v19
  s_waitcnt lgkmcnt(3)
  v_mfma_f32_32x32x16_bf16 v[192:207], v[156:159], v[144:147], v[192:207]
  ds_read_b128 v[128:131], v229 offset:18432
  ds_read_b64_tr_b16 v[140:141], v233 offset:8192
  v_cvt_pk_bf16_f32 v18, v20, v21
  v_cvt_pk_bf16_f32 v19, v22, v23
  s_waitcnt lgkmcnt(4)
  v_mfma_f32_32x32x16_bf16 v[176:191], v[152:155], v[148:151], v[176:191]
  ds_read_b64_tr_b16 v[142:143], v233 offset:9216
  ds_read_b128 v[132:135], v229 offset:22528
  buffer_store_dwordx4 v[16:19], v254, s[40:43], s67 offen offset:0 sc1
  v_mfma_f32_32x32x16_bf16 v[208:223], v[156:159], v[148:151], v[208:223]
  s_waitcnt lgkmcnt(3)
  v_mfma_f32_32x32x16_bf16 v[160:175], v[136:139], v[128:131], v[160:175]
  ds_read_b64_tr_b16 v[152:153], v231 offset:12288
  ds_read_b64_tr_b16 v[154:155], v231 offset:13312
  v_cvt_pk_bf16_f32 v20, v24, v25
  v_cvt_pk_bf16_f32 v21, v26, v27
  s_waitcnt lgkmcnt(3)
  v_mfma_f32_32x32x16_bf16 v[192:207], v[140:143], v[128:131], v[192:207]
  ds_read_b128 v[144:147], v229 offset:19456
  ds_read_b64_tr_b16 v[156:157], v233 offset:12288
  v_cvt_pk_bf16_f32 v22, v28, v29
  v_cvt_pk_bf16_f32 v23, v30, v31
  s_waitcnt lgkmcnt(4)
  v_mfma_f32_32x32x16_bf16 v[176:191], v[136:139], v[132:135], v[176:191]
  ds_read_b64_tr_b16 v[158:159], v233 offset:13312
  ds_read_b128 v[148:151], v229 offset:23552
  buffer_store_dwordx4 v[20:23], v254, s[40:43], s67 offen offset:1024 sc1
  s_add_u32 s67, s67, 8192
  v_mfma_f32_32x32x16_bf16 v[208:223], v[140:143], v[132:135], v[208:223]
  s_waitcnt vmcnt(10) lgkmcnt(0)
  v_mfma_f32_32x32x16_bf16 v[160:175], v[152:155], v[144:147], v[160:175]
  s_barrier
  ds_read_b64_tr_b16 v[136:137], v230 offset:32768
  ds_read_b64_tr_b16 v[138:139], v230 offset:33792
  ds_read_b128 v[128:131], v229 offset:32768
  v_mfma_f32_32x32x16_bf16 v[192:207], v[156:159], v[144:147], v[192:207]
  ds_read_b64_tr_b16 v[140:141], v232 offset:32768
  ds_read_b64_tr_b16 v[142:143], v232 offset:33792
  ds_read_b128 v[132:135], v229 offset:36864
  s_add_u32 m0, s73, 0x4000
  s_nop 0
  buffer_load_dwordx4 v224, s[44:47], s69 offen offset:0 sc1 lds
  v_mfma_f32_32x32x16_bf16 v[176:191], v[152:155], v[148:151], v[176:191]
  buffer_load_dwordx4 v224, s[44:47], s69 offen offset:1024 sc1 lds
  s_add_u32 m0, s66, 0x20000
  s_nop 0
  buffer_load_dwordx4 v225, s[48:51], s70 offen offset:0 lds
  v_mfma_f32_32x32x16_bf16 v[208:223], v[156:159], v[148:151], v[208:223]
  buffer_load_dwordx4 v226, s[48:51], s70 offen offset:1024 lds
  s_waitcnt lgkmcnt(3)
  v_mfma_f32_32x32x16_bf16 v[160:175], v[136:139], v[128:131], v[160:175]
  ds_read_b64_tr_b16 v[152:153], v230 offset:36864
  ds_read_b64_tr_b16 v[154:155], v230 offset:37888
  s_waitcnt lgkmcnt(3)
  v_mfma_f32_32x32x16_bf16 v[192:207], v[140:143], v[128:131], v[192:207]
  ds_read_b128 v[144:147], v229 offset:33792
  ds_read_b64_tr_b16 v[156:157], v232 offset:36864
  buffer_load_dwordx4 v227, s[48:51], s70 offen offset:2048 lds
  s_waitcnt lgkmcnt(4)
  v_mfma_f32_32x32x16_bf16 v[176:191], v[136:139], v[132:135], v[176:191]
  ds_read_b64_tr_b16 v[158:159], v232 offset:37888
  ds_read_b128 v[148:151], v229 offset:37888
  v_mfma_f32_32x32x16_bf16 v[208:223], v[140:143], v[132:135], v[208:223]
  buffer_load_dwordx4 v228, s[48:51], s70 offen offset:3072 lds
  s_add_u32 s69, s69, 4096
  s_and_b32 s69, s69, 0x7fff
  s_add_u32 s70, s70, 229376
  s_cmp_ge_u32 s70, 1835008
  s_cselect_b32 s70, 0, s70
  s_waitcnt lgkmcnt(3)
  v_mfma_f32_32x32x16_bf16 v[160:175], v[152:155], v[144:147], v[160:175]
  ds_read_b64_tr_b16 v[136:137], v230 offset:40960
  ds_read_b64_tr_b16 v[138:139], v230 offset:41984
  v_cvt_pk_bf16_f32 v32, v32, v33
  v_cvt_pk_bf16_f32 v33, v34, v35
  s_waitcnt lgkmcnt(3)
  v_mfma_f32_32x32x16_bf16 v[192:207], v[156:159], v[144:147], v[192:207]
  ds_read_b128 v[128:131], v229 offset:34816
  ds_read_b64_tr_b16 v[140:141], v232 offset:40960
  v_cvt_pk_bf16_f32 v34, v36, v37
  v_cvt_pk_bf16_f32 v35, v38, v39
  s_waitcnt lgkmcnt(4)
  v_mfma_f32_32x32x16_bf16 v[176:191], v[152:155], v[148:151], v[176:191]
  ds_read_b64_tr_b16 v[142:143], v232 offset:41984
  ds_read_b128 v[132:135], v229 offset:38912
  buffer_store_dwordx4 v[32:35], v254, s[40:43], s67 offen offset:0 sc1
  v_mfma_f32_32x32x16_bf16 v[208:223], v[156:159], v[148:151], v[208:223]
  s_waitcnt lgkmcnt(3)
  v_mfma_f32_32x32x16_bf16 v[160:175], v[136:139], v[128:131], v[160:175]
  ds_read_b64_tr_b16 v[152:153], v230 offset:45056
  ds_read_b64_tr_b16 v[154:155], v230 offset:46080
  v_cvt_pk_bf16_f32 v36, v40, v41
  v_cvt_pk_bf16_f32 v37, v42, v43
  s_waitcnt lgkmcnt(3)
  v_mfma_f32_32x32x16_bf16 v[192:207], v[140:143], v[128:131], v[192:207]
  ds_read_b128 v[144:147], v229 offset:35840
  ds_read_b64_tr_b16 v[156:157], v232 offset:45056
  v_cvt_pk_bf16_f32 v38, v44, v45
  v_cvt_pk_bf16_f32 v39, v46, v47
  s_waitcnt lgkmcnt(4)
  v_mfma_f32_32x32x16_bf16 v[176:191], v[136:139], v[132:135], v[176:191]
  ds_read_b64_tr_b16 v[158:159], v232 offset:46080
  ds_read_b128 v[148:151], v229 offset:39936
  buffer_store_dwordx4 v[36:39], v254, s[40:43], s67 offen offset:1024 sc1
  s_add_u32 s67, s67, 8192
  v_mfma_f32_32x32x16_bf16 v[208:223], v[140:143], v[132:135], v[208:223]
  s_waitcnt vmcnt(10) lgkmcnt(0)
  v_mfma_f32_32x32x16_bf16 v[160:175], v[152:155], v[144:147], v[160:175]
  s_barrier
  ds_read_b64_tr_b16 v[136:137], v230 offset:0
  ds_read_b64_tr_b16 v[138:139], v230 offset:1024
  ds_read_b128 v[128:131], v229 offset:0
  v_mfma_f32_32x32x16_bf16 v[192:207], v[156:159], v[144:147], v[192:207]
  ds_read_b64_tr_b16 v[140:141], v232 offset:0
  ds_read_b64_tr_b16 v[142:143], v232 offset:1024
  ds_read_b128 v[132:135], v229 offset:4096
  s_add_u32 m0, s73, 0x8000
  s_nop 0
  buffer_load_dwordx4 v224, s[44:47], s69 offen offset:0 sc1 lds
  v_mfma_f32_32x32x16_bf16 v[176:191], v[152:155], v[148:151], v[176:191]
  buffer_load_dwordx4 v224, s[44:47], s69 offen offset:1024 sc1 lds
  s_add_u32 m0, s66, 0x18000
  s_nop 0
  buffer_load_dwordx4 v225, s[48:51], s70 offen offset:0 lds
  v_mfma_f32_32x32x16_bf16 v[208:223], v[156:159], v[148:151], v[208:223]
  buffer_load_dwordx4 v226, s[48:51], s70 offen offset:1024 lds
  s_waitcnt lgkmcnt(3)
  v_mfma_f32_32x32x16_bf16 v[160:175], v[136:139], v[128:131], v[160:175]
  ds_read_b64_tr_b16 v[152:153], v230 offset:4096
  ds_read_b64_tr_b16 v[154:155], v230 offset:5120
  s_waitcnt lgkmcnt(3)
  v_mfma_f32_32x32x16_bf16 v[192:207], v[140:143], v[128:131], v[192:207]
  ds_read_b128 v[144:147], v229 offset:1024
  ds_read_b64_tr_b16 v[156:157], v232 offset:4096
  buffer_load_dwordx4 v227, s[48:51], s70 offen offset:2048 lds
  s_waitcnt lgkmcnt(4)
  v_mfma_f32_32x32x16_bf16 v[176:191], v[136:139], v[132:135], v[176:191]
  ds_read_b64_tr_b16 v[158:159], v232 offset:5120
  ds_read_b128 v[148:151], v229 offset:5120
  v_mfma_f32_32x32x16_bf16 v[208:223], v[140:143], v[132:135], v[208:223]
  buffer_load_dwordx4 v228, s[48:51], s70 offen offset:3072 lds
  s_add_u32 s69, s69, 4096
  s_and_b32 s69, s69, 0x7fff
  s_add_u32 s70, s70, 229376
  s_cmp_ge_u32 s70, 1835008
  s_cselect_b32 s70, 0, s70
  s_waitcnt lgkmcnt(3)
  v_mfma_f32_32x32x16_bf16 v[160:175], v[152:155], v[144:147], v[160:175]
  ds_read_b64_tr_b16 v[136:137], v230 offset:8192
  ds_read_b64_tr_b16 v[138:139], v230 offset:9216
  v_cvt_pk_bf16_f32 v48, v48, v49
  v_cvt_pk_bf16_f32 v49, v50, v51
  s_waitcnt lgkmcnt(3)
  v_mfma_f32_32x32x16_bf16 v[192:207], v[156:159], v[144:147], v[192:207]
  ds_read_b128 v[128:131], v229 offset:2048
  ds_read_b64_tr_b16 v[140:141], v232 offset:8192
  v_cvt_pk_bf16_f32 v50, v52, v53
  v_cvt_pk_bf16_f32 v51, v54, v55
  s_waitcnt lgkmcnt(4)
  v_mfma_f32_32x32x16_bf16 v[176:191], v[152:155], v[148:151], v[176:191]
  ds_read_b64_tr_b16 v[142:143], v232 offset:9216
  ds_read_b128 v[132:135], v229 offset:6144
  buffer_store_dwordx4 v[48:51], v254, s[40:43], s67 offen offset:0 sc1
  v_mfma_f32_32x32x16_bf16 v[208:223], v[156:159], v[148:151], v[208:223]
  s_waitcnt lgkmcnt(3)
  v_mfma_f32_32x32x16_bf16 v[160:175], v[136:139], v[128:131], v[160:175]
  ds_read_b64_tr_b16 v[152:153], v230 offset:12288
  ds_read_b64_tr_b16 v[154:155], v230 offset:13312
  v_cvt_pk_bf16_f32 v52, v56, v57
  v_cvt_pk_bf16_f32 v53, v58, v59
  s_waitcnt lgkmcnt(3)
  v_mfma_f32_32x32x16_bf16 v[192:207], v[140:143], v[128:131], v[192:207]
  ds_read_b128 v[144:147], v229 offset:3072
  ds_read_b64_tr_b16 v[156:157], v232 offset:12288
  v_cvt_pk_bf16_f32 v54, v60, v61
  v_cvt_pk_bf16_f32 v55, v62, v63
  s_waitcnt lgkmcnt(4)
  v_mfma_f32_32x32x16_bf16 v[176:191], v[136:139], v[132:135], v[176:191]
  ds_read_b64_tr_b16 v[158:159], v232 offset:13312
  ds_read_b128 v[148:151], v229 offset:7168
  buffer_store_dwordx4 v[52:55], v254, s[40:43], s67 offen offset:1024 sc1
  s_sub_u32 s67, s67, 24576
  v_mfma_f32_32x32x16_bf16 v[208:223], v[140:143], v[132:135], v[208:223]
  s_waitcnt vmcnt(10) lgkmcnt(0)
  v_mfma_f32_32x32x16_bf16 v[160:175], v[152:155], v[144:147], v[160:175]
  s_barrier
  ds_read_b64_tr_b16 v[136:137], v231 offset:0
  ds_read_b64_tr_b16 v[138:139], v231 offset:1024
  ds_read_b128 v[128:131], v229 offset:16384
  v_mfma_f32_32x32x16_bf16 v[192:207], v[156:159], v[144:147], v[192:207]
  ds_read_b64_tr_b16 v[140:141], v233 offset:0
  ds_read_b64_tr_b16 v[142:143], v233 offset:1024
  ds_read_b128 v[132:135], v229 offset:20480
  s_add_u32 m0, s73, 0x0
  s_nop 0
  buffer_load_dwordx4 v224, s[44:47], s69 offen offset:0 sc1 lds
  v_mfma_f32_32x32x16_bf16 v[176:191], v[152:155], v[148:151], v[176:191]
  buffer_load_dwordx4 v224, s[44:47], s69 offen offset:1024 sc1 lds
  s_add_u32 m0, s66, 0x10000
  s_nop 0
  buffer_load_dwordx4 v225, s[48:51], s70 offen offset:0 lds
  v_mfma_f32_32x32x16_bf16 v[208:223], v[156:159], v[148:151], v[208:223]
  buffer_load_dwordx4 v226, s[48:51], s70 offen offset:1024 lds
  s_waitcnt lgkmcnt(3)
  v_mfma_f32_32x32x16_bf16 v[160:175], v[136:139], v[128:131], v[160:175]
  ds_read_b64_tr_b16 v[152:153], v231 offset:4096
  ds_read_b64_tr_b16 v[154:155], v231 offset:5120
  s_waitcnt lgkmcnt(3)
  v_mfma_f32_32x32x16_bf16 v[192:207], v[140:143], v[128:131], v[192:207]
  ds_read_b128 v[144:147], v229 offset:17408
  ds_read_b64_tr_b16 v[156:157], v233 offset:4096
  buffer_load_dwordx4 v227, s[48:51], s70 offen offset:2048 lds
  s_waitcnt lgkmcnt(4)
  v_mfma_f32_32x32x16_bf16 v[176:191], v[136:139], v[132:135], v[176:191]
  ds_read_b64_tr_b16 v[158:159], v233 offset:5120
  ds_read_b128 v[148:151], v229 offset:21504
  v_mfma_f32_32x32x16_bf16 v[208:223], v[140:143], v[132:135], v[208:223]
  buffer_load_dwordx4 v228, s[48:51], s70 offen offset:3072 lds
  s_add_u32 s69, s69, 4096
  s_and_b32 s69, s69, 0x7fff
  s_add_u32 s70, s70, 229376
  s_cmp_ge_u32 s70, 1835008
  s_cselect_b32 s70, 0, s70
  s_waitcnt lgkmcnt(3)
  v_mfma_f32_32x32x16_bf16 v[160:175], v[152:155], v[144:147], v[160:175]
  ds_read_b64_tr_b16 v[136:137], v231 offset:8192
  ds_read_b64_tr_b16 v[138:139], v231 offset:9216
  v_cvt_pk_bf16_f32 v64, v64, v65
  v_cvt_pk_bf16_f32 v65, v66, v67
  s_waitcnt lgkmcnt(3)
  v_mfma_f32_32x32x16_bf16 v[192:207], v[156:159], v[144:147], v[192:207]
  ds_read_b128 v[128:131], v229 offset:18432
  ds_read_b64_tr_b16 v[140:141], v233 offset:8192
  v_cvt_pk_bf16_f32 v66, v68, v69
  v_cvt_pk_bf16_f32 v67, v70, v71
  s_waitcnt lgkmcnt(4)
  v_mfma_f32_32x32x16_bf16 v[176:191], v[152:155], v[148:151], v[176:191]
  ds_read_b64_tr_b16 v[142:143], v233 offset:9216
  ds_read_b128 v[132:135], v229 offset:22528
  buffer_store_dwordx4 v[64:67], v254, s[40:43], s67 offen offset:2048 sc1
  v_mfma_f32_32x32x16_bf16 v[208:223], v[156:159], v[148:151], v[208:223]
  s_waitcnt lgkmcnt(3)
  v_mfma_f32_32x32x16_bf16 v[160:175], v[136:139], v[128:131], v[160:175]
  ds_read_b64_tr_b16 v[152:153], v231 offset:12288
  ds_read_b64_tr_b16 v[154:155], v231 offset:13312
  v_cvt_pk_bf16_f32 v68, v72, v73
  v_cvt_pk_bf16_f32 v69, v74, v75
  s_waitcnt lgkmcnt(3)
  v_mfma_f32_32x32x16_bf16 v[192:207], v[140:143], v[128:131], v[192:207]
  ds_read_b128 v[144:147], v229 offset:19456
  ds_read_b64_tr_b16 v[156:157], v233 offset:12288
  v_cvt_pk_bf16_f32 v70, v76, v77
  v_cvt_pk_bf16_f32 v71, v78, v79
  s_waitcnt lgkmcnt(4)
  v_mfma_f32_32x32x16_bf16 v[176:191], v[136:139], v[132:135], v[176:191]
  ds_read_b64_tr_b16 v[158:159], v233 offset:13312
  ds_read_b128 v[148:151], v229 offset:23552
  buffer_store_dwordx4 v[68:71], v254, s[40:43], s67 offen offset:3072 sc1
  s_add_u32 s67, s67, 8192
  v_mfma_f32_32x32x16_bf16 v[208:223], v[140:143], v[132:135], v[208:223]
  s_waitcnt vmcnt(10) lgkmcnt(0)
  v_mfma_f32_32x32x16_bf16 v[160:175], v[152:155], v[144:147], v[160:175]
  s_barrier
  ds_read_b64_tr_b16 v[136:137], v230 offset:32768
  ds_read_b64_tr_b16 v[138:139], v230 offset:33792
  ds_read_b128 v[128:131], v229 offset:32768
  v_mfma_f32_32x32x16_bf16 v[192:207], v[156:159], v[144:147], v[192:207]
  ds_read_b64_tr_b16 v[140:141], v232 offset:32768
  ds_read_b64_tr_b16 v[142:143], v232 offset:33792
  ds_read_b128 v[132:135], v229 offset:36864
  s_add_u32 m0, s73, 0x4000
  s_nop 0
  buffer_load_dwordx4 v224, s[44:47], s69 offen offset:0 sc1 lds
  v_mfma_f32_32x32x16_bf16 v[176:191], v[152:155], v[148:151], v[176:191]
  buffer_load_dwordx4 v224, s[44:47], s69 offen offset:1024 sc1 lds
  s_add_u32 m0, s66, 0x20000
  s_nop 0
  buffer_load_dwordx4 v225, s[48:51], s70 offen offset:0 lds
  v_mfma_f32_32x32x16_bf16 v[208:223], v[156:159], v[148:151], v[208:223]
  buffer_load_dwordx4 v226, s[48:51], s70 offen offset:1024 lds
  s_waitcnt lgkmcnt(3)
  v_mfma_f32_32x32x16_bf16 v[160:175], v[136:139], v[128:131], v[160:175]
  ds_read_b64_tr_b16 v[152:153], v230 offset:36864
  ds_read_b64_tr_b16 v[154:155], v230 offset:37888
  s_waitcnt lgkmcnt(3)
  v_mfma_f32_32x32x16_bf16 v[192:207], v[140:143], v[128:131], v[192:207]
  ds_read_b128 v[144:147], v229 offset:33792
  ds_read_b64_tr_b16 v[156:157], v232 offset:36864
  buffer_load_dwordx4 v227, s[48:51], s70 offen offset:2048 lds
  s_waitcnt lgkmcnt(4)
  v_mfma_f32_32x32x16_bf16 v[176:191], v[136:139], v[132:135], v[176:191]
  ds_read_b64_tr_b16 v[158:159], v232 offset:37888
  ds_read_b128 v[148:151], v229 offset:37888
  v_mfma_f32_32x32x16_bf16 v[208:223], v[140:143], v[132:135], v[208:223]
  buffer_load_dwordx4 v228, s[48:51], s70 offen offset:3072 lds
  s_add_u32 s69, s69, 4096
  s_and_b32 s69, s69, 0x7fff
  s_add_u32 s70, s70, 229376
  s_cmp_ge_u32 s70, 1835008
  s_cselect_b32 s70, 0, s70
  s_waitcnt lgkmcnt(3)
  v_mfma_f32_32x32x16_bf16 v[160:175], v[152:155], v[144:147], v[160:175]
  ds_read_b64_tr_b16 v[136:137], v230 offset:40960
  ds_read_b64_tr_b16 v[138:139], v230 offset:41984
  v_cvt_pk_bf16_f32 v80, v80, v81
  v_cvt_pk_bf16_f32 v81, v82, v83
  s_waitcnt lgkmcnt(3)
  v_mfma_f32_32x32x16_bf16 v[192:207], v[156:159], v[144:147], v[192:207]
  ds_read_b128 v[128:131], v229 offset:34816
  ds_read_b64_tr_b16 v[140:141], v232 offset:40960
  v_cvt_pk_bf16_f32 v82, v84, v85
  v_cvt_pk_bf16_f32 v83, v86, v87
  s_waitcnt lgkmcnt(4)
  v_mfma_f32_32x32x16_bf16 v[176:191], v[152:155], v[148:151], v[176:191]
  ds_read_b64_tr_b16 v[142:143], v232 offset:41984
  ds_read_b128 v[132:135], v229 offset:38912
  buffer_store_dwordx4 v[80:83], v254, s[40:43], s67 offen offset:2048 sc1
  v_mfma_f32_32x32x16_bf16 v[208:223], v[156:159], v[148:151], v[208:223]
  s_waitcnt lgkmcnt(3)
  v_mfma_f32_32x32x16_bf16 v[160:175], v[136:139], v[128:131], v[160:175]
  ds_read_b64_tr_b16 v[152:153], v230 offset:45056
  ds_read_b64_tr_b16 v[154:155], v230 offset:46080
  v_cvt_pk_bf16_f32 v84, v88, v89
  v_cvt_pk_bf16_f32 v85, v90, v91
  s_waitcnt lgkmcnt(3)
  v_mfma_f32_32x32x16_bf16 v[192:207], v[140:143], v[128:131], v[192:207]
  ds_read_b128 v[144:147], v229 offset:35840
  ds_read_b64_tr_b16 v[156:157], v232 offset:45056
  v_cvt_pk_bf16_f32 v86, v92, v93
  v_cvt_pk_bf16_f32 v87, v94, v95
  s_waitcnt lgkmcnt(4)
  v_mfma_f32_32x32x16_bf16 v[176:191], v[136:139], v[132:135], v[176:191]
  ds_read_b64_tr_b16 v[158:159], v232 offset:46080
  ds_read_b128 v[148:151], v229 offset:39936
  buffer_store_dwordx4 v[84:87], v254, s[40:43], s67 offen offset:3072 sc1
  s_add_u32 s67, s67, 8192
  v_mfma_f32_32x32x16_bf16 v[208:223], v[140:143], v[132:135], v[208:223]
  s_sub_u32 s60, 15, s31
  s_cmp_lg_u32 s57, 0
  s_cselect_b32 s64, s60, s31
  s_mov_b32 s46, 0x200000
  s_mov_b32 s48, s8
  s_mov_b32 s49, s9
  s_mov_b32 s50, 0x400000
  s_mov_b32 s51, 0x00020000
  s_and_b32 s83, s31, 1
  s_lshl_b32 s83, s83, 15
  s_lshl_b32 s84, s30, 8
  s_lshl_b32 s85, s64, 2
  s_add_u32 s85, s85, s56
  s_lshl_b32 s85, s85, 15
  v_add_u32 v227, s85, v254
  s_and_b32 s85, s31, 0
  s_lshl_b32 s60, s85, 20
  s_add_u32 s84, s84, s60
  s_lshl_b32 s85, s85, 13
  s_waitcnt vmcnt(8) lgkmcnt(0)
  v_mfma_f32_32x32x16_bf16 v[160:175], v[152:155], v[144:147], v[160:175]
  s_barrier
  ds_read_b64_tr_b16 v[136:137], v230 offset:0
  ds_read_b64_tr_b16 v[138:139], v230 offset:1024
  ds_read_b128 v[128:131], v229 offset:0
  v_mfma_f32_32x32x16_bf16 v[192:207], v[156:159], v[144:147], v[192:207]
  ds_read_b64_tr_b16 v[140:141], v232 offset:0
  ds_read_b64_tr_b16 v[142:143], v232 offset:1024
  ds_read_b128 v[132:135], v229 offset:4096
  v_mfma_f32_32x32x16_bf16 v[176:191], v[152:155], v[148:151], v[176:191]
  s_add_u32 m0, s66, 0x18000
  s_nop 0
  buffer_load_dwordx4 v244, s[48:51], s84 offen offset:0 lds
  buffer_load_dwordx4 v245, s[48:51], s84 offen offset:1024 lds
  v_mfma_f32_32x32x16_bf16 v[208:223], v[156:159], v[148:151], v[208:223]
  buffer_load_dwordx4 v246, s[48:51], s84 offen offset:2048 lds
  buffer_load_dwordx4 v247, s[48:51], s84 offen offset:3072 lds
  s_add_u32 s84, s84, 0x100000
  s_and_b32 s84, s84, 0x3fffff
  s_waitcnt lgkmcnt(3)
  v_mfma_f32_32x32x16_bf16 v[160:175], v[136:139], v[128:131], v[160:175]
  ds_read_b64_tr_b16 v[152:153], v230 offset:4096
  ds_read_b64_tr_b16 v[154:155], v230 offset:5120
  buffer_load_dwordx4 v[0:3], v227, s[44:47], s85 offen offset:0 sc1
  s_waitcnt lgkmcnt(3)
  v_mfma_f32_32x32x16_bf16 v[192:207], v[140:143], v[128:131], v[192:207]
  ds_read_b128 v[144:147], v229 offset:1024
  ds_read_b64_tr_b16 v[156:157], v232 offset:4096
  buffer_load_dwordx4 v[4:7], v227, s[44:47], s85 offen offset:1024 sc1
  s_waitcnt lgkmcnt(4)
  v_mfma_f32_32x32x16_bf16 v[176:191], v[136:139], v[132:135], v[176:191]
  ds_read_b64_tr_b16 v[158:159], v232 offset:5120
  ds_read_b128 v[148:151], v229 offset:5120
  buffer_load_dwordx4 v[8:11], v227, s[44:47], s85 offen offset:2048 sc1
  v_mfma_f32_32x32x16_bf16 v[208:223], v[140:143], v[132:135], v[208:223]
  buffer_load_dwordx4 v[12:15], v227, s[44:47], s85 offen offset:3072 sc1
  s_waitcnt lgkmcnt(3)
  v_mfma_f32_32x32x16_bf16 v[160:175], v[152:155], v[144:147], v[160:175]
  ds_read_b64_tr_b16 v[136:137], v230 offset:8192
  ds_read_b64_tr_b16 v[138:139], v230 offset:9216
  s_add_u32 s85, s85, 4096
  s_and_b32 s85, s85, 0x7fff
  v_cvt_pk_bf16_f32 v96, v96, v97
  v_cvt_pk_bf16_f32 v97, v98, v99
  s_waitcnt lgkmcnt(3)
  v_mfma_f32_32x32x16_bf16 v[192:207], v[156:159], v[144:147], v[192:207]
  ds_read_b128 v[128:131], v229 offset:2048
  ds_read_b64_tr_b16 v[140:141], v232 offset:8192
  buffer_load_dwordx4 v[16:19], v227, s[44:47], s85 offen offset:0 sc1
  v_cvt_pk_bf16_f32 v98, v100, v101
  v_cvt_pk_bf16_f32 v99, v102, v103
  s_waitcnt lgkmcnt(4)
  v_mfma_f32_32x32x16_bf16 v[176:191], v[152:155], v[148:151], v[176:191]
  ds_read_b64_tr_b16 v[142:143], v232 offset:9216
  ds_read_b128 v[132:135], v229 offset:6144
  buffer_load_dwordx4 v[20:23], v227, s[44:47], s85 offen offset:1024 sc1
  buffer_store_dwordx4 v[96:99], v254, s[40:43], s67 offen offset:2048 sc1
  v_mfma_f32_32x32x16_bf16 v[208:223], v[156:159], v[148:151], v[208:223]
  buffer_load_dwordx4 v[24:27], v227, s[44:47], s85 offen offset:2048 sc1
  s_waitcnt lgkmcnt(3)
  v_mfma_f32_32x32x16_bf16 v[160:175], v[136:139], v[128:131], v[160:175]
  ds_read_b64_tr_b16 v[152:153], v230 offset:12288
  ds_read_b64_tr_b16 v[154:155], v230 offset:13312
  buffer_load_dwordx4 v[28:31], v227, s[44:47], s85 offen offset:3072 sc1
  v_cvt_pk_bf16_f32 v100, v104, v105
  v_cvt_pk_bf16_f32 v101, v106, v107
  s_waitcnt lgkmcnt(3)
  v_mfma_f32_32x32x16_bf16 v[192:207], v[140:143], v[128:131], v[192:207]
  ds_read_b128 v[144:147], v229 offset:3072
  ds_read_b64_tr_b16 v[156:157], v232 offset:12288
  s_add_u32 s85, s85, 4096
  s_and_b32 s85, s85, 0x7fff
  v_cvt_pk_bf16_f32 v102, v108, v109
  v_cvt_pk_bf16_f32 v103, v110, v111
  s_waitcnt lgkmcnt(4)
  v_mfma_f32_32x32x16_bf16 v[176:191], v[136:139], v[132:135], v[176:191]
  ds_read_b64_tr_b16 v[158:159], v232 offset:13312
  ds_read_b128 v[148:151], v229 offset:7168
  buffer_store_dwordx4 v[100:103], v254, s[40:43], s67 offen offset:3072 sc1
  s_add_u32 s67, s67, 8192
  v_mfma_f32_32x32x16_bf16 v[208:223], v[140:143], v[132:135], v[208:223]
  s_waitcnt vmcnt(12) lgkmcnt(0)
  v_mfma_f32_32x32x16_bf16 v[160:175], v[152:155], v[144:147], v[160:175]
  s_barrier
  ds_read_b64_tr_b16 v[136:137], v231 offset:0
  ds_read_b64_tr_b16 v[138:139], v231 offset:1024
  ds_read_b128 v[128:131], v229 offset:16384
  v_mfma_f32_32x32x16_bf16 v[192:207], v[156:159], v[144:147], v[192:207]
  ds_read_b64_tr_b16 v[140:141], v233 offset:0
  ds_read_b64_tr_b16 v[142:143], v233 offset:1024
  ds_read_b128 v[132:135], v229 offset:20480
  v_mfma_f32_32x32x16_bf16 v[176:191], v[152:155], v[148:151], v[176:191]
  s_add_u32 m0, s66, 0x10000
  s_nop 0
  buffer_load_dwordx4 v244, s[48:51], s84 offen offset:0 lds
  buffer_load_dwordx4 v245, s[48:51], s84 offen offset:1024 lds
  v_mfma_f32_32x32x16_bf16 v[208:223], v[156:159], v[148:151], v[208:223]
  buffer_load_dwordx4 v246, s[48:51], s84 offen offset:2048 lds
  buffer_load_dwordx4 v247, s[48:51], s84 offen offset:3072 lds
  s_add_u32 s84, s84, 0x100000
  s_and_b32 s84, s84, 0x3fffff
  s_waitcnt lgkmcnt(3)
  v_mfma_f32_32x32x16_bf16 v[160:175], v[136:139], v[128:131], v[160:175]
  ds_read_b64_tr_b16 v[152:153], v231 offset:4096
  ds_read_b64_tr_b16 v[154:155], v231 offset:5120
  buffer_load_dwordx4 v[32:35], v227, s[44:47], s85 offen offset:0 sc1
  s_waitcnt lgkmcnt(3)
  v_mfma_f32_32x32x16_bf16 v[192:207], v[140:143], v[128:131], v[192:207]
  ds_read_b128 v[144:147], v229 offset:17408
  ds_read_b64_tr_b16 v[156:157], v233 offset:4096
  buffer_load_dwordx4 v[36:39], v227, s[44:47], s85 offen offset:1024 sc1
  s_waitcnt lgkmcnt(4)
  v_mfma_f32_32x32x16_bf16 v[176:191], v[136:139], v[132:135], v[176:191]
  ds_read_b64_tr_b16 v[158:159], v233 offset:5120
  ds_read_b128 v[148:151], v229 offset:21504
  buffer_load_dwordx4 v[40:43], v227, s[44:47], s85 offen offset:2048 sc1
  v_mfma_f32_32x32x16_bf16 v[208:223], v[140:143], v[132:135], v[208:223]
  buffer_load_dwordx4 v[44:47], v227, s[44:47], s85 offen offset:3072 sc1
  s_waitcnt lgkmcnt(3)
  v_mfma_f32_32x32x16_bf16 v[160:175], v[152:155], v[144:147], v[160:175]
  ds_read_b64_tr_b16 v[136:137], v231 offset:8192
  ds_read_b64_tr_b16 v[138:139], v231 offset:9216
  s_add_u32 s85, s85, 4096
  s_and_b32 s85, s85, 0x7fff
  v_cvt_pk_bf16_f32 v112, v112, v113
  v_cvt_pk_bf16_f32 v113, v114, v115
  s_waitcnt lgkmcnt(3)
  v_mfma_f32_32x32x16_bf16 v[192:207], v[156:159], v[144:147], v[192:207]
  ds_read_b128 v[128:131], v229 offset:18432
  ds_read_b64_tr_b16 v[140:141], v233 offset:8192
  buffer_load_dwordx4 v[48:51], v227, s[44:47], s85 offen offset:0 sc1
  v_cvt_pk_bf16_f32 v114, v116, v117
  v_cvt_pk_bf16_f32 v115, v118, v119
  s_waitcnt lgkmcnt(4)
  v_mfma_f32_32x32x16_bf16 v[176:191], v[152:155], v[148:151], v[176:191]
  ds_read_b64_tr_b16 v[142:143], v233 offset:9216
  ds_read_b128 v[132:135], v229 offset:22528
  buffer_load_dwordx4 v[52:55], v227, s[44:47], s85 offen offset:1024 sc1
  buffer_store_dwordx4 v[112:115], v254, s[40:43], s67 offen offset:2048 sc1
  v_mfma_f32_32x32x16_bf16 v[208:223], v[156:159], v[148:151], v[208:223]
  buffer_load_dwordx4 v[56:59], v227, s[44:47], s85 offen offset:2048 sc1
  s_waitcnt lgkmcnt(3)
  v_mfma_f32_32x32x16_bf16 v[160:175], v[136:139], v[128:131], v[160:175]
  ds_read_b64_tr_b16 v[152:153], v231 offset:12288
  ds_read_b64_tr_b16 v[154:155], v231 offset:13312
  buffer_load_dwordx4 v[60:63], v227, s[44:47], s85 offen offset:3072 sc1
  v_cvt_pk_bf16_f32 v116, v120, v121
  v_cvt_pk_bf16_f32 v117, v122, v123
  s_waitcnt lgkmcnt(3)
  v_mfma_f32_32x32x16_bf16 v[192:207], v[140:143], v[128:131], v[192:207]
  ds_read_b128 v[144:147], v229 offset:19456
  ds_read_b64_tr_b16 v[156:157], v233 offset:12288
  s_add_u32 s85, s85, 4096
  s_and_b32 s85, s85, 0x7fff
  v_cvt_pk_bf16_f32 v118, v124, v125
  v_cvt_pk_bf16_f32 v119, v126, v127
  s_waitcnt lgkmcnt(4)
  v_mfma_f32_32x32x16_bf16 v[176:191], v[136:139], v[132:135], v[176:191]
  ds_read_b64_tr_b16 v[158:159], v233 offset:13312
  ds_read_b128 v[148:151], v229 offset:23552
  buffer_store_dwordx4 v[116:119], v254, s[40:43], s67 offen offset:3072 sc1
  s_sub_u32 s67, s67, 24576
  v_mfma_f32_32x32x16_bf16 v[208:223], v[140:143], v[132:135], v[208:223]
  s_waitcnt vmcnt(12) lgkmcnt(0)
  v_mfma_f32_32x32x16_bf16 v[160:175], v[152:155], v[144:147], v[160:175]
  s_barrier
  ds_read_b64_tr_b16 v[128:129], v240 offset:32768
  ds_read_b64_tr_b16 v[130:131], v240 offset:33792
  ds_read_b64_tr_b16 v[132:133], v241 offset:32768
  ds_read_b64_tr_b16 v[134:135], v241 offset:33792
  v_mfma_f32_32x32x16_bf16 v[192:207], v[156:159], v[144:147], v[192:207]
  ds_read_b64_tr_b16 v[136:137], v242 offset:32768
  ds_read_b64_tr_b16 v[138:139], v242 offset:33792
  ds_read_b64_tr_b16 v[140:141], v243 offset:32768
  ds_read_b64_tr_b16 v[142:143], v243 offset:33792
  v_mfma_f32_32x32x16_bf16 v[176:191], v[152:155], v[148:151], v[176:191]
  v_mfma_f32_32x32x16_bf16 v[208:223], v[156:159], v[148:151], v[208:223]
.Lq:
  s_mov_b32 s63, s76
  s_mov_b32 s62, s71
  s_waitcnt lgkmcnt(6)
  v_mfma_f32_32x32x16_bf16 v[64:79], v[128:131], v[0:3], 0
  ds_read_b64_tr_b16 v[144:145], v240 offset:36864
  ds_read_b64_tr_b16 v[146:147], v240 offset:37888
  ds_read_b64_tr_b16 v[148:149], v241 offset:36864
  v_pk_mul_f32 v[192:193], v[160:161], v[192:193]
  v_pk_mul_f32 v[194:195], v[162:163], v[194:195]
  v_pk_mul_f32 v[196:197], v[164:165], v[196:197]
  v_pk_mul_f32 v[198:199], v[166:167], v[198:199]
  v_pk_mul_f32 v[160:161], v[160:161], s[74:75]
  s_add_u32 m0, s66, s83
  s_waitcnt lgkmcnt(7)
  v_mfma_f32_32x32x16_bf16 v[80:95], v[132:135], v[0:3], 0
  ds_read_b64_tr_b16 v[150:151], v241 offset:37888
  ds_read_b64_tr_b16 v[152:153], v242 offset:36864
  ds_read_b64_tr_b16 v[154:155], v242 offset:37888
  v_pk_mul_f32 v[162:163], v[162:163], s[74:75]
  v_pk_mul_f32 v[164:165], v[164:165], s[74:75]
  v_pk_mul_f32 v[166:167], v[166:167], s[74:75]
  v_exp_f32 v160, v160
  buffer_load_dwordx4 v244, s[48:51], s84 offen offset:0 lds
  s_waitcnt lgkmcnt(8)
  v_mfma_f32_32x32x16_bf16 v[96:111], v[136:139], v[0:3], 0
  ds_read_b64_tr_b16 v[156:157], v243 offset:36864
  ds_read_b64_tr_b16 v[158:159], v243 offset:37888
  v_exp_f32 v161, v161
  v_exp_f32 v162, v162
  v_exp_f32 v163, v163
  v_exp_f32 v164, v164
  buffer_load_dwordx4 v245, s[48:51], s84 offen offset:1024 lds
  s_waitcnt lgkmcnt(8)
  v_mfma_f32_32x32x16_bf16 v[112:127], v[140:143], v[0:3], 0
  v_exp_f32 v165, v165
  v_exp_f32 v166, v166
  v_exp_f32 v167, v167
  v_add_f32 v160, 1.0, v160
  s_waitcnt lgkmcnt(6)
  v_mfma_f32_32x32x16_bf16 v[64:79], v[144:147], v[4:7], v[64:79]
  ds_read_b64_tr_b16 v[128:129], v240 offset:40960
  ds_read_b64_tr_b16 v[130:131], v240 offset:41984
  ds_read_b64_tr_b16 v[132:133], v241 offset:40960
  v_add_f32 v161, 1.0, v161
  v_add_f32 v162, 1.0, v162
  v_add_f32 v163, 1.0, v163
  v_add_f32 v164, 1.0, v164
  v_add_f32 v165, 1.0, v165
  buffer_load_dwordx4 v246, s[48:51], s84 offen offset:2048 lds
  s_waitcnt lgkmcnt(7)
  v_mfma_f32_32x32x16_bf16 v[80:95], v[148:151], v[4:7], v[80:95]
  ds_read_b64_tr_b16 v[134:135], v241 offset:41984
  ds_read_b64_tr_b16 v[136:137], v242 offset:40960
  ds_read_b64_tr_b16 v[138:139], v242 offset:41984
  v_add_f32 v166, 1.0, v166
  v_add_f32 v167, 1.0, v167
  v_rcp_f32 v160, v160
  v_rcp_f32 v161, v161
  buffer_load_dwordx4 v247, s[48:51], s84 offen offset:3072 lds
  s_waitcnt lgkmcnt(8)
  v_mfma_f32_32x32x16_bf16 v[96:111], v[152:155], v[4:7], v[96:111]
  ds_read_b64_tr_b16 v[140:141], v243 offset:40960
  ds_read_b64_tr_b16 v[142:143], v243 offset:41984
  v_rcp_f32 v162, v162
  v_rcp_f32 v163, v163
  v_rcp_f32 v164, v164
  v_rcp_f32 v165, v165
  s_add_u32 s84, s84, 0x100000
  s_and_b32 s84, s84, 0x3fffff
  s_waitcnt lgkmcnt(8)
  v_mfma_f32_32x32x16_bf16 v[112:127], v[156:159], v[4:7], v[112:127]
  v_rcp_f32 v166, v166
  v_rcp_f32 v167, v167
  v_pk_mul_f32 v[192:193], v[192:193], v[160:161]
  v_pk_mul_f32 v[194:195], v[194:195], v[162:163]
  s_waitcnt lgkmcnt(6)
  v_mfma_f32_32x32x16_bf16 v[64:79], v[128:131], v[8:11], v[64:79]
  ds_read_b64_tr_b16 v[144:145], v240 offset:45056
  ds_read_b64_tr_b16 v[146:147], v240 offset:46080
  ds_read_b64_tr_b16 v[148:149], v241 offset:45056
  v_pk_mul_f32 v[196:197], v[196:197], v[164:165]
  v_pk_mul_f32 v[198:199], v[198:199], v[166:167]
  v_cvt_pk_bf16_f32 v192, v192, v193
  v_cvt_pk_bf16_f32 v193, v194, v195
  v_cvt_pk_bf16_f32 v194, v196, v197
  s_waitcnt lgkmcnt(7)
  v_mfma_f32_32x32x16_bf16 v[80:95], v[132:135], v[8:11], v[80:95]
  ds_read_b64_tr_b16 v[150:151], v241 offset:46080
  ds_read_b64_tr_b16 v[152:153], v242 offset:45056
  ds_read_b64_tr_b16 v[154:155], v242 offset:46080
  v_cvt_pk_bf16_f32 v195, v198, v199
  buffer_store_dwordx4 v[192:195], v254, s[40:43], s80 offen offset:0 sc1
  v_pk_mul_f32 v[200:201], v[168:169], v[200:201]
  v_pk_mul_f32 v[202:203], v[170:171], v[202:203]
  s_waitcnt lgkmcnt(8)
  v_mfma_f32_32x32x16_bf16 v[96:111], v[136:139], v[8:11], v[96:111]
  ds_read_b64_tr_b16 v[156:157], v243 offset:45056
  ds_read_b64_tr_b16 v[158:159], v243 offset:46080
  v_pk_mul_f32 v[204:205], v[172:173], v[204:205]
  v_pk_mul_f32 v[206:207], v[174:175], v[206:207]
  v_pk_mul_f32 v[168:169], v[168:169], s[74:75]
  v_pk_mul_f32 v[170:171], v[170:171], s[74:75]
  s_waitcnt lgkmcnt(8)
  v_mfma_f32_32x32x16_bf16 v[112:127], v[140:143], v[8:11], v[112:127]
  v_pk_mul_f32 v[172:173], v[172:173], s[74:75]
  v_pk_mul_f32 v[174:175], v[174:175], s[74:75]
  v_exp_f32 v168, v168
  v_exp_f32 v169, v169
  s_waitcnt lgkmcnt(6)
  v_mfma_f32_32x32x16_bf16 v[64:79], v[144:147], v[12:15], v[64:79]
  ds_read_b64_tr_b16 v[128:129], v240 offset:49152
  ds_read_b64_tr_b16 v[130:131], v240 offset:50176
  ds_read_b64_tr_b16 v[132:133], v241 offset:49152
  v_exp_f32 v170, v170
  v_exp_f32 v171, v171
  v_exp_f32 v172, v172
  v_exp_f32 v173, v173
  v_exp_f32 v174, v174
  s_waitcnt lgkmcnt(7)
  v_mfma_f32_32x32x16_bf16 v[80:95], v[148:151], v[12:15], v[80:95]
  ds_read_b64_tr_b16 v[134:135], v241 offset:50176
  ds_read_b64_tr_b16 v[136:137], v242 offset:49152
  ds_read_b64_tr_b16 v[138:139], v242 offset:50176
  v_exp_f32 v175, v175
  v_add_f32 v168, 1.0, v168
  v_add_f32 v169, 1.0, v169
  v_add_f32 v170, 1.0, v170
  s_waitcnt lgkmcnt(8)
  v_mfma_f32_32x32x16_bf16 v[96:111], v[152:155], v[12:15], v[96:111]
  ds_read_b64_tr_b16 v[140:141], v243 offset:49152
  ds_read_b64_tr_b16 v[142:143], v243 offset:50176
  v_add_f32 v171, 1.0, v171
  v_add_f32 v172, 1.0, v172
  v_add_f32 v173, 1.0, v173
  v_add_f32 v174, 1.0, v174
  s_waitcnt lgkmcnt(8)
  v_mfma_f32_32x32x16_bf16 v[112:127], v[156:159], v[12:15], v[112:127]
  v_add_f32 v175, 1.0, v175
  v_rcp_f32 v168, v168
  v_rcp_f32 v169, v169
  v_rcp_f32 v170, v170
  s_waitcnt lgkmcnt(6)
  v_mfma_f32_32x32x16_bf16 v[64:79], v[128:131], v[16:19], v[64:79]
  ds_read_b64_tr_b16 v[144:145], v240 offset:53248
  ds_read_b64_tr_b16 v[146:147], v240 offset:54272
  ds_read_b64_tr_b16 v[148:149], v241 offset:53248
  v_rcp_f32 v171, v171
  v_rcp_f32 v172, v172
  v_rcp_f32 v173, v173
  v_rcp_f32 v174, v174
  s_waitcnt lgkmcnt(7)
  v_mfma_f32_32x32x16_bf16 v[80:95], v[132:135], v[16:19], v[80:95]
  ds_read_b64_tr_b16 v[150:151], v241 offset:54272
  ds_read_b64_tr_b16 v[152:153], v242 offset:53248
  ds_read_b64_tr_b16 v[154:155], v242 offset:54272
  v_rcp_f32 v175, v175
  v_pk_mul_f32 v[200:201], v[200:201], v[168:169]
  v_pk_mul_f32 v[202:203], v[202:203], v[170:171]
  v_pk_mul_f32 v[204:205], v[204:205], v[172:173]
  s_waitcnt lgkmcnt(8)
  v_mfma_f32_32x32x16_bf16 v[96:111], v[136:139], v[16:19], v[96:111]
  ds_read_b64_tr_b16 v[156:157], v243 offset:53248
  ds_read_b64_tr_b16 v[158:159], v243 offset:54272
  v_pk_mul_f32 v[206:207], v[206:207], v[174:175]
  v_cvt_pk_bf16_f32 v200, v200, v201
  v_cvt_pk_bf16_f32 v201, v202, v203
  v_cvt_pk_bf16_f32 v202, v204, v205
  s_waitcnt lgkmcnt(8)
  v_mfma_f32_32x32x16_bf16 v[112:127], v[140:143], v[16:19], v[112:127]
  v_cvt_pk_bf16_f32 v203, v206, v207
  buffer_store_dwordx4 v[200:203], v254, s[40:43], s80 offen offset:1024 sc1
  s_add_u32 s80, s80, 376832
  s_waitcnt lgkmcnt(6)
  v_mfma_f32_32x32x16_bf16 v[64:79], v[144:147], v[20:23], v[64:79]
  ds_read_b64_tr_b16 v[128:129], v240 offset:57344
  ds_read_b64_tr_b16 v[130:131], v240 offset:58368
  ds_read_b64_tr_b16 v[132:133], v241 offset:57344
  v_pk_mul_f32 v[208:209], v[176:177], v[208:209]
  v_pk_mul_f32 v[210:211], v[178:179], v[210:211]
  v_pk_mul_f32 v[212:213], v[180:181], v[212:213]
  v_pk_mul_f32 v[214:215], v[182:183], v[214:215]
  v_pk_mul_f32 v[176:177], v[176:177], s[74:75]
  s_waitcnt lgkmcnt(7)
  v_mfma_f32_32x32x16_bf16 v[80:95], v[148:151], v[20:23], v[80:95]
  ds_read_b64_tr_b16 v[134:135], v241 offset:58368
  ds_read_b64_tr_b16 v[136:137], v242 offset:57344
  ds_read_b64_tr_b16 v[138:139], v242 offset:58368
  v_pk_mul_f32 v[178:179], v[178:179], s[74:75]
  v_pk_mul_f32 v[180:181], v[180:181], s[74:75]
  v_pk_mul_f32 v[182:183], v[182:183], s[74:75]
  v_exp_f32 v176, v176
  buffer_load_dwordx4 v[160:163], v227, s[44:47], s85 offen offset:0 sc1
  buffer_load_dwordx4 v[164:167], v227, s[44:47], s85 offen offset:1024 sc1
  s_waitcnt lgkmcnt(8)
  v_mfma_f32_32x32x16_bf16 v[96:111], v[152:155], v[20:23], v[96:111]
  ds_read_b64_tr_b16 v[140:141], v243 offset:57344
  ds_read_b64_tr_b16 v[142:143], v243 offset:58368
  v_exp_f32 v177, v177
  v_exp_f32 v178, v178
  v_exp_f32 v179, v179
  v_exp_f32 v180, v180
  buffer_load_dwordx4 v[168:171], v227, s[44:47], s85 offen offset:2048 sc1
  buffer_load_dwordx4 v[172:175], v227, s[44:47], s85 offen offset:3072 sc1
  s_waitcnt lgkmcnt(8)
  v_mfma_f32_32x32x16_bf16 v[112:127], v[156:159], v[20:23], v[112:127]
  v_exp_f32 v181, v181
  v_exp_f32 v182, v182
  v_exp_f32 v183, v183
  v_add_f32 v176, 1.0, v176
  s_add_u32 s85, s85, 4096
  s_and_b32 s85, s85, 0x7fff
  s_waitcnt lgkmcnt(6)
  v_mfma_f32_32x32x16_bf16 v[64:79], v[128:131], v[24:27], v[64:79]
  ds_read_b64_tr_b16 v[144:145], v240 offset:61440
  ds_read_b64_tr_b16 v[146:147], v240 offset:62464
  ds_read_b64_tr_b16 v[148:149], v241 offset:61440
  v_add_f32 v177, 1.0, v177
  v_add_f32 v178, 1.0, v178
  v_add_f32 v179, 1.0, v179
  v_add_f32 v180, 1.0, v180
  v_add_f32 v181, 1.0, v181
  buffer_load_dwordx4 v[192:195], v227, s[44:47], s85 offen offset:0 sc1
  buffer_load_dwordx4 v[196:199], v227, s[44:47], s85 offen offset:1024 sc1
  s_waitcnt lgkmcnt(7)
  v_mfma_f32_32x32x16_bf16 v[80:95], v[132:135], v[24:27], v[80:95]
  ds_read_b64_tr_b16 v[150:151], v241 offset:62464
  ds_read_b64_tr_b16 v[152:153], v242 offset:61440
  ds_read_b64_tr_b16 v[154:155], v242 offset:62464
  v_add_f32 v182, 1.0, v182
  v_add_f32 v183, 1.0, v183
  v_rcp_f32 v176, v176
  v_rcp_f32 v177, v177
  buffer_load_dwordx4 v[200:203], v227, s[44:47], s85 offen offset:2048 sc1
  s_waitcnt lgkmcnt(8)
  v_mfma_f32_32x32x16_bf16 v[96:111], v[136:139], v[24:27], v[96:111]
  ds_read_b64_tr_b16 v[156:157], v243 offset:61440
  ds_read_b64_tr_b16 v[158:159], v243 offset:62464
  v_rcp_f32 v178, v178
  v_rcp_f32 v179, v179
  v_rcp_f32 v180, v180
  v_rcp_f32 v181, v181
  buffer_load_dwordx4 v[204:207], v227, s[44:47], s85 offen offset:3072 sc1
  s_add_u32 s85, s85, 4096
  s_and_b32 s85, s85, 0x7fff
  s_waitcnt lgkmcnt(8)
  v_mfma_f32_32x32x16_bf16 v[112:127], v[140:143], v[24:27], v[112:127]
  v_rcp_f32 v182, v182
  v_rcp_f32 v183, v183
  v_pk_mul_f32 v[208:209], v[208:209], v[176:177]
  v_pk_mul_f32 v[210:211], v[210:211], v[178:179]
  s_waitcnt vmcnt(14) lgkmcnt(0)
  v_mfma_f32_32x32x16_bf16 v[64:79], v[144:147], v[28:31], v[64:79]
  s_barrier
  ds_read_b64_tr_b16 v[128:129], v240 offset:0
  ds_read_b64_tr_b16 v[130:131], v240 offset:1024
  ds_read_b64_tr_b16 v[132:133], v241 offset:0
  ds_read_b64_tr_b16 v[134:135], v241 offset:1024
  v_pk_mul_f32 v[212:213], v[212:213], v[180:181]
  v_pk_mul_f32 v[214:215], v[214:215], v[182:183]
  v_cvt_pk_bf16_f32 v208, v208, v209
  v_cvt_pk_bf16_f32 v209, v210, v211
  v_cvt_pk_bf16_f32 v210, v212, v213
  v_mfma_f32_32x32x16_bf16 v[80:95], v[148:151], v[28:31], v[80:95]
  ds_read_b64_tr_b16 v[136:137], v242 offset:0
  ds_read_b64_tr_b16 v[138:139], v242 offset:1024
  ds_read_b64_tr_b16 v[140:141], v243 offset:0
  ds_read_b64_tr_b16 v[142:143], v243 offset:1024
  v_cvt_pk_bf16_f32 v211, v214, v215
  buffer_store_dwordx4 v[208:211], v254, s[40:43], s80 offen offset:0 sc1
  v_pk_mul_f32 v[216:217], v[184:185], v[216:217]
  v_pk_mul_f32 v[218:219], v[186:187], v[218:219]
  v_mfma_f32_32x32x16_bf16 v[96:111], v[152:155], v[28:31], v[96:111]
  v_pk_mul_f32 v[220:221], v[188:189], v[220:221]
  v_pk_mul_f32 v[222:223], v[190:191], v[222:223]
  v_pk_mul_f32 v[184:185], v[184:185], s[74:75]
  v_pk_mul_f32 v[186:187], v[186:187], s[74:75]
  v_mfma_f32_32x32x16_bf16 v[112:127], v[156:159], v[28:31], v[112:127]
  s_cmp_eq_u32 s62, 0
  s_cbranch_scc1 .Lkvsig
  s_cmp_lg_u32 s3, 0
  s_cbranch_scc1 .Lsig_kv1
  s_lshl_b32 s88, s79, 7
  v_mov_b32 v234, s88
  s_mov_b64 exec, 1
  global_atomic_add v234, v253, s[16:17]
  s_mov_b64 exec, -1
.Lsig_kv1:
.Lkvsig:
  v_pk_mul_f32 v[188:189], v[188:189], s[74:75]
  v_pk_mul_f32 v[190:191], v[190:191], s[74:75]
  v_exp_f32 v184, v184
  v_exp_f32 v185, v185
  s_waitcnt lgkmcnt(6)
  v_mfma_f32_32x32x16_bf16 v[64:79], v[128:131], v[32:35], v[64:79]
  ds_read_b64_tr_b16 v[144:145], v240 offset:4096
  ds_read_b64_tr_b16 v[146:147], v240 offset:5120
  ds_read_b64_tr_b16 v[148:149], v241 offset:4096
  v_exp_f32 v186, v186
  v_exp_f32 v187, v187
  v_exp_f32 v188, v188
  v_exp_f32 v189, v189
  v_exp_f32 v190, v190
  s_xor_b32 m0, s83, 0x8000
  s_add_u32 m0, m0, s66
  s_waitcnt lgkmcnt(7)
  v_mfma_f32_32x32x16_bf16 v[80:95], v[132:135], v[32:35], v[80:95]
  ds_read_b64_tr_b16 v[150:151], v241 offset:5120
  ds_read_b64_tr_b16 v[152:153], v242 offset:4096
  ds_read_b64_tr_b16 v[154:155], v242 offset:5120
  v_exp_f32 v191, v191
  v_add_f32 v184, 1.0, v184
  v_add_f32 v185, 1.0, v185
  v_add_f32 v186, 1.0, v186
  buffer_load_dwordx4 v244, s[48:51], s84 offen offset:0 lds
  s_waitcnt lgkmcnt(8)
  v_mfma_f32_32x32x16_bf16 v[96:111], v[136:139], v[32:35], v[96:111]
  ds_read_b64_tr_b16 v[156:157], v243 offset:4096
  ds_read_b64_tr_b16 v[158:159], v243 offset:5120
  v_add_f32 v187, 1.0, v187
  v_add_f32 v188, 1.0, v188
  v_add_f32 v189, 1.0, v189
  v_add_f32 v190, 1.0, v190
  buffer_load_dwordx4 v245, s[48:51], s84 offen offset:1024 lds
  s_waitcnt lgkmcnt(8)
  v_mfma_f32_32x32x16_bf16 v[112:127], v[140:143], v[32:35], v[112:127]
  v_add_f32 v191, 1.0, v191
  v_rcp_f32 v184, v184
  v_rcp_f32 v185, v185
  v_rcp_f32 v186, v186
  s_waitcnt lgkmcnt(6)
  v_mfma_f32_32x32x16_bf16 v[64:79], v[144:147], v[36:39], v[64:79]
  ds_read_b64_tr_b16 v[128:129], v240 offset:8192
  ds_read_b64_tr_b16 v[130:131], v240 offset:9216
  ds_read_b64_tr_b16 v[132:133], v241 offset:8192
  v_rcp_f32 v187, v187
  v_rcp_f32 v188, v188
  v_rcp_f32 v189, v189
  v_rcp_f32 v190, v190
  buffer_load_dwordx4 v246, s[48:51], s84 offen offset:2048 lds
  s_waitcnt lgkmcnt(7)
  v_mfma_f32_32x32x16_bf16 v[80:95], v[148:151], v[36:39], v[80:95]
  ds_read_b64_tr_b16 v[134:135], v241 offset:9216
  ds_read_b64_tr_b16 v[136:137], v242 offset:8192
  ds_read_b64_tr_b16 v[138:139], v242 offset:9216
  v_rcp_f32 v191, v191
  v_pk_mul_f32 v[216:217], v[216:217], v[184:185]
  v_pk_mul_f32 v[218:219], v[218:219], v[186:187]
  buffer_load_dwordx4 v247, s[48:51], s84 offen offset:3072 lds
  s_waitcnt lgkmcnt(8)
  v_mfma_f32_32x32x16_bf16 v[96:111], v[152:155], v[36:39], v[96:111]
  ds_read_b64_tr_b16 v[140:141], v243 offset:8192
  ds_read_b64_tr_b16 v[142:143], v243 offset:9216
  v_pk_mul_f32 v[220:221], v[220:221], v[188:189]
  v_pk_mul_f32 v[222:223], v[222:223], v[190:191]
  v_cvt_pk_bf16_f32 v216, v216, v217
  v_cvt_pk_bf16_f32 v217, v218, v219
  s_add_u32 s84, s84, 0x100000
  s_and_b32 s84, s84, 0x3fffff
  s_waitcnt lgkmcnt(8)
  v_mfma_f32_32x32x16_bf16 v[112:127], v[156:159], v[36:39], v[112:127]
  v_cvt_pk_bf16_f32 v218, v220, v221
  v_cvt_pk_bf16_f32 v219, v222, v223
  buffer_store_dwordx4 v[216:219], v254, s[40:43], s80 offen offset:1024 sc1
  s_waitcnt lgkmcnt(6)
  v_mfma_f32_32x32x16_bf16 v[64:79], v[128:131], v[40:43], v[64:79]
  ds_read_b64_tr_b16 v[144:145], v240 offset:12288
  ds_read_b64_tr_b16 v[146:147], v240 offset:13312
  ds_read_b64_tr_b16 v[148:149], v241 offset:12288
  s_sub_u32 s60, 16, s31
  s_lshl_b32 s60, s60, 15
  s_lshl_b32 s58, s30, 19
  s_add_u32 s59, s58, 0x1200000
  s_waitcnt lgkmcnt(7)
  v_mfma_f32_32x32x16_bf16 v[80:95], v[132:135], v[40:43], v[80:95]
  ds_read_b64_tr_b16 v[150:151], v241 offset:13312
  ds_read_b64_tr_b16 v[152:153], v242 offset:12288
  ds_read_b64_tr_b16 v[154:155], v242 offset:13312
  buffer_load_dwordx4 v[176:179], v227, s[44:47], s85 offen offset:0 sc1
  buffer_load_dwordx4 v[180:183], v227, s[44:47], s85 offen offset:1024 sc1
  s_waitcnt lgkmcnt(8)
  v_mfma_f32_32x32x16_bf16 v[96:111], v[136:139], v[40:43], v[96:111]
  ds_read_b64_tr_b16 v[156:157], v243 offset:12288
  ds_read_b64_tr_b16 v[158:159], v243 offset:13312
  buffer_load_dwordx4 v[184:187], v227, s[44:47], s85 offen offset:2048 sc1
  buffer_load_dwordx4 v[188:191], v227, s[44:47], s85 offen offset:3072 sc1
  s_add_u32 s32, s28, s59
  s_addc_u32 s33, s29, 0
  s_mov_b32 s34, s60
  s_mov_b32 s35, 0x00020000
  s_waitcnt lgkmcnt(8)
  v_mfma_f32_32x32x16_bf16 v[112:127], v[140:143], v[40:43], v[112:127]
  s_add_u32 s85, s85, 4096
  s_and_b32 s85, s85, 0x7fff
  s_waitcnt lgkmcnt(6)
  v_mfma_f32_32x32x16_bf16 v[64:79], v[144:147], v[44:47], v[64:79]
  ds_read_b64_tr_b16 v[128:129], v240 offset:16384
  ds_read_b64_tr_b16 v[130:131], v240 offset:17408
  ds_read_b64_tr_b16 v[132:133], v241 offset:16384
  buffer_load_dwordx4 v[208:211], v227, s[44:47], s85 offen offset:0 sc1
  buffer_load_dwordx4 v[212:215], v227, s[44:47], s85 offen offset:1024 sc1
  s_add_u32 s59, s58, 0x2200000
  s_add_u32 s36, s28, s59
  s_addc_u32 s37, s29, 0
  s_mov_b32 s38, s60
  s_waitcnt lgkmcnt(7)
  v_mfma_f32_32x32x16_bf16 v[80:95], v[148:151], v[44:47], v[80:95]
  ds_read_b64_tr_b16 v[134:135], v241 offset:17408
  ds_read_b64_tr_b16 v[136:137], v242 offset:16384
  ds_read_b64_tr_b16 v[138:139], v242 offset:17408
  buffer_load_dwordx4 v[216:219], v227, s[44:47], s85 offen offset:2048 sc1
  s_mov_b32 s39, 0x00020000
  s_lshl_b32 s77, s56, 12
  s_add_u32 s78, s77, 0x10000
  v_add_u32 v226, s77, v254
  s_waitcnt lgkmcnt(8)
  v_mfma_f32_32x32x16_bf16 v[96:111], v[152:155], v[44:47], v[96:111]
  ds_read_b64_tr_b16 v[140:141], v243 offset:16384
  ds_read_b64_tr_b16 v[142:143], v243 offset:17408
  buffer_load_dwordx4 v[220:223], v227, s[44:47], s85 offen offset:3072 sc1
  s_add_u32 s85, s85, 4096
  s_and_b32 s85, s85, 0x7fff
  s_mov_b32 s67, 0
  s_mov_b32 s68, 0
  s_mov_b32 s69, s83
  s_mov_b32 s70, s83
  s_waitcnt lgkmcnt(8)
  v_mfma_f32_32x32x16_bf16 v[112:127], v[156:159], v[44:47], v[112:127]
  s_waitcnt lgkmcnt(6)
  v_mfma_f32_32x32x16_bf16 v[64:79], v[128:131], v[48:51], v[64:79]
  ds_read_b64_tr_b16 v[144:145], v240 offset:20480
  ds_read_b64_tr_b16 v[146:147], v240 offset:21504
  ds_read_b64_tr_b16 v[148:149], v241 offset:20480
  s_lshr_b32 s82, s30, 1
  s_lshl_b32 s60, s64, 2
  s_add_u32 s60, s60, s56
  s_mul_i32 s60, s60, 368
  s_waitcnt lgkmcnt(7)
  v_mfma_f32_32x32x16_bf16 v[80:95], v[132:135], v[48:51], v[80:95]
  ds_read_b64_tr_b16 v[150:151], v241 offset:21504
  ds_read_b64_tr_b16 v[152:153], v242 offset:20480
  ds_read_b64_tr_b16 v[154:155], v242 offset:21504
  s_waitcnt lgkmcnt(8)
  v_mfma_f32_32x32x16_bf16 v[96:111], v[136:139], v[48:51], v[96:111]
  ds_read_b64_tr_b16 v[156:157], v243 offset:20480
  ds_read_b64_tr_b16 v[158:159], v243 offset:21504
  s_lshl_b32 s61, s30, 3
  s_add_u32 s60, s60, s61
  s_lshl_b32 s72, s60, 10
  s_add_u32 s72, s72, 0x3200000
  s_waitcnt lgkmcnt(8)
  v_mfma_f32_32x32x16_bf16 v[112:127], v[140:143], v[48:51], v[112:127]
  s_waitcnt lgkmcnt(6)
  v_mfma_f32_32x32x16_bf16 v[64:79], v[144:147], v[52:55], v[64:79]
  ds_read_b64_tr_b16 v[128:129], v240 offset:24576
  ds_read_b64_tr_b16 v[130:131], v240 offset:25600
  ds_read_b64_tr_b16 v[132:133], v241 offset:24576
  s_add_u32 s73, s72, 4096
  s_lshl_b32 s71, s64, 1
  s_lshr_b32 s58, s56, 1
  s_add_u32 s71, s71, s58
  s_waitcnt lgkmcnt(7)
  v_mfma_f32_32x32x16_bf16 v[80:95], v[148:151], v[52:55], v[80:95]
  ds_read_b64_tr_b16 v[134:135], v241 offset:25600
  ds_read_b64_tr_b16 v[136:137], v242 offset:24576
  ds_read_b64_tr_b16 v[138:139], v242 offset:25600
  s_lshl_b32 s58, s31, 1
  s_add_u32 s58, s58, s71
  s_sub_u32 s65, 31, s58
  s_mov_b32 s76, 0x41200000
  s_waitcnt lgkmcnt(8)
  v_mfma_f32_32x32x16_bf16 v[96:111], v[152:155], v[52:55], v[96:111]
  ds_read_b64_tr_b16 v[140:141], v243 offset:24576
  ds_read_b64_tr_b16 v[142:143], v243 offset:25600
  s_mov_b32 s74, 0x3e0293ee
  s_mov_b32 s75, 0x3e0293ee
  v_add_u32 v225, s83, v254
  v_add_u32 v224, 0x10000, v225
  s_waitcnt lgkmcnt(8)
  v_mfma_f32_32x32x16_bf16 v[112:127], v[156:159], v[52:55], v[112:127]
  s_waitcnt lgkmcnt(6)
  v_mfma_f32_32x32x16_bf16 v[64:79], v[128:131], v[56:59], v[64:79]
  ds_read_b64_tr_b16 v[144:145], v240 offset:28672
  ds_read_b64_tr_b16 v[146:147], v240 offset:29696
  ds_read_b64_tr_b16 v[148:149], v241 offset:28672
  v_and_b32 v235, 31, v255
  v_lshrrev_b32 v236, 5, v255
  v_lshlrev_b32 v236, 2, v236
  v_sub_u32 v235, v235, v236
  s_waitcnt lgkmcnt(7)
  v_mfma_f32_32x32x16_bf16 v[80:95], v[132:135], v[56:59], v[80:95]
  ds_read_b64_tr_b16 v[150:151], v241 offset:29696
  ds_read_b64_tr_b16 v[152:153], v242 offset:28672
  ds_read_b64_tr_b16 v[154:155], v242 offset:29696
  s_and_b32 s58, s56, 1
  s_lshl_b32 s58, s58, 5
  v_add_u32 v233, s58, v235
  v_mov_b32 v238, 0xff800000
  s_waitcnt lgkmcnt(8)
  v_mfma_f32_32x32x16_bf16 v[96:111], v[136:139], v[56:59], v[96:111]
  ds_read_b64_tr_b16 v[156:157], v243 offset:28672
  ds_read_b64_tr_b16 v[158:159], v243 offset:29696
  v_mov_b32 v228, 0
  v_mov_b32 v229, 0
  s_waitcnt lgkmcnt(8)
  v_mfma_f32_32x32x16_bf16 v[112:127], v[140:143], v[56:59], v[112:127]
  s_waitcnt vmcnt(14) lgkmcnt(0)
  s_sub_u32 s58, s83, 0x10000
  v_add_u32 v240, s58, v240
  v_add_u32 v241, s58, v241
  v_add_u32 v242, s58, v242
  v_add_u32 v243, s58, v243
  v_mfma_f32_32x32x16_bf16 v[64:79], v[144:147], v[60:63], v[64:79]
  s_barrier
  ds_read_b64_tr_b16 v[128:129], v240 offset:0
  ds_read_b64_tr_b16 v[130:131], v240 offset:1024
  ds_read_b64_tr_b16 v[132:133], v241 offset:0
  ds_read_b64_tr_b16 v[134:135], v241 offset:1024
  v_mfma_f32_32x32x16_bf16 v[80:95], v[148:151], v[60:63], v[80:95]
  ds_read_b64_tr_b16 v[136:137], v242 offset:0
  ds_read_b64_tr_b16 v[138:139], v242 offset:1024
  ds_read_b64_tr_b16 v[140:141], v243 offset:0
  ds_read_b64_tr_b16 v[142:143], v243 offset:1024
  v_mfma_f32_32x32x16_bf16 v[96:111], v[152:155], v[60:63], v[96:111]
  v_mfma_f32_32x32x16_bf16 v[112:127], v[156:159], v[60:63], v[112:127]
  s_waitcnt lgkmcnt(6)
  v_mfma_f32_32x32x16_bf16 v[64:79], v[128:131], v[160:163], v[64:79]
  ds_read_b64_tr_b16 v[144:145], v240 offset:4096
  ds_read_b64_tr_b16 v[146:147], v240 offset:5120
  ds_read_b64_tr_b16 v[148:149], v241 offset:4096
  s_waitcnt lgkmcnt(7)
  v_mfma_f32_32x32x16_bf16 v[80:95], v[132:135], v[160:163], v[80:95]
  ds_read_b64_tr_b16 v[150:151], v241 offset:5120
  ds_read_b64_tr_b16 v[152:153], v242 offset:4096
  ds_read_b64_tr_b16 v[154:155], v242 offset:5120
  s_waitcnt lgkmcnt(8)
  v_mfma_f32_32x32x16_bf16 v[96:111], v[136:139], v[160:163], v[96:111]
  ds_read_b64_tr_b16 v[156:157], v243 offset:4096
  ds_read_b64_tr_b16 v[158:159], v243 offset:5120
  s_waitcnt lgkmcnt(8)
  v_mfma_f32_32x32x16_bf16 v[112:127], v[140:143], v[160:163], v[112:127]
  s_waitcnt lgkmcnt(6)
  v_mfma_f32_32x32x16_bf16 v[64:79], v[144:147], v[164:167], v[64:79]
  ds_read_b64_tr_b16 v[128:129], v240 offset:8192
  ds_read_b64_tr_b16 v[130:131], v240 offset:9216
  ds_read_b64_tr_b16 v[132:133], v241 offset:8192
  v_mov_b32 v0, 0
  v_mov_b32 v1, 0
  s_waitcnt lgkmcnt(7)
  v_mfma_f32_32x32x16_bf16 v[80:95], v[148:151], v[164:167], v[80:95]
  ds_read_b64_tr_b16 v[134:135], v241 offset:9216
  ds_read_b64_tr_b16 v[136:137], v242 offset:8192
  ds_read_b64_tr_b16 v[138:139], v242 offset:9216
  v_mov_b32 v2, 0
  v_mov_b32 v3, 0
  s_waitcnt lgkmcnt(8)
  v_mfma_f32_32x32x16_bf16 v[96:111], v[152:155], v[164:167], v[96:111]
  ds_read_b64_tr_b16 v[140:141], v243 offset:8192
  ds_read_b64_tr_b16 v[142:143], v243 offset:9216
  v_mov_b32 v4, 0
  v_mov_b32 v5, 0
  s_waitcnt lgkmcnt(8)
  v_mfma_f32_32x32x16_bf16 v[112:127], v[156:159], v[164:167], v[112:127]
  v_mov_b32 v6, 0
  v_mov_b32 v7, 0
  s_waitcnt lgkmcnt(6)
  v_mfma_f32_32x32x16_bf16 v[64:79], v[128:131], v[168:171], v[64:79]
  ds_read_b64_tr_b16 v[144:145], v240 offset:12288
  ds_read_b64_tr_b16 v[146:147], v240 offset:13312
  ds_read_b64_tr_b16 v[148:149], v241 offset:12288
  v_mov_b32 v8, 0
  v_mov_b32 v9, 0
  s_waitcnt lgkmcnt(7)
  v_mfma_f32_32x32x16_bf16 v[80:95], v[132:135], v[168:171], v[80:95]
  ds_read_b64_tr_b16 v[150:151], v241 offset:13312
  ds_read_b64_tr_b16 v[152:153], v242 offset:12288
  ds_read_b64_tr_b16 v[154:155], v242 offset:13312
  v_mov_b32 v10, 0
  v_mov_b32 v11, 0
  s_waitcnt lgkmcnt(8)
  v_mfma_f32_32x32x16_bf16 v[96:111], v[136:139], v[168:171], v[96:111]
  ds_read_b64_tr_b16 v[156:157], v243 offset:12288
  ds_read_b64_tr_b16 v[158:159], v243 offset:13312
  v_mov_b32 v12, 0
  v_mov_b32 v13, 0
  s_waitcnt lgkmcnt(8)
  v_mfma_f32_32x32x16_bf16 v[112:127], v[140:143], v[168:171], v[112:127]
  s_cmp_lg_u32 s3, 0
  s_cbranch_scc1 .Lpi_kv
  s_lshl_b32 s88, s82, 7
  v_mov_b32 v251, s88
  s_mov_b64 exec, 1
  global_atomic_add v250, v251, v249, s[16:17] sc0
  s_mov_b64 exec, -1
.Lpi_kv:
  v_mov_b32 v14, 0
  v_mov_b32 v15, 0
  s_waitcnt lgkmcnt(6)
  v_mfma_f32_32x32x16_bf16 v[64:79], v[144:147], v[172:175], v[64:79]
  ds_read_b64_tr_b16 v[128:129], v240 offset:16384
  ds_read_b64_tr_b16 v[130:131], v240 offset:17408
  ds_read_b64_tr_b16 v[132:133], v241 offset:16384
  v_mov_b32 v16, 0
  v_mov_b32 v17, 0
  s_waitcnt lgkmcnt(7)
  v_mfma_f32_32x32x16_bf16 v[80:95], v[148:151], v[172:175], v[80:95]
  ds_read_b64_tr_b16 v[134:135], v241 offset:17408
  ds_read_b64_tr_b16 v[136:137], v242 offset:16384
  ds_read_b64_tr_b16 v[138:139], v242 offset:17408
  v_mov_b32 v18, 0
  v_mov_b32 v19, 0
  s_waitcnt lgkmcnt(8)
  v_mfma_f32_32x32x16_bf16 v[96:111], v[152:155], v[172:175], v[96:111]
  ds_read_b64_tr_b16 v[140:141], v243 offset:16384
  ds_read_b64_tr_b16 v[142:143], v243 offset:17408
  v_mov_b32 v20, 0
  v_mov_b32 v21, 0
  s_waitcnt lgkmcnt(8)
  v_mfma_f32_32x32x16_bf16 v[112:127], v[156:159], v[172:175], v[112:127]
  v_mov_b32 v22, 0
  v_mov_b32 v23, 0
  s_waitcnt lgkmcnt(6)
  v_mfma_f32_32x32x16_bf16 v[64:79], v[128:131], v[192:195], v[64:79]
  ds_read_b64_tr_b16 v[144:145], v240 offset:20480
  ds_read_b64_tr_b16 v[146:147], v240 offset:21504
  ds_read_b64_tr_b16 v[148:149], v241 offset:20480
  v_mov_b32 v24, 0
  v_mov_b32 v25, 0
  s_waitcnt lgkmcnt(7)
  v_mfma_f32_32x32x16_bf16 v[80:95], v[132:135], v[192:195], v[80:95]
  ds_read_b64_tr_b16 v[150:151], v241 offset:21504
  ds_read_b64_tr_b16 v[152:153], v242 offset:20480
  ds_read_b64_tr_b16 v[154:155], v242 offset:21504
  v_mov_b32 v26, 0
  v_mov_b32 v27, 0
  s_waitcnt lgkmcnt(8)
  v_mfma_f32_32x32x16_bf16 v[96:111], v[136:139], v[192:195], v[96:111]
  ds_read_b64_tr_b16 v[156:157], v243 offset:20480
  ds_read_b64_tr_b16 v[158:159], v243 offset:21504
  v_mov_b32 v28, 0
  v_mov_b32 v29, 0
  s_waitcnt lgkmcnt(8)
  v_mfma_f32_32x32x16_bf16 v[112:127], v[140:143], v[192:195], v[112:127]
  v_mov_b32 v30, 0
  v_mov_b32 v31, 0
  s_waitcnt lgkmcnt(6)
  v_mfma_f32_32x32x16_bf16 v[64:79], v[144:147], v[196:199], v[64:79]
  ds_read_b64_tr_b16 v[128:129], v240 offset:24576
  ds_read_b64_tr_b16 v[130:131], v240 offset:25600
  ds_read_b64_tr_b16 v[132:133], v241 offset:24576
  v_mov_b32 v32, 0
  v_mov_b32 v33, 0
  s_waitcnt lgkmcnt(7)
  v_mfma_f32_32x32x16_bf16 v[80:95], v[148:151], v[196:199], v[80:95]
  ds_read_b64_tr_b16 v[134:135], v241 offset:25600
  ds_read_b64_tr_b16 v[136:137], v242 offset:24576
  ds_read_b64_tr_b16 v[138:139], v242 offset:25600
  v_mov_b32 v34, 0
  v_mov_b32 v35, 0
  s_waitcnt lgkmcnt(8)
  v_mfma_f32_32x32x16_bf16 v[96:111], v[152:155], v[196:199], v[96:111]
  ds_read_b64_tr_b16 v[140:141], v243 offset:24576
  ds_read_b64_tr_b16 v[142:143], v243 offset:25600
  v_mov_b32 v36, 0
  v_mov_b32 v37, 0
  s_waitcnt lgkmcnt(8)
  v_mfma_f32_32x32x16_bf16 v[112:127], v[156:159], v[196:199], v[112:127]
  v_mov_b32 v38, 0
  v_mov_b32 v39, 0
  s_waitcnt lgkmcnt(6)
  v_mfma_f32_32x32x16_bf16 v[64:79], v[128:131], v[200:203], v[64:79]
  ds_read_b64_tr_b16 v[144:145], v240 offset:28672
  ds_read_b64_tr_b16 v[146:147], v240 offset:29696
  ds_read_b64_tr_b16 v[148:149], v241 offset:28672
  v_mov_b32 v40, 0
  v_mov_b32 v41, 0
  s_waitcnt lgkmcnt(7)
  v_mfma_f32_32x32x16_bf16 v[80:95], v[132:135], v[200:203], v[80:95]
  ds_read_b64_tr_b16 v[150:151], v241 offset:29696
  ds_read_b64_tr_b16 v[152:153], v242 offset:28672
  ds_read_b64_tr_b16 v[154:155], v242 offset:29696
  v_mov_b32 v42, 0
  v_mov_b32 v43, 0
  s_waitcnt lgkmcnt(8)
  v_mfma_f32_32x32x16_bf16 v[96:111], v[136:139], v[200:203], v[96:111]
  ds_read_b64_tr_b16 v[156:157], v243 offset:28672
  ds_read_b64_tr_b16 v[158:159], v243 offset:29696
  v_mov_b32 v44, 0
  v_mov_b32 v45, 0
  s_waitcnt lgkmcnt(8)
  v_mfma_f32_32x32x16_bf16 v[112:127], v[140:143], v[200:203], v[112:127]
  v_mov_b32 v46, 0
  v_mov_b32 v47, 0
  s_waitcnt vmcnt(0) lgkmcnt(0)
  s_cmp_lg_u32 s3, 0
  s_cbranch_scc1 .Lok_kv
  v_readfirstlane_b32 s86, v250
  s_nop 0
  s_cmp_lt_u32 s86, 16
  s_cbranch_scc1 .Lspin_kv
.Lok_kv:
  v_xor_b32 v240, 0x8000, v240
  v_xor_b32 v241, 0x8000, v241
  v_xor_b32 v242, 0x8000, v242
  v_xor_b32 v243, 0x8000, v243
  v_mfma_f32_32x32x16_bf16 v[64:79], v[144:147], v[204:207], v[64:79]
  s_barrier
  ds_read_b64_tr_b16 v[128:129], v240 offset:0
  ds_read_b64_tr_b16 v[130:131], v240 offset:1024
  ds_read_b64_tr_b16 v[132:133], v241 offset:0
  ds_read_b64_tr_b16 v[134:135], v241 offset:1024
  v_mov_b32 v48, 0
  v_mov_b32 v49, 0
  v_mfma_f32_32x32x16_bf16 v[80:95], v[148:151], v[204:207], v[80:95]
  ds_read_b64_tr_b16 v[136:137], v242 offset:0
  ds_read_b64_tr_b16 v[138:139], v242 offset:1024
  ds_read_b64_tr_b16 v[140:141], v243 offset:0
  ds_read_b64_tr_b16 v[142:143], v243 offset:1024
  v_mov_b32 v50, 0
  v_mov_b32 v51, 0
  v_mfma_f32_32x32x16_bf16 v[96:111], v[152:155], v[204:207], v[96:111]
  s_cmp_lg_u32 s57, 0
  s_cbranch_scc1 .Lg0_q2
  s_add_u32 m0, s69, s78
  s_add_u32 s69, s69, 0x4000
  buffer_load_dwordx4 v226, s[32:35], s67 offen offset:0 sc1 lds
  buffer_load_dwordx4 v226, s[32:35], s67 offen offset:1024 sc1 lds
  buffer_load_dwordx4 v226, s[32:35], s67 offen offset:2048 sc1 lds
  buffer_load_dwordx4 v226, s[32:35], s67 offen offset:3072 sc1 lds
  s_and_b32 s69, s69, 0xffff
  s_add_u32 s67, s67, 0x4000
  s_add_u32 m0, s69, s78
  s_add_u32 s69, s69, 0x4000
  buffer_load_dwordx4 v226, s[32:35], s67 offen offset:0 sc1 lds
  buffer_load_dwordx4 v226, s[32:35], s67 offen offset:1024 sc1 lds
  buffer_load_dwordx4 v226, s[32:35], s67 offen offset:2048 sc1 lds
  buffer_load_dwordx4 v226, s[32:35], s67 offen offset:3072 sc1 lds
  s_and_b32 s69, s69, 0xffff
  s_add_u32 s67, s67, 0x4000
  s_add_u32 m0, s70, s77
  s_add_u32 s70, s70, 0x4000
  buffer_load_dwordx4 v226, s[36:39], s68 offen offset:0 sc1 lds
  buffer_load_dwordx4 v226, s[36:39], s68 offen offset:1024 sc1 lds
  buffer_load_dwordx4 v226, s[36:39], s68 offen offset:2048 sc1 lds
  buffer_load_dwordx4 v226, s[36:39], s68 offen offset:3072 sc1 lds
  s_and_b32 s70, s70, 0xffff
  s_add_u32 s68, s68, 0x4000
  s_add_u32 m0, s69, s78
  s_add_u32 s69, s69, 0x4000
  buffer_load_dwordx4 v226, s[32:35], s67 offen offset:0 sc1 lds
  buffer_load_dwordx4 v226, s[32:35], s67 offen offset:1024 sc1 lds
  buffer_load_dwordx4 v226, s[32:35], s67 offen offset:2048 sc1 lds
  buffer_load_dwordx4 v226, s[32:35], s67 offen offset:3072 sc1 lds
  s_and_b32 s69, s69, 0xffff
  s_add_u32 s67, s67, 0x4000
  s_add_u32 m0, s70, s77
  s_add_u32 s70, s70, 0x4000
  buffer_load_dwordx4 v226, s[36:39], s68 offen offset:0 sc1 lds
  buffer_load_dwordx4 v226, s[36:39], s68 offen offset:1024 sc1 lds
  buffer_load_dwordx4 v226, s[36:39], s68 offen offset:2048 sc1 lds
  buffer_load_dwordx4 v226, s[36:39], s68 offen offset:3072 sc1 lds
  s_and_b32 s70, s70, 0xffff
  s_add_u32 s68, s68, 0x4000
  s_add_u32 m0, s69, s78
  s_add_u32 s69, s69, 0x4000
  buffer_load_dwordx4 v226, s[32:35], s67 offen offset:0 sc1 lds
  buffer_load_dwordx4 v226, s[32:35], s67 offen offset:1024 sc1 lds
  buffer_load_dwordx4 v226, s[32:35], s67 offen offset:2048 sc1 lds
  buffer_load_dwordx4 v226, s[32:35], s67 offen offset:3072 sc1 lds
  s_and_b32 s69, s69, 0xffff
  s_add_u32 s67, s67, 0x4000
.Lg0_q2:
  v_mov_b32 v52, 0
  v_mov_b32 v53, 0
  v_mfma_f32_32x32x16_bf16 v[112:127], v[156:159], v[204:207], v[112:127]
  s_cmp_eq_u32 s62, 0
  s_cbranch_scc1 .Lhsig
  s_cmp_lg_u32 s3, 0
  s_cbranch_scc1 .Lsig_h
  s_lshl_b32 s88, s63, 7
  v_mov_b32 v234, s88
  s_mov_b64 exec, 1
  global_atomic_add v234, v253, s[16:17]
  s_mov_b64 exec, -1
.Lsig_h:
.Lhsig:
  v_mov_b32 v54, 0
  v_mov_b32 v55, 0
  s_waitcnt lgkmcnt(6)
  v_mfma_f32_32x32x16_bf16 v[64:79], v[128:131], v[176:179], v[64:79]
  ds_read_b64_tr_b16 v[144:145], v240 offset:4096
  ds_read_b64_tr_b16 v[146:147], v240 offset:5120
  ds_read_b64_tr_b16 v[148:149], v241 offset:4096
  v_mov_b32 v56, 0
  v_mov_b32 v57, 0
  s_waitcnt lgkmcnt(7)
  v_mfma_f32_32x32x16_bf16 v[80:95], v[132:135], v[176:179], v[80:95]
  ds_read_b64_tr_b16 v[150:151], v241 offset:5120
  ds_read_b64_tr_b16 v[152:153], v242 offset:4096
  ds_read_b64_tr_b16 v[154:155], v242 offset:5120
  v_mov_b32 v58, 0
  v_mov_b32 v59, 0
  s_waitcnt lgkmcnt(8)
  v_mfma_f32_32x32x16_bf16 v[96:111], v[136:139], v[176:179], v[96:111]
  ds_read_b64_tr_b16 v[156:157], v243 offset:4096
  ds_read_b64_tr_b16 v[158:159], v243 offset:5120
  v_mov_b32 v60, 0
  v_mov_b32 v61, 0
  s_waitcnt lgkmcnt(8)
  v_mfma_f32_32x32x16_bf16 v[112:127], v[140:143], v[176:179], v[112:127]
  v_mov_b32 v62, 0
  v_mov_b32 v63, 0
  s_waitcnt lgkmcnt(6)
  v_mfma_f32_32x32x16_bf16 v[64:79], v[144:147], v[180:183], v[64:79]
  ds_read_b64_tr_b16 v[128:129], v240 offset:8192
  ds_read_b64_tr_b16 v[130:131], v240 offset:9216
  ds_read_b64_tr_b16 v[132:133], v241 offset:8192
  s_waitcnt lgkmcnt(7)
  v_mfma_f32_32x32x16_bf16 v[80:95], v[148:151], v[180:183], v[80:95]
  ds_read_b64_tr_b16 v[134:135], v241 offset:9216
  ds_read_b64_tr_b16 v[136:137], v242 offset:8192
  ds_read_b64_tr_b16 v[138:139], v242 offset:9216
  s_waitcnt lgkmcnt(8)
  v_mfma_f32_32x32x16_bf16 v[96:111], v[152:155], v[180:183], v[96:111]
  ds_read_b64_tr_b16 v[140:141], v243 offset:8192
  ds_read_b64_tr_b16 v[142:143], v243 offset:9216
  s_waitcnt lgkmcnt(8)
  v_mfma_f32_32x32x16_bf16 v[112:127], v[156:159], v[180:183], v[112:127]
  s_waitcnt lgkmcnt(6)
  v_mfma_f32_32x32x16_bf16 v[64:79], v[128:131], v[184:187], v[64:79]
  ds_read_b64_tr_b16 v[144:145], v240 offset:12288
  ds_read_b64_tr_b16 v[146:147], v240 offset:13312
  ds_read_b64_tr_b16 v[148:149], v241 offset:12288
  s_waitcnt lgkmcnt(7)
  v_mfma_f32_32x32x16_bf16 v[80:95], v[132:135], v[184:187], v[80:95]
  ds_read_b64_tr_b16 v[150:151], v241 offset:13312
  ds_read_b64_tr_b16 v[152:153], v242 offset:12288
  ds_read_b64_tr_b16 v[154:155], v242 offset:13312
  s_waitcnt lgkmcnt(8)
  v_mfma_f32_32x32x16_bf16 v[96:111], v[136:139], v[184:187], v[96:111]
  ds_read_b64_tr_b16 v[156:157], v243 offset:12288
  ds_read_b64_tr_b16 v[158:159], v243 offset:13312
  s_waitcnt lgkmcnt(8)
  v_mfma_f32_32x32x16_bf16 v[112:127], v[140:143], v[184:187], v[112:127]
  s_waitcnt lgkmcnt(6)
  v_mfma_f32_32x32x16_bf16 v[64:79], v[144:147], v[188:191], v[64:79]
  ds_read_b64_tr_b16 v[128:129], v240 offset:16384
  ds_read_b64_tr_b16 v[130:131], v240 offset:17408
  ds_read_b64_tr_b16 v[132:133], v241 offset:16384
  s_waitcnt lgkmcnt(7)
  v_mfma_f32_32x32x16_bf16 v[80:95], v[148:151], v[188:191], v[80:95]
  ds_read_b64_tr_b16 v[134:135], v241 offset:17408
  ds_read_b64_tr_b16 v[136:137], v242 offset:16384
  ds_read_b64_tr_b16 v[138:139], v242 offset:17408
  s_waitcnt lgkmcnt(8)
  v_mfma_f32_32x32x16_bf16 v[96:111], v[152:155], v[188:191], v[96:111]
  ds_read_b64_tr_b16 v[140:141], v243 offset:16384
  ds_read_b64_tr_b16 v[142:143], v243 offset:17408
  s_waitcnt lgkmcnt(8)
  v_mfma_f32_32x32x16_bf16 v[112:127], v[156:159], v[188:191], v[112:127]
  s_waitcnt lgkmcnt(6)
  v_mfma_f32_32x32x16_bf16 v[64:79], v[128:131], v[208:211], v[64:79]
  ds_read_b64_tr_b16 v[144:145], v240 offset:20480
  ds_read_b64_tr_b16 v[146:147], v240 offset:21504
  ds_read_b64_tr_b16 v[148:149], v241 offset:20480
  s_waitcnt lgkmcnt(7)
  v_mfma_f32_32x32x16_bf16 v[80:95], v[132:135], v[208:211], v[80:95]
  ds_read_b64_tr_b16 v[150:151], v241 offset:21504
  ds_read_b64_tr_b16 v[152:153], v242 offset:20480
  ds_read_b64_tr_b16 v[154:155], v242 offset:21504
  s_waitcnt lgkmcnt(8)
  v_mfma_f32_32x32x16_bf16 v[96:111], v[136:139], v[208:211], v[96:111]
  ds_read_b64_tr_b16 v[156:157], v243 offset:20480
  ds_read_b64_tr_b16 v[158:159], v243 offset:21504
  s_waitcnt lgkmcnt(8)
  v_mfma_f32_32x32x16_bf16 v[112:127], v[140:143], v[208:211], v[112:127]
  s_waitcnt lgkmcnt(6)
  v_mfma_f32_32x32x16_bf16 v[64:79], v[144:147], v[212:215], v[64:79]
  ds_read_b64_tr_b16 v[128:129], v240 offset:24576
  ds_read_b64_tr_b16 v[130:131], v240 offset:25600
  ds_read_b64_tr_b16 v[132:133], v241 offset:24576
  s_waitcnt lgkmcnt(7)
  v_mfma_f32_32x32x16_bf16 v[80:95], v[148:151], v[212:215], v[80:95]
  ds_read_b64_tr_b16 v[134:135], v241 offset:25600
  ds_read_b64_tr_b16 v[136:137], v242 offset:24576
  ds_read_b64_tr_b16 v[138:139], v242 offset:25600
  s_waitcnt lgkmcnt(8)
  v_mfma_f32_32x32x16_bf16 v[96:111], v[152:155], v[212:215], v[96:111]
  ds_read_b64_tr_b16 v[140:141], v243 offset:24576
  ds_read_b64_tr_b16 v[142:143], v243 offset:25600
  s_waitcnt lgkmcnt(8)
  v_mfma_f32_32x32x16_bf16 v[112:127], v[156:159], v[212:215], v[112:127]
  s_waitcnt lgkmcnt(6)
  v_mfma_f32_32x32x16_bf16 v[64:79], v[128:131], v[216:219], v[64:79]
  ds_read_b64_tr_b16 v[144:145], v240 offset:28672
  ds_read_b64_tr_b16 v[146:147], v240 offset:29696
  ds_read_b64_tr_b16 v[148:149], v241 offset:28672
  s_waitcnt lgkmcnt(7)
  v_mfma_f32_32x32x16_bf16 v[80:95], v[132:135], v[216:219], v[80:95]
  ds_read_b64_tr_b16 v[150:151], v241 offset:29696
  ds_read_b64_tr_b16 v[152:153], v242 offset:28672
  ds_read_b64_tr_b16 v[154:155], v242 offset:29696
  s_waitcnt lgkmcnt(8)
  v_mfma_f32_32x32x16_bf16 v[96:111], v[136:139], v[216:219], v[96:111]
  ds_read_b64_tr_b16 v[156:157], v243 offset:28672
  ds_read_b64_tr_b16 v[158:159], v243 offset:29696
  s_waitcnt lgkmcnt(8)
  v_mfma_f32_32x32x16_bf16 v[112:127], v[140:143], v[216:219], v[112:127]
  s_waitcnt vmcnt(16) lgkmcnt(0)
  v_mfma_f32_32x32x16_bf16 v[64:79], v[144:147], v[220:223], v[64:79]
  s_barrier
  v_mfma_f32_32x32x16_bf16 v[80:95], v[148:151], v[220:223], v[80:95]
  ds_read_b128 v[192:195], v224 offset:0
  ds_read_b128 v[196:199], v224 offset:1024
  ds_read_b128 v[200:203], v224 offset:2048
  ds_read_b128 v[204:207], v224 offset:3072
  v_mfma_f32_32x32x16_bf16 v[96:111], v[152:155], v[220:223], v[96:111]
  s_cmp_lg_u32 s57, 0
  s_cbranch_scc1 .Lg0_q3
  s_add_u32 m0, s70, s77
  s_add_u32 s70, s70, 0x4000
  buffer_load_dwordx4 v226, s[36:39], s68 offen offset:0 sc1 lds
  buffer_load_dwordx4 v226, s[36:39], s68 offen offset:1024 sc1 lds
  buffer_load_dwordx4 v226, s[36:39], s68 offen offset:2048 sc1 lds
  buffer_load_dwordx4 v226, s[36:39], s68 offen offset:3072 sc1 lds
  s_and_b32 s70, s70, 0xffff
  s_add_u32 s68, s68, 0x4000
.Lg0_q3:
  v_mfma_f32_32x32x16_bf16 v[112:127], v[156:159], v[220:223], v[112:127]
  ds_read_b128 v[208:211], v224 offset:4096
  ds_read_b128 v[212:215], v224 offset:5120
  ds_read_b128 v[216:219], v224 offset:6144
  ds_read_b128 v[220:223], v224 offset:7168
  s_nop 5
  v_pk_mul_f32 v[64:65], v[64:65], s[74:75]
  v_pk_mul_f32 v[66:67], v[66:67], s[74:75]
  v_pk_mul_f32 v[68:69], v[68:69], s[74:75]
  v_pk_mul_f32 v[70:71], v[70:71], s[74:75]
  v_pk_mul_f32 v[72:73], v[72:73], s[74:75]
  v_pk_mul_f32 v[74:75], v[74:75], s[74:75]
  v_pk_mul_f32 v[76:77], v[76:77], s[74:75]
  v_pk_mul_f32 v[78:79], v[78:79], s[74:75]
  v_cvt_pk_bf16_f32 v128, v64, v65
  v_cvt_pk_bf16_f32 v129, v66, v67
  v_cvt_pk_bf16_f32 v130, v68, v69
  v_cvt_pk_bf16_f32 v131, v70, v71
  v_cvt_pk_bf16_f32 v132, v72, v73
  v_cvt_pk_bf16_f32 v133, v74, v75
  v_cvt_pk_bf16_f32 v134, v76, v77
  v_cvt_pk_bf16_f32 v135, v78, v79
  v_pk_mul_f32 v[80:81], v[80:81], s[74:75]
  v_pk_mul_f32 v[82:83], v[82:83], s[74:75]
  v_pk_mul_f32 v[84:85], v[84:85], s[74:75]
  v_pk_mul_f32 v[86:87], v[86:87], s[74:75]
  v_pk_mul_f32 v[88:89], v[88:89], s[74:75]
  v_pk_mul_f32 v[90:91], v[90:91], s[74:75]
  v_pk_mul_f32 v[92:93], v[92:93], s[74:75]
  v_pk_mul_f32 v[94:95], v[94:95], s[74:75]
  v_cvt_pk_bf16_f32 v136, v80, v81
  v_cvt_pk_bf16_f32 v137, v82, v83
  v_cvt_pk_bf16_f32 v138, v84, v85
  v_cvt_pk_bf16_f32 v139, v86, v87
  v_cvt_pk_bf16_f32 v140, v88, v89
  v_cvt_pk_bf16_f32 v141, v90, v91
  v_cvt_pk_bf16_f32 v142, v92, v93
  v_cvt_pk_bf16_f32 v143, v94, v95
  v_pk_mul_f32 v[96:97], v[96:97], s[74:75]
  v_pk_mul_f32 v[98:99], v[98:99], s[74:75]
  v_pk_mul_f32 v[100:101], v[100:101], s[74:75]
  v_pk_mul_f32 v[102:103], v[102:103], s[74:75]
  v_pk_mul_f32 v[104:105], v[104:105], s[74:75]
  v_pk_mul_f32 v[106:107], v[106:107], s[74:75]
  v_pk_mul_f32 v[108:109], v[108:109], s[74:75]
  v_pk_mul_f32 v[110:111], v[110:111], s[74:75]
  v_cvt_pk_bf16_f32 v144, v96, v97
  v_cvt_pk_bf16_f32 v145, v98, v99
  v_cvt_pk_bf16_f32 v146, v100, v101
  v_cvt_pk_bf16_f32 v147, v102, v103
  v_cvt_pk_bf16_f32 v148, v104, v105
  v_cvt_pk_bf16_f32 v149, v106, v107
  v_cvt_pk_bf16_f32 v150, v108, v109
  v_cvt_pk_bf16_f32 v151, v110, v111
  v_pk_mul_f32 v[112:113], v[112:113], s[74:75]
  v_pk_mul_f32 v[114:115], v[114:115], s[74:75]
  v_pk_mul_f32 v[116:117], v[116:117], s[74:75]
  v_pk_mul_f32 v[118:119], v[118:119], s[74:75]
  v_pk_mul_f32 v[120:121], v[120:121], s[74:75]
  v_pk_mul_f32 v[122:123], v[122:123], s[74:75]
  v_pk_mul_f32 v[124:125], v[124:125], s[74:75]
  v_pk_mul_f32 v[126:127], v[126:127], s[74:75]
  v_cvt_pk_bf16_f32 v152, v112, v113
  v_cvt_pk_bf16_f32 v153, v114, v115
  v_cvt_pk_bf16_f32 v154, v116, v117
  v_cvt_pk_bf16_f32 v155, v118, v119
  v_cvt_pk_bf16_f32 v156, v120, v121
  v_cvt_pk_bf16_f32 v157, v122, v123
  v_cvt_pk_bf16_f32 v158, v124, v125
  v_cvt_pk_bf16_f32 v159, v126, v127
  s_cmp_lg_u32 s57, 0
  s_cbranch_scc1 .Lat1_first
.Lat0_first:
  s_waitcnt lgkmcnt(7)
  v_mfma_f32_32x32x16_bf16 v[64:79], v[192:195], v[128:131], 0
  ds_read_b128 v[192:195], v224 offset:8192
  s_waitcnt lgkmcnt(7)
  v_mfma_f32_32x32x16_bf16 v[64:79], v[196:199], v[132:135], v[64:79]
  ds_read_b128 v[196:199], v224 offset:9216
  s_waitcnt lgkmcnt(7)
  v_mfma_f32_32x32x16_bf16 v[64:79], v[200:203], v[136:139], v[64:79]
  ds_read_b128 v[200:203], v224 offset:10240
  s_waitcnt lgkmcnt(7)
  v_mfma_f32_32x32x16_bf16 v[64:79], v[204:207], v[140:143], v[64:79]
  ds_read_b128 v[204:207], v224 offset:11264
  s_waitcnt lgkmcnt(7)
  v_mfma_f32_32x32x16_bf16 v[64:79], v[208:211], v[144:147], v[64:79]
  ds_read_b128 v[208:211], v224 offset:12288
  s_waitcnt lgkmcnt(7)
  v_mfma_f32_32x32x16_bf16 v[64:79], v[212:215], v[148:151], v[64:79]
  ds_read_b128 v[212:215], v224 offset:13312
  s_waitcnt lgkmcnt(7)
  v_mfma_f32_32x32x16_bf16 v[64:79], v[216:219], v[152:155], v[64:79]
  ds_read_b128 v[216:219], v224 offset:14336
  s_waitcnt lgkmcnt(7)
  v_mfma_f32_32x32x16_bf16 v[64:79], v[220:223], v[156:159], v[64:79]
  ds_read_b128 v[220:223], v224 offset:15360
  v_add_u32 v224, 0x4000, v224
  v_and_b32 v224, 0xffff, v224
  v_or_b32 v224, 0x10000, v224
  s_waitcnt lgkmcnt(7)
  v_mfma_f32_32x32x16_bf16 v[80:95], v[192:195], v[128:131], 0
  ds_read_b128 v[192:195], v224 offset:0
  s_waitcnt lgkmcnt(7)
  v_mfma_f32_32x32x16_bf16 v[80:95], v[196:199], v[132:135], v[80:95]
  ds_read_b128 v[196:199], v224 offset:1024
  s_waitcnt lgkmcnt(7)
  v_mfma_f32_32x32x16_bf16 v[80:95], v[200:203], v[136:139], v[80:95]
  ds_read_b128 v[200:203], v224 offset:2048
  s_waitcnt lgkmcnt(7)
  v_mfma_f32_32x32x16_bf16 v[80:95], v[204:207], v[140:143], v[80:95]
  ds_read_b128 v[204:207], v224 offset:3072
  s_waitcnt lgkmcnt(7)
  v_mfma_f32_32x32x16_bf16 v[80:95], v[208:211], v[144:147], v[80:95]
  ds_read_b128 v[208:211], v224 offset:4096
  v_max3_f32 v230, v64, v65, v66
  v_max3_f32 v230, v230, v67, v68
  s_waitcnt lgkmcnt(7)
  v_mfma_f32_32x32x16_bf16 v[80:95], v[212:215], v[148:151], v[80:95]
  ds_read_b128 v[212:215], v224 offset:5120
  v_max3_f32 v230, v230, v69, v70
  v_max3_f32 v230, v230, v71, v72
  s_waitcnt lgkmcnt(7)
  v_mfma_f32_32x32x16_bf16 v[80:95], v[216:219], v[152:155], v[80:95]
  ds_read_b128 v[216:219], v224 offset:6144
  v_max3_f32 v230, v230, v73, v74
  v_max3_f32 v230, v230, v75, v76
  s_waitcnt lgkmcnt(7)
  v_mfma_f32_32x32x16_bf16 v[80:95], v[220:223], v[156:159], v[80:95]
  ds_read_b128 v[220:223], v224 offset:7168
  v_max3_f32 v230, v230, v77, v78
  v_max_f32 v230, v230, v79
  s_waitcnt vmcnt(8)
  s_barrier
  s_cmp_lg_u32 s71, 0
  s_cbranch_scc1 .Lat_nomask
  s_nop 7
  v_cmp_gt_i32 vcc, 0, v233
  v_cmp_gt_i32 s[80:81], 1, v233
  v_cmp_gt_i32 s[82:83], 2, v233
  v_cmp_gt_i32 s[84:85], 3, v233
  v_cndmask_b32 v64, v64, v238, vcc
  v_cmp_gt_i32 vcc, 8, v233
  v_cndmask_b32 v65, v65, v238, s[80:81]
  v_cmp_gt_i32 s[80:81], 9, v233
  v_cndmask_b32 v66, v66, v238, s[82:83]
  v_cmp_gt_i32 s[82:83], 10, v233
  v_cndmask_b32 v67, v67, v238, s[84:85]
  v_cmp_gt_i32 s[84:85], 11, v233
  v_cndmask_b32 v68, v68, v238, vcc
  v_cmp_gt_i32 vcc, 16, v233
  v_cndmask_b32 v69, v69, v238, s[80:81]
  v_cmp_gt_i32 s[80:81], 17, v233
  v_cndmask_b32 v70, v70, v238, s[82:83]
  v_cmp_gt_i32 s[82:83], 18, v233
  v_cndmask_b32 v71, v71, v238, s[84:85]
  v_cmp_gt_i32 s[84:85], 19, v233
  v_cndmask_b32 v72, v72, v238, vcc
  v_cmp_gt_i32 vcc, 24, v233
  v_cndmask_b32 v73, v73, v238, s[80:81]
  v_cmp_gt_i32 s[80:81], 25, v233
  v_cndmask_b32 v74, v74, v238, s[82:83]
  v_cmp_gt_i32 s[82:83], 26, v233
  v_cndmask_b32 v75, v75, v238, s[84:85]
  v_cmp_gt_i32 s[84:85], 27, v233
  v_cndmask_b32 v76, v76, v238, vcc
  v_cmp_gt_i32 vcc, 32, v233
  v_cndmask_b32 v77, v77, v238, s[80:81]
  v_cmp_gt_i32 s[80:81], 33, v233
  v_cndmask_b32 v78, v78, v238, s[82:83]
  v_cmp_gt_i32 s[82:83], 34, v233
  v_cndmask_b32 v79, v79, v238, s[84:85]
  v_cmp_gt_i32 s[84:85], 35, v233
  v_cndmask_b32 v80, v80, v238, vcc
  v_cmp_gt_i32 vcc, 40, v233
  v_cndmask_b32 v81, v81, v238, s[80:81]
  v_cmp_gt_i32 s[80:81], 41, v233
  v_cndmask_b32 v82, v82, v238, s[82:83]
  v_cmp_gt_i32 s[82:83], 42, v233
  v_cndmask_b32 v83, v83, v238, s[84:85]
  v_cmp_gt_i32 s[84:85], 43, v233
  v_cndmask_b32 v84, v84, v238, vcc
  v_cmp_gt_i32 vcc, 48, v233
  v_cndmask_b32 v85, v85, v238, s[80:81]
  v_cmp_gt_i32 s[80:81], 49, v233
  v_cndmask_b32 v86, v86, v238, s[82:83]
  v_cmp_gt_i32 s[82:83], 50, v233
  v_cndmask_b32 v87, v87, v238, s[84:85]
  v_cmp_gt_i32 s[84:85], 51, v233
  v_cndmask_b32 v88, v88, v238, vcc
  v_cmp_gt_i32 vcc, 56, v233
  v_cndmask_b32 v89, v89, v238, s[80:81]
  v_cmp_gt_i32 s[80:81], 57, v233
  v_cndmask_b32 v90, v90, v238, s[82:83]
  v_cmp_gt_i32 s[82:83], 58, v233
  v_cndmask_b32 v91, v91, v238, s[84:85]
  v_cmp_gt_i32 s[84:85], 59, v233
  v_cndmask_b32 v92, v92, v238, vcc
  v_cndmask_b32 v93, v93, v238, s[80:81]
  v_cndmask_b32 v94, v94, v238, s[82:83]
  v_cndmask_b32 v95, v95, v238, s[84:85]
  v_max3_f32 v230, v64, v65, v66
  v_max3_f32 v230, v230, v67, v68
  v_max3_f32 v230, v230, v69, v70
  v_max3_f32 v230, v230, v71, v72
  v_max3_f32 v230, v230, v73, v74
  v_max3_f32 v230, v230, v75, v76
  v_max3_f32 v230, v230, v77, v78
  v_max_f32 v230, v230, v79
.Lat_nomask:
  s_nop 4
  v_max3_f32 v231, v80, v81, v82
  v_max3_f32 v231, v231, v83, v84
  v_max3_f32 v231, v231, v85, v86
  v_max3_f32 v231, v231, v87, v88
  v_max3_f32 v231, v231, v89, v90
  v_max3_f32 v231, v231, v91, v92
  v_max3_f32 v231, v231, v93, v94
  v_max3_f32 v231, v231, v95, v230
  v_mov_b32 v235, v231
  s_nop 1
  v_permlane32_swap_b32 v231, v235
  v_max_f32 v231, v231, v235
  v_sub_f32 v176, 0, v231
  v_sub_f32 v64, v64, v231
  v_sub_f32 v65, v65, v231
  v_sub_f32 v66, v66, v231
  v_sub_f32 v67, v67, v231
  v_sub_f32 v68, v68, v231
  v_sub_f32 v69, v69, v231
  v_sub_f32 v70, v70, v231
  v_sub_f32 v71, v71, v231
  v_sub_f32 v72, v72, v231
  v_sub_f32 v73, v73, v231
  v_sub_f32 v74, v74, v231
  v_sub_f32 v75, v75, v231
  v_sub_f32 v76, v76, v231
  v_sub_f32 v77, v77, v231
  v_sub_f32 v78, v78, v231
  v_sub_f32 v79, v79, v231
  v_sub_f32 v80, v80, v231
  v_sub_f32 v81, v81, v231
  v_sub_f32 v82, v82, v231
  v_sub_f32 v83, v83, v231
  v_sub_f32 v84, v84, v231
  v_sub_f32 v85, v85, v231
  v_sub_f32 v86, v86, v231
  v_sub_f32 v87, v87, v231
  v_sub_f32 v88, v88, v231
  v_sub_f32 v89, v89, v231
  v_sub_f32 v90, v90, v231
  v_sub_f32 v91, v91, v231
  v_sub_f32 v92, v92, v231
  v_sub_f32 v93, v93, v231
  v_sub_f32 v94, v94, v231
  v_sub_f32 v95, v95, v231
  v_mov_b32 v177, v176
  v_mov_b32 v178, v176
  v_mov_b32 v179, v176
  v_mov_b32 v180, v176
  v_mov_b32 v181, v176
  v_mov_b32 v182, v176
  v_mov_b32 v183, v176
  v_mov_b32 v184, v176
  v_mov_b32 v185, v176
  v_mov_b32 v186, v176
  v_mov_b32 v187, v176
  v_mov_b32 v188, v176
  v_mov_b32 v189, v176
  v_mov_b32 v190, v176
  v_mov_b32 v191, v176
  s_waitcnt lgkmcnt(4)
  s_cmp_eq_u32 s71, 0
  s_cbranch_scc1 .Lat0_tail0
  s_cmp_eq_u32 s71, 1
  s_cbranch_scc1 .Lat0_mask0
.Lat0_loop:
  v_mfma_f32_32x32x16_bf16 v[96:111], v[192:195], v[128:131], v[176:191]
  ds_read_b128 v[192:195], v224 offset:8192
  v_exp_f32 v64, v64
  v_exp_f32 v65, v65
  v_add_f32 v228, v228, v64
  v_mfma_f32_32x32x16_bf16 v[96:111], v[196:199], v[132:135], v[96:111]
  ds_read_b128 v[196:199], v224 offset:9216
  v_exp_f32 v66, v66
  v_exp_f32 v67, v67
  v_cvt_pk_bf16_f32 v160, v64, v65
  s_add_u32 m0, s70, s77
  s_add_u32 s70, s70, 0x4000
  v_mfma_f32_32x32x16_bf16 v[96:111], v[200:203], v[136:139], v[96:111]
  ds_read_b128 v[200:203], v224 offset:10240
  v_exp_f32 v68, v68
  v_exp_f32 v69, v69
  v_cvt_pk_bf16_f32 v161, v66, v67
  v_mfma_f32_32x32x16_bf16 v[96:111], v[204:207], v[140:143], v[96:111]
  ds_read_b128 v[204:207], v224 offset:11264
  v_exp_f32 v70, v70
  v_exp_f32 v71, v71
  buffer_load_dwordx4 v226, s[36:39], s68 offen offset:0 sc1 lds
  buffer_load_dwordx4 v226, s[36:39], s68 offen offset:1024 sc1 lds
  s_waitcnt lgkmcnt(4)
  v_mfma_f32_32x32x16_bf16 v[96:111], v[208:211], v[144:147], v[96:111]
  ds_read_b128 v[208:211], v224 offset:12288
  v_cvt_pk_bf16_f32 v162, v68, v69
  v_cvt_pk_bf16_f32 v163, v70, v71
  v_exp_f32 v72, v72
  v_add_f32 v229, v229, v65
  v_mfma_f32_32x32x16_bf16 v[96:111], v[212:215], v[148:151], v[96:111]
  ds_read_b128 v[212:215], v224 offset:13312
  v_exp_f32 v73, v73
  v_exp_f32 v74, v74
  v_cvt_pk_bf16_f32 v164, v72, v73
  buffer_load_dwordx4 v226, s[36:39], s68 offen offset:2048 sc1 lds
  buffer_load_dwordx4 v226, s[36:39], s68 offen offset:3072 sc1 lds
  v_mfma_f32_32x32x16_bf16 v[96:111], v[216:219], v[152:155], v[96:111]
  ds_read_b128 v[216:219], v224 offset:14336
  v_exp_f32 v75, v75
  v_exp_f32 v76, v76
  v_cvt_pk_bf16_f32 v165, v74, v75
  v_mfma_f32_32x32x16_bf16 v[96:111], v[220:223], v[156:159], v[96:111]
  ds_read_b128 v[220:223], v224 offset:15360
  v_exp_f32 v77, v77
  v_exp_f32 v78, v78
  s_and_b32 s70, s70, 0xffff
  s_add_u32 s68, s68, 0x4000
  s_waitcnt lgkmcnt(4)
  v_mfma_f32_32x32x16_bf16 v[112:127], v[192:195], v[128:131], v[176:191]
  ds_read_b128 v[192:195], v225 offset:0
  v_add_u32 v224, 0x4000, v224
  v_and_b32 v224, 0xffff, v224
  v_or_b32 v224, 0x10000, v224
  v_exp_f32 v79, v79
  v_mfma_f32_32x32x16_bf16 v[112:127], v[196:199], v[132:135], v[112:127]
  ds_read_b128 v[196:199], v225 offset:2048
  v_cvt_pk_bf16_f32 v166, v76, v77
  v_cvt_pk_bf16_f32 v167, v78, v79
  v_exp_f32 v80, v80
  v_add_f32 v228, v228, v66
  s_add_u32 m0, s69, s78
  s_add_u32 s69, s69, 0x4000
  v_mfma_f32_32x32x16_bf16 v[112:127], v[200:203], v[136:139], v[112:127]
  ds_read_b128 v[200:203], v225 offset:4096
  v_exp_f32 v81, v81
  v_exp_f32 v82, v82
  v_cvt_pk_bf16_f32 v168, v80, v81
  v_mfma_f32_32x32x16_bf16 v[112:127], v[204:207], v[140:143], v[112:127]
  ds_read_b128 v[204:207], v225 offset:6144
  v_exp_f32 v83, v83
  v_exp_f32 v84, v84
  buffer_load_dwordx4 v226, s[32:35], s67 offen offset:0 sc1 lds
  buffer_load_dwordx4 v226, s[32:35], s67 offen offset:1024 sc1 lds
  s_waitcnt lgkmcnt(4)
  v_mfma_f32_32x32x16_bf16 v[112:127], v[208:211], v[144:147], v[112:127]
  ds_read_b128 v[208:211], v225 offset:1024
  v_exp_f32 v85, v85
  v_exp_f32 v86, v86
  v_cvt_pk_bf16_f32 v169, v82, v83
  v_mfma_f32_32x32x16_bf16 v[112:127], v[212:215], v[148:151], v[112:127]
  ds_read_b128 v[212:215], v225 offset:3072
  v_exp_f32 v87, v87
  v_cvt_pk_bf16_f32 v170, v84, v85
  v_cvt_pk_bf16_f32 v171, v86, v87
  v_max3_f32 v230, v96, v97, v98
  buffer_load_dwordx4 v226, s[32:35], s67 offen offset:2048 sc1 lds
  buffer_load_dwordx4 v226, s[32:35], s67 offen offset:3072 sc1 lds
  v_mfma_f32_32x32x16_bf16 v[112:127], v[216:219], v[152:155], v[112:127]
  ds_read_b128 v[216:219], v225 offset:5120
  v_exp_f32 v88, v88
  v_exp_f32 v89, v89
  v_max3_f32 v230, v230, v99, v100
  v_mfma_f32_32x32x16_bf16 v[112:127], v[220:223], v[156:159], v[112:127]
  ds_read_b128 v[220:223], v225 offset:7168
  v_exp_f32 v90, v90
  v_exp_f32 v91, v91
  s_and_b32 s69, s69, 0xffff
  s_add_u32 s67, s67, 0x4000
  s_waitcnt lgkmcnt(4)
  v_mfma_f32_32x32x16_bf16 v[0:15], v[192:195], v[160:163], v[0:15]
  ds_read_b128 v[192:195], v225 offset:8192
  v_exp_f32 v92, v92
  v_exp_f32 v93, v93
  v_cvt_pk_bf16_f32 v172, v88, v89
  v_mfma_f32_32x32x16_bf16 v[16:31], v[196:199], v[160:163], v[16:31]
  ds_read_b128 v[196:199], v225 offset:10240
  v_exp_f32 v94, v94
  v_exp_f32 v95, v95
  v_cvt_pk_bf16_f32 v173, v90, v91
  v_mfma_f32_32x32x16_bf16 v[32:47], v[200:203], v[160:163], v[32:47]
  ds_read_b128 v[200:203], v225 offset:12288
  v_cvt_pk_bf16_f32 v174, v92, v93
  v_cvt_pk_bf16_f32 v175, v94, v95
  v_max3_f32 v230, v230, v101, v102
  v_add_f32 v229, v229, v67
  v_max3_f32 v230, v230, v103, v104
  v_mfma_f32_32x32x16_bf16 v[48:63], v[204:207], v[160:163], v[48:63]
  ds_read_b128 v[204:207], v225 offset:14336
  v_max3_f32 v230, v230, v105, v106
  v_add_f32 v228, v228, v68
  v_max3_f32 v230, v230, v107, v108
  v_add_f32 v229, v229, v69
  s_waitcnt lgkmcnt(4)
  v_mfma_f32_32x32x16_bf16 v[0:15], v[208:211], v[164:167], v[0:15]
  ds_read_b128 v[208:211], v225 offset:9216
  v_max3_f32 v230, v230, v109, v110
  v_add_f32 v228, v228, v70
  v_max_f32 v230, v230, v111
  v_add_f32 v229, v229, v71
  v_max3_f32 v231, v112, v113, v114
  v_mfma_f32_32x32x16_bf16 v[16:31], v[212:215], v[164:167], v[16:31]
  ds_read_b128 v[212:215], v225 offset:11264
  v_max3_f32 v231, v231, v115, v116
  v_add_f32 v228, v228, v72
  v_max3_f32 v231, v231, v117, v118
  v_add_f32 v229, v229, v73
  v_max3_f32 v231, v231, v119, v120
  v_mfma_f32_32x32x16_bf16 v[32:47], v[216:219], v[164:167], v[32:47]
  ds_read_b128 v[216:219], v225 offset:13312
  v_max3_f32 v231, v231, v121, v122
  v_add_f32 v228, v228, v74
  v_max3_f32 v231, v231, v123, v124
  v_add_f32 v229, v229, v75
  v_max3_f32 v231, v231, v125, v126
  v_mfma_f32_32x32x16_bf16 v[48:63], v[220:223], v[164:167], v[48:63]
  ds_read_b128 v[220:223], v225 offset:15360
  v_max3_f32 v231, v231, v127, v230
  v_add_f32 v228, v228, v76
  v_add_f32 v229, v229, v77
  v_add_f32 v228, v228, v78
  s_waitcnt lgkmcnt(4)
  v_mfma_f32_32x32x16_bf16 v[0:15], v[192:195], v[168:171], v[0:15]
  ds_read_b128 v[192:195], v224 offset:0
  v_add_u32 v225, 0x4000, v225
  v_and_b32 v225, 0xffff, v225
  v_add_f32 v229, v229, v79
  v_add_f32 v228, v228, v80
  v_add_f32 v229, v229, v81
  v_mfma_f32_32x32x16_bf16 v[16:31], v[196:199], v[168:171], v[16:31]
  ds_read_b128 v[196:199], v224 offset:1024
  v_add_f32 v228, v228, v82
  v_add_f32 v229, v229, v83
  v_add_f32 v228, v228, v84
  v_add_f32 v229, v229, v85
  v_add_f32 v228, v228, v86
  v_mfma_f32_32x32x16_bf16 v[32:47], v[200:203], v[168:171], v[32:47]
  ds_read_b128 v[200:203], v224 offset:2048
  v_add_f32 v229, v229, v87
  v_add_f32 v228, v228, v88
  v_add_f32 v229, v229, v89
  v_add_f32 v228, v228, v90
  v_add_f32 v229, v229, v91
  v_mfma_f32_32x32x16_bf16 v[48:63], v[204:207], v[168:171], v[48:63]
  ds_read_b128 v[204:207], v224 offset:3072
  v_add_f32 v228, v228, v92
  v_add_f32 v229, v229, v93
  v_add_f32 v228, v228, v94
  v_add_f32 v229, v229, v95
  s_waitcnt lgkmcnt(4)
  v_mfma_f32_32x32x16_bf16 v[0:15], v[208:211], v[172:175], v[0:15]
  ds_read_b128 v[208:211], v224 offset:4096
  v_mfma_f32_32x32x16_bf16 v[16:31], v[212:215], v[172:175], v[16:31]
  ds_read_b128 v[212:215], v224 offset:5120
  v_mfma_f32_32x32x16_bf16 v[32:47], v[216:219], v[172:175], v[32:47]
  ds_read_b128 v[216:219], v224 offset:6144
  v_mfma_f32_32x32x16_bf16 v[48:63], v[220:223], v[172:175], v[48:63]
  ds_read_b128 v[220:223], v224 offset:7168
  s_waitcnt vmcnt(8)
  s_barrier
  s_waitcnt lgkmcnt(4)
  v_cmp_lt_f32 vcc, s76, v231
  s_cbranch_vccnz .Lat0_rarea
.Lat0_backa:
  s_sub_u32 s71, s71, 1
  s_cmp_eq_u32 s71, 1
  s_cbranch_scc1 .Lat0_mask1
  v_mfma_f32_32x32x16_bf16 v[64:79], v[192:195], v[128:131], v[176:191]
  ds_read_b128 v[192:195], v224 offset:8192
  v_exp_f32 v96, v96
  v_exp_f32 v97, v97
  v_add_f32 v228, v228, v96
  v_mfma_f32_32x32x16_bf16 v[64:79], v[196:199], v[132:135], v[64:79]
  ds_read_b128 v[196:199], v224 offset:9216
  v_exp_f32 v98, v98
  v_exp_f32 v99, v99
  v_cvt_pk_bf16_f32 v160, v96, v97
  s_add_u32 m0, s70, s77
  s_add_u32 s70, s70, 0x4000
  v_mfma_f32_32x32x16_bf16 v[64:79], v[200:203], v[136:139], v[64:79]
  ds_read_b128 v[200:203], v224 offset:10240
  v_exp_f32 v100, v100
  v_exp_f32 v101, v101
  v_cvt_pk_bf16_f32 v161, v98, v99
  v_mfma_f32_32x32x16_bf16 v[64:79], v[204:207], v[140:143], v[64:79]
  ds_read_b128 v[204:207], v224 offset:11264
  v_exp_f32 v102, v102
  v_exp_f32 v103, v103
  buffer_load_dwordx4 v226, s[36:39], s68 offen offset:0 sc1 lds
  buffer_load_dwordx4 v226, s[36:39], s68 offen offset:1024 sc1 lds
  s_waitcnt lgkmcnt(4)
  v_mfma_f32_32x32x16_bf16 v[64:79], v[208:211], v[144:147], v[64:79]
  ds_read_b128 v[208:211], v224 offset:12288
  v_cvt_pk_bf16_f32 v162, v100, v101
  v_cvt_pk_bf16_f32 v163, v102, v103
  v_exp_f32 v104, v104
  v_add_f32 v229, v229, v97
  v_mfma_f32_32x32x16_bf16 v[64:79], v[212:215], v[148:151], v[64:79]
  ds_read_b128 v[212:215], v224 offset:13312
  v_exp_f32 v105, v105
  v_exp_f32 v106, v106
  v_cvt_pk_bf16_f32 v164, v104, v105
  buffer_load_dwordx4 v226, s[36:39], s68 offen offset:2048 sc1 lds
  buffer_load_dwordx4 v226, s[36:39], s68 offen offset:3072 sc1 lds
  v_mfma_f32_32x32x16_bf16 v[64:79], v[216:219], v[152:155], v[64:79]
  ds_read_b128 v[216:219], v224 offset:14336
  v_exp_f32 v107, v107
  v_exp_f32 v108, v108
  v_cvt_pk_bf16_f32 v165, v106, v107
  v_mfma_f32_32x32x16_bf16 v[64:79], v[220:223], v[156:159], v[64:79]
  ds_read_b128 v[220:223], v224 offset:15360
  v_exp_f32 v109, v109
  v_exp_f32 v110, v110
  s_and_b32 s70, s70, 0xffff
  s_add_u32 s68, s68, 0x4000
  s_waitcnt lgkmcnt(4)
  v_mfma_f32_32x32x16_bf16 v[80:95], v[192:195], v[128:131], v[176:191]
  ds_read_b128 v[192:195], v225 offset:0
  v_add_u32 v224, 0x4000, v224
  v_and_b32 v224, 0xffff, v224
  v_or_b32 v224, 0x10000, v224
  v_exp_f32 v111, v111
  v_mfma_f32_32x32x16_bf16 v[80:95], v[196:199], v[132:135], v[80:95]
  ds_read_b128 v[196:199], v225 offset:2048
  v_cvt_pk_bf16_f32 v166, v108, v109
  v_cvt_pk_bf16_f32 v167, v110, v111
  v_exp_f32 v112, v112
  v_add_f32 v228, v228, v98
  s_add_u32 m0, s69, s78
  s_add_u32 s69, s69, 0x4000
  v_mfma_f32_32x32x16_bf16 v[80:95], v[200:203], v[136:139], v[80:95]
  ds_read_b128 v[200:203], v225 offset:4096
  v_exp_f32 v113, v113
  v_exp_f32 v114, v114
  v_cvt_pk_bf16_f32 v168, v112, v113
  v_mfma_f32_32x32x16_bf16 v[80:95], v[204:207], v[140:143], v[80:95]
  ds_read_b128 v[204:207], v225 offset:6144
  v_exp_f32 v115, v115
  v_exp_f32 v116, v116
  buffer_load_dwordx4 v226, s[32:35], s67 offen offset:0 sc1 lds
  buffer_load_dwordx4 v226, s[32:35], s67 offen offset:1024 sc1 lds
  s_waitcnt lgkmcnt(4)
  v_mfma_f32_32x32x16_bf16 v[80:95], v[208:211], v[144:147], v[80:95]
  ds_read_b128 v[208:211], v225 offset:1024
  v_exp_f32 v117, v117
  v_exp_f32 v118, v118
  v_cvt_pk_bf16_f32 v169, v114, v115
  v_mfma_f32_32x32x16_bf16 v[80:95], v[212:215], v[148:151], v[80:95]
  ds_read_b128 v[212:215], v225 offset:3072
  v_exp_f32 v119, v119
  v_cvt_pk_bf16_f32 v170, v116, v117
  v_cvt_pk_bf16_f32 v171, v118, v119
  v_max3_f32 v230, v64, v65, v66
  buffer_load_dwordx4 v226, s[32:35], s67 offen offset:2048 sc1 lds
  buffer_load_dwordx4 v226, s[32:35], s67 offen offset:3072 sc1 lds
  v_mfma_f32_32x32x16_bf16 v[80:95], v[216:219], v[152:155], v[80:95]
  ds_read_b128 v[216:219], v225 offset:5120
  v_exp_f32 v120, v120
  v_exp_f32 v121, v121
  v_max3_f32 v230, v230, v67, v68
  v_mfma_f32_32x32x16_bf16 v[80:95], v[220:223], v[156:159], v[80:95]
  ds_read_b128 v[220:223], v225 offset:7168
  v_exp_f32 v122, v122
  v_exp_f32 v123, v123
  s_and_b32 s69, s69, 0xffff
  s_add_u32 s67, s67, 0x4000
  s_waitcnt lgkmcnt(4)
  v_mfma_f32_32x32x16_bf16 v[0:15], v[192:195], v[160:163], v[0:15]
  ds_read_b128 v[192:195], v225 offset:8192
  v_exp_f32 v124, v124
  v_exp_f32 v125, v125
  v_cvt_pk_bf16_f32 v172, v120, v121
  v_mfma_f32_32x32x16_bf16 v[16:31], v[196:199], v[160:163], v[16:31]
  ds_read_b128 v[196:199], v225 offset:10240
  v_exp_f32 v126, v126
  v_exp_f32 v127, v127
  v_cvt_pk_bf16_f32 v173, v122, v123
  v_mfma_f32_32x32x16_bf16 v[32:47], v[200:203], v[160:163], v[32:47]
  ds_read_b128 v[200:203], v225 offset:12288
  v_cvt_pk_bf16_f32 v174, v124, v125
  v_cvt_pk_bf16_f32 v175, v126, v127
  v_max3_f32 v230, v230, v69, v70
  v_add_f32 v229, v229, v99
  v_max3_f32 v230, v230, v71, v72
  v_mfma_f32_32x32x16_bf16 v[48:63], v[204:207], v[160:163], v[48:63]
  ds_read_b128 v[204:207], v225 offset:14336
  v_max3_f32 v230, v230, v73, v74
  v_add_f32 v228, v228, v100
  v_max3_f32 v230, v230, v75, v76
  v_add_f32 v229, v229, v101
  s_waitcnt lgkmcnt(4)
  v_mfma_f32_32x32x16_bf16 v[0:15], v[208:211], v[164:167], v[0:15]
  ds_read_b128 v[208:211], v225 offset:9216
  v_max3_f32 v230, v230, v77, v78
  v_add_f32 v228, v228, v102
  v_max_f32 v230, v230, v79
  v_add_f32 v229, v229, v103
  v_max3_f32 v231, v80, v81, v82
  v_mfma_f32_32x32x16_bf16 v[16:31], v[212:215], v[164:167], v[16:31]
  ds_read_b128 v[212:215], v225 offset:11264
  v_max3_f32 v231, v231, v83, v84
  v_add_f32 v228, v228, v104
  v_max3_f32 v231, v231, v85, v86
  v_add_f32 v229, v229, v105
  v_max3_f32 v231, v231, v87, v88
  v_mfma_f32_32x32x16_bf16 v[32:47], v[216:219], v[164:167], v[32:47]
  ds_read_b128 v[216:219], v225 offset:13312
  v_max3_f32 v231, v231, v89, v90
  v_add_f32 v228, v228, v106
  v_max3_f32 v231, v231, v91, v92
  v_add_f32 v229, v229, v107
  v_max3_f32 v231, v231, v93, v94
  v_mfma_f32_32x32x16_bf16 v[48:63], v[220:223], v[164:167], v[48:63]
  ds_read_b128 v[220:223], v225 offset:15360
  v_max3_f32 v231, v231, v95, v230
  v_add_f32 v228, v228, v108
  v_add_f32 v229, v229, v109
  v_add_f32 v228, v228, v110
  s_waitcnt lgkmcnt(4)
  v_mfma_f32_32x32x16_bf16 v[0:15], v[192:195], v[168:171], v[0:15]
  ds_read_b128 v[192:195], v224 offset:0
  v_add_u32 v225, 0x4000, v225
  v_and_b32 v225, 0xffff, v225
  v_add_f32 v229, v229, v111
  v_add_f32 v228, v228, v112
  v_add_f32 v229, v229, v113
  v_mfma_f32_32x32x16_bf16 v[16:31], v[196:199], v[168:171], v[16:31]
  ds_read_b128 v[196:199], v224 offset:1024
  v_add_f32 v228, v228, v114
  v_add_f32 v229, v229, v115
  v_add_f32 v228, v228, v116
  v_add_f32 v229, v229, v117
  v_add_f32 v228, v228, v118
  v_mfma_f32_32x32x16_bf16 v[32:47], v[200:203], v[168:171], v[32:47]
  ds_read_b128 v[200:203], v224 offset:2048
  v_add_f32 v229, v229, v119
  v_add_f32 v228, v228, v120
  v_add_f32 v229, v229, v121
  v_add_f32 v228, v228, v122
  v_add_f32 v229, v229, v123
  v_mfma_f32_32x32x16_bf16 v[48:63], v[204:207], v[168:171], v[48:63]
  ds_read_b128 v[204:207], v224 offset:3072
  v_add_f32 v228, v228, v124
  v_add_f32 v229, v229, v125
  v_add_f32 v228, v228, v126
  v_add_f32 v229, v229, v127
  s_waitcnt lgkmcnt(4)
  v_mfma_f32_32x32x16_bf16 v[0:15], v[208:211], v[172:175], v[0:15]
  ds_read_b128 v[208:211], v224 offset:4096
  v_mfma_f32_32x32x16_bf16 v[16:31], v[212:215], v[172:175], v[16:31]
  ds_read_b128 v[212:215], v224 offset:5120
  v_mfma_f32_32x32x16_bf16 v[32:47], v[216:219], v[172:175], v[32:47]
  ds_read_b128 v[216:219], v224 offset:6144
  v_mfma_f32_32x32x16_bf16 v[48:63], v[220:223], v[172:175], v[48:63]
  ds_read_b128 v[220:223], v224 offset:7168
  s_waitcnt vmcnt(8)
  s_barrier
  s_waitcnt lgkmcnt(4)
  v_cmp_lt_f32 vcc, s76, v231
  s_cbranch_vccnz .Lat0_rareb
.Lat0_backb:
  s_sub_u32 s71, s71, 1
  s_cmp_lg_u32 s71, 1
  s_cbranch_scc1 .Lat0_loop
.Lat0_mask0:
  v_cmp_gt_i32 vcc, 0, v233
  v_cmp_gt_i32 s[80:81], 1, v233
  v_cmp_gt_i32 s[82:83], 2, v233
  v_cmp_gt_i32 s[84:85], 3, v233
  v_cndmask_b32 v96, v176, v238, vcc
  v_cmp_gt_i32 vcc, 8, v233
  v_cndmask_b32 v97, v176, v238, s[80:81]
  v_cmp_gt_i32 s[80:81], 9, v233
  v_cndmask_b32 v98, v176, v238, s[82:83]
  v_cmp_gt_i32 s[82:83], 10, v233
  v_cndmask_b32 v99, v176, v238, s[84:85]
  v_cmp_gt_i32 s[84:85], 11, v233
  v_cndmask_b32 v100, v176, v238, vcc
  v_cmp_gt_i32 vcc, 16, v233
  v_cndmask_b32 v101, v176, v238, s[80:81]
  v_cmp_gt_i32 s[80:81], 17, v233
  v_cndmask_b32 v102, v176, v238, s[82:83]
  v_cmp_gt_i32 s[82:83], 18, v233
  v_cndmask_b32 v103, v176, v238, s[84:85]
  v_cmp_gt_i32 s[84:85], 19, v233
  v_cndmask_b32 v104, v176, v238, vcc
  v_cmp_gt_i32 vcc, 24, v233
  v_cndmask_b32 v105, v176, v238, s[80:81]
  v_cmp_gt_i32 s[80:81], 25, v233
  v_cndmask_b32 v106, v176, v238, s[82:83]
  v_cmp_gt_i32 s[82:83], 26, v233
  v_cndmask_b32 v107, v176, v238, s[84:85]
  v_cmp_gt_i32 s[84:85], 27, v233
  v_cndmask_b32 v108, v176, v238, vcc
  v_cmp_gt_i32 vcc, 32, v233
  v_cndmask_b32 v109, v176, v238, s[80:81]
  v_cmp_gt_i32 s[80:81], 33, v233
  v_cndmask_b32 v110, v176, v238, s[82:83]
  v_cmp_gt_i32 s[82:83], 34, v233
  v_cndmask_b32 v111, v176, v238, s[84:85]
  v_cmp_gt_i32 s[84:85], 35, v233
  v_cndmask_b32 v112, v176, v238, vcc
  v_cmp_gt_i32 vcc, 40, v233
  v_cndmask_b32 v113, v176, v238, s[80:81]
  v_cmp_gt_i32 s[80:81], 41, v233
  v_cndmask_b32 v114, v176, v238, s[82:83]
  v_cmp_gt_i32 s[82:83], 42, v233
  v_cndmask_b32 v115, v176, v238, s[84:85]
  v_cmp_gt_i32 s[84:85], 43, v233
  v_cndmask_b32 v116, v176, v238, vcc
  v_cmp_gt_i32 vcc, 48, v233
  v_cndmask_b32 v117, v176, v238, s[80:81]
  v_cmp_gt_i32 s[80:81], 49, v233
  v_cndmask_b32 v118, v176, v238, s[82:83]
  v_cmp_gt_i32 s[82:83], 50, v233
  v_cndmask_b32 v119, v176, v238, s[84:85]
  v_cmp_gt_i32 s[84:85], 51, v233
  v_cndmask_b32 v120, v176, v238, vcc
  v_cmp_gt_i32 vcc, 56, v233
  v_cndmask_b32 v121, v176, v238, s[80:81]
  v_cmp_gt_i32 s[80:81], 57, v233
  v_cndmask_b32 v122, v176, v238, s[82:83]
  v_cmp_gt_i32 s[82:83], 58, v233
  v_cndmask_b32 v123, v176, v238, s[84:85]
  v_cmp_gt_i32 s[84:85], 59, v233
  v_cndmask_b32 v124, v176, v238, vcc
  v_cndmask_b32 v125, v176, v238, s[80:81]
  v_cndmask_b32 v126, v176, v238, s[82:83]
  v_cndmask_b32 v127, v176, v238, s[84:85]
  v_mfma_f32_32x32x16_bf16 v[96:111], v[192:195], v[128:131], v[96:111]
  ds_read_b128 v[192:195], v224 offset:8192
  v_exp_f32 v64, v64
  v_exp_f32 v65, v65
  v_add_f32 v228, v228, v64
  v_mfma_f32_32x32x16_bf16 v[96:111], v[196:199], v[132:135], v[96:111]
  ds_read_b128 v[196:199], v224 offset:9216
  v_exp_f32 v66, v66
  v_exp_f32 v67, v67
  v_cvt_pk_bf16_f32 v160, v64, v65
  s_add_u32 m0, s70, s77
  s_add_u32 s70, s70, 0x4000
  v_mfma_f32_32x32x16_bf16 v[96:111], v[200:203], v[136:139], v[96:111]
  ds_read_b128 v[200:203], v224 offset:10240
  v_exp_f32 v68, v68
  v_exp_f32 v69, v69
  v_cvt_pk_bf16_f32 v161, v66, v67
  v_mfma_f32_32x32x16_bf16 v[96:111], v[204:207], v[140:143], v[96:111]
  ds_read_b128 v[204:207], v224 offset:11264
  v_exp_f32 v70, v70
  v_exp_f32 v71, v71
  buffer_load_dwordx4 v226, s[36:39], s68 offen offset:0 sc1 lds
  buffer_load_dwordx4 v226, s[36:39], s68 offen offset:1024 sc1 lds
  s_waitcnt lgkmcnt(4)
  v_mfma_f32_32x32x16_bf16 v[96:111], v[208:211], v[144:147], v[96:111]
  ds_read_b128 v[208:211], v224 offset:12288
  v_cvt_pk_bf16_f32 v162, v68, v69
  v_cvt_pk_bf16_f32 v163, v70, v71
  v_exp_f32 v72, v72
  v_add_f32 v229, v229, v65
  v_mfma_f32_32x32x16_bf16 v[96:111], v[212:215], v[148:151], v[96:111]
  ds_read_b128 v[212:215], v224 offset:13312
  v_exp_f32 v73, v73
  v_exp_f32 v74, v74
  v_cvt_pk_bf16_f32 v164, v72, v73
  buffer_load_dwordx4 v226, s[36:39], s68 offen offset:2048 sc1 lds
  buffer_load_dwordx4 v226, s[36:39], s68 offen offset:3072 sc1 lds
  v_mfma_f32_32x32x16_bf16 v[96:111], v[216:219], v[152:155], v[96:111]
  ds_read_b128 v[216:219], v224 offset:14336
  v_exp_f32 v75, v75
  v_exp_f32 v76, v76
  v_cvt_pk_bf16_f32 v165, v74, v75
  v_mfma_f32_32x32x16_bf16 v[96:111], v[220:223], v[156:159], v[96:111]
  ds_read_b128 v[220:223], v224 offset:15360
  v_exp_f32 v77, v77
  v_exp_f32 v78, v78
  s_and_b32 s70, s70, 0xffff
  s_add_u32 s68, s68, 0x4000
  s_waitcnt lgkmcnt(4)
  v_mfma_f32_32x32x16_bf16 v[112:127], v[192:195], v[128:131], v[112:127]
  ds_read_b128 v[192:195], v225 offset:0
  v_add_u32 v224, 0x4000, v224
  v_and_b32 v224, 0xffff, v224
  v_or_b32 v224, 0x10000, v224
  v_exp_f32 v79, v79
  v_mfma_f32_32x32x16_bf16 v[112:127], v[196:199], v[132:135], v[112:127]
  ds_read_b128 v[196:199], v225 offset:2048
  v_cvt_pk_bf16_f32 v166, v76, v77
  v_cvt_pk_bf16_f32 v167, v78, v79
  v_exp_f32 v80, v80
  v_add_f32 v228, v228, v66
  s_add_u32 m0, s69, s78
  s_add_u32 s69, s69, 0x4000
  v_mfma_f32_32x32x16_bf16 v[112:127], v[200:203], v[136:139], v[112:127]
  ds_read_b128 v[200:203], v225 offset:4096
  v_exp_f32 v81, v81
  v_exp_f32 v82, v82
  v_cvt_pk_bf16_f32 v168, v80, v81
  v_mfma_f32_32x32x16_bf16 v[112:127], v[204:207], v[140:143], v[112:127]
  ds_read_b128 v[204:207], v225 offset:6144
  v_exp_f32 v83, v83
  v_exp_f32 v84, v84
  buffer_load_dwordx4 v226, s[32:35], s67 offen offset:0 sc1 lds
  buffer_load_dwordx4 v226, s[32:35], s67 offen offset:1024 sc1 lds
  s_waitcnt lgkmcnt(4)
  v_mfma_f32_32x32x16_bf16 v[112:127], v[208:211], v[144:147], v[112:127]
  ds_read_b128 v[208:211], v225 offset:1024
  v_exp_f32 v85, v85
  v_exp_f32 v86, v86
  v_cvt_pk_bf16_f32 v169, v82, v83
  v_mfma_f32_32x32x16_bf16 v[112:127], v[212:215], v[148:151], v[112:127]
  ds_read_b128 v[212:215], v225 offset:3072
  v_exp_f32 v87, v87
  v_cvt_pk_bf16_f32 v170, v84, v85
  v_cvt_pk_bf16_f32 v171, v86, v87
  v_max3_f32 v230, v96, v97, v98
  buffer_load_dwordx4 v226, s[32:35], s67 offen offset:2048 sc1 lds
  buffer_load_dwordx4 v226, s[32:35], s67 offen offset:3072 sc1 lds
  v_mfma_f32_32x32x16_bf16 v[112:127], v[216:219], v[152:155], v[112:127]
  ds_read_b128 v[216:219], v225 offset:5120
  v_exp_f32 v88, v88
  v_exp_f32 v89, v89
  v_max3_f32 v230, v230, v99, v100
  v_mfma_f32_32x32x16_bf16 v[112:127], v[220:223], v[156:159], v[112:127]
  ds_read_b128 v[220:223], v225 offset:7168
  v_exp_f32 v90, v90
  v_exp_f32 v91, v91
  s_and_b32 s69, s69, 0xffff
  s_add_u32 s67, s67, 0x4000
  s_waitcnt lgkmcnt(4)
  v_mfma_f32_32x32x16_bf16 v[0:15], v[192:195], v[160:163], v[0:15]
  ds_read_b128 v[192:195], v225 offset:8192
  v_exp_f32 v92, v92
  v_exp_f32 v93, v93
  v_cvt_pk_bf16_f32 v172, v88, v89
  v_mfma_f32_32x32x16_bf16 v[16:31], v[196:199], v[160:163], v[16:31]
  ds_read_b128 v[196:199], v225 offset:10240
  v_exp_f32 v94, v94
  v_exp_f32 v95, v95
  v_cvt_pk_bf16_f32 v173, v90, v91
  v_mfma_f32_32x32x16_bf16 v[32:47], v[200:203], v[160:163], v[32:47]
  ds_read_b128 v[200:203], v225 offset:12288
  v_cvt_pk_bf16_f32 v174, v92, v93
  v_cvt_pk_bf16_f32 v175, v94, v95
  v_max3_f32 v230, v230, v101, v102
  v_add_f32 v229, v229, v67
  v_max3_f32 v230, v230, v103, v104
  v_mfma_f32_32x32x16_bf16 v[48:63], v[204:207], v[160:163], v[48:63]
  ds_read_b128 v[204:207], v225 offset:14336
  v_max3_f32 v230, v230, v105, v106
  v_add_f32 v228, v228, v68
  v_max3_f32 v230, v230, v107, v108
  v_add_f32 v229, v229, v69
  s_waitcnt lgkmcnt(4)
  v_mfma_f32_32x32x16_bf16 v[0:15], v[208:211], v[164:167], v[0:15]
  ds_read_b128 v[208:211], v225 offset:9216
  v_max3_f32 v230, v230, v109, v110
  v_add_f32 v228, v228, v70
  v_max_f32 v230, v230, v111
  v_add_f32 v229, v229, v71
  v_max3_f32 v231, v112, v113, v114
  v_mfma_f32_32x32x16_bf16 v[16:31], v[212:215], v[164:167], v[16:31]
  ds_read_b128 v[212:215], v225 offset:11264
  v_max3_f32 v231, v231, v115, v116
  v_add_f32 v228, v228, v72
  v_max3_f32 v231, v231, v117, v118
  v_add_f32 v229, v229, v73
  v_max3_f32 v231, v231, v119, v120
  v_mfma_f32_32x32x16_bf16 v[32:47], v[216:219], v[164:167], v[32:47]
  ds_read_b128 v[216:219], v225 offset:13312
  v_max3_f32 v231, v231, v121, v122
  v_add_f32 v228, v228, v74
  v_max3_f32 v231, v231, v123, v124
  v_add_f32 v229, v229, v75
  v_max3_f32 v231, v231, v125, v126
  v_mfma_f32_32x32x16_bf16 v[48:63], v[220:223], v[164:167], v[48:63]
  ds_read_b128 v[220:223], v225 offset:15360
  v_max3_f32 v231, v231, v127, v230
  v_add_f32 v228, v228, v76
  v_add_f32 v229, v229, v77
  v_add_f32 v228, v228, v78
  s_waitcnt lgkmcnt(4)
  v_mfma_f32_32x32x16_bf16 v[0:15], v[192:195], v[168:171], v[0:15]
  ds_read_b128 v[192:195], v224 offset:0
  v_add_u32 v225, 0x4000, v225
  v_and_b32 v225, 0xffff, v225
  v_add_f32 v229, v229, v79
  v_add_f32 v228, v228, v80
  v_add_f32 v229, v229, v81
  v_mfma_f32_32x32x16_bf16 v[16:31], v[196:199], v[168:171], v[16:31]
  ds_read_b128 v[196:199], v224 offset:1024
  v_add_f32 v228, v228, v82
  v_add_f32 v229, v229, v83
  v_add_f32 v228, v228, v84
  v_add_f32 v229, v229, v85
  v_add_f32 v228, v228, v86
  v_mfma_f32_32x32x16_bf16 v[32:47], v[200:203], v[168:171], v[32:47]
  ds_read_b128 v[200:203], v224 offset:2048
  v_add_f32 v229, v229, v87
  v_add_f32 v228, v228, v88
  v_add_f32 v229, v229, v89
  v_add_f32 v228, v228, v90
  v_add_f32 v229, v229, v91
  v_mfma_f32_32x32x16_bf16 v[48:63], v[204:207], v[168:171], v[48:63]
  ds_read_b128 v[204:207], v224 offset:3072
  v_add_f32 v228, v228, v92
  v_add_f32 v229, v229, v93
  v_add_f32 v228, v228, v94
  v_add_f32 v229, v229, v95
  s_waitcnt lgkmcnt(4)
  v_mfma_f32_32x32x16_bf16 v[0:15], v[208:211], v[172:175], v[0:15]
  ds_read_b128 v[208:211], v224 offset:4096
  v_mfma_f32_32x32x16_bf16 v[16:31], v[212:215], v[172:175], v[16:31]
  ds_read_b128 v[212:215], v224 offset:5120
  v_mfma_f32_32x32x16_bf16 v[32:47], v[216:219], v[172:175], v[32:47]
  ds_read_b128 v[216:219], v224 offset:6144
  v_mfma_f32_32x32x16_bf16 v[48:63], v[220:223], v[172:175], v[48:63]
  ds_read_b128 v[220:223], v224 offset:7168
  s_waitcnt vmcnt(8)
  s_barrier
  s_waitcnt lgkmcnt(4)
  v_cmp_lt_f32 vcc, s76, v231
  s_cbranch_vccnz .Lat0_rarem0
.Lat0_backm0:
.Lat0_tail1:
  s_waitcnt lgkmcnt(0)
  ds_read_b128 v[192:195], v225 offset:0
  ds_read_b128 v[196:199], v225 offset:2048
  ds_read_b128 v[200:203], v225 offset:4096
  ds_read_b128 v[204:207], v225 offset:6144
  ds_read_b128 v[208:211], v225 offset:1024
  ds_read_b128 v[212:215], v225 offset:3072
  ds_read_b128 v[216:219], v225 offset:5120
  ds_read_b128 v[220:223], v225 offset:7168
  s_lshr_b32 s58, s2, 1
  s_xor_b32 s58, s58, s2
  s_and_b32 s58, s58, 1
  s_lshl_b32 s58, s58, 3
  s_add_u32 s58, s58, s31
  s_add_u32 s58, s58, 16
  s_cmp_lg_u32 s3, 0
  s_cbranch_scc1 .Lpi_h1
  s_lshl_b32 s88, s58, 7
  v_mov_b32 v251, s88
  s_mov_b64 exec, 1
  global_atomic_add v250, v251, v249, s[16:17] sc0
  s_mov_b64 exec, -1
.Lpi_h1:
  s_add_u32 m0, s70, s77
  s_add_u32 s70, s70, 0x4000
  buffer_load_dwordx4 v226, s[36:39], s68 offen offset:0 sc1 lds
  buffer_load_dwordx4 v226, s[36:39], s68 offen offset:1024 sc1 lds
  buffer_load_dwordx4 v226, s[36:39], s68 offen offset:2048 sc1 lds
  buffer_load_dwordx4 v226, s[36:39], s68 offen offset:3072 sc1 lds
  s_and_b32 s70, s70, 0xffff
  s_add_u32 s68, s68, 0x4000
  s_add_u32 m0, s69, s78
  s_add_u32 s69, s69, 0x4000
  buffer_load_dwordx4 v226, s[32:35], s67 offen offset:0 sc1 lds
  buffer_load_dwordx4 v226, s[32:35], s67 offen offset:1024 sc1 lds
  buffer_load_dwordx4 v226, s[32:35], s67 offen offset:2048 sc1 lds
  buffer_load_dwordx4 v226, s[32:35], s67 offen offset:3072 sc1 lds
  s_and_b32 s69, s69, 0xffff
  s_add_u32 s67, s67, 0x4000
  v_exp_f32 v96, v96
  v_exp_f32 v97, v97
  s_nop 0
  v_cvt_pk_bf16_f32 v160, v96, v97
  v_exp_f32 v98, v98
  v_exp_f32 v99, v99
  s_nop 0
  v_cvt_pk_bf16_f32 v161, v98, v99
  v_exp_f32 v100, v100
  v_exp_f32 v101, v101
  s_nop 0
  v_cvt_pk_bf16_f32 v162, v100, v101
  v_exp_f32 v102, v102
  v_exp_f32 v103, v103
  s_nop 0
  v_cvt_pk_bf16_f32 v163, v102, v103
  s_waitcnt lgkmcnt(7)
  s_nop 0
  v_mfma_f32_32x32x16_bf16 v[0:15], v[192:195], v[160:163], v[0:15]
  ds_read_b128 v[192:195], v225 offset:8192
  v_exp_f32 v104, v104
  v_exp_f32 v105, v105
  v_exp_f32 v106, v106
  v_exp_f32 v107, v107
  s_waitcnt lgkmcnt(7)
  v_mfma_f32_32x32x16_bf16 v[16:31], v[196:199], v[160:163], v[16:31]
  ds_read_b128 v[196:199], v225 offset:10240
  v_exp_f32 v108, v108
  v_exp_f32 v109, v109
  v_exp_f32 v110, v110
  v_exp_f32 v111, v111
  s_waitcnt lgkmcnt(7)
  v_mfma_f32_32x32x16_bf16 v[32:47], v[200:203], v[160:163], v[32:47]
  ds_read_b128 v[200:203], v225 offset:12288
  v_cvt_pk_bf16_f32 v164, v104, v105
  v_cvt_pk_bf16_f32 v165, v106, v107
  v_cvt_pk_bf16_f32 v166, v108, v109
  v_cvt_pk_bf16_f32 v167, v110, v111
  v_exp_f32 v112, v112
  v_exp_f32 v113, v113
  s_waitcnt lgkmcnt(7)
  v_mfma_f32_32x32x16_bf16 v[48:63], v[204:207], v[160:163], v[48:63]
  ds_read_b128 v[204:207], v225 offset:14336
  v_exp_f32 v114, v114
  v_exp_f32 v115, v115
  v_exp_f32 v116, v116
  v_exp_f32 v117, v117
  s_waitcnt lgkmcnt(7)
  v_mfma_f32_32x32x16_bf16 v[0:15], v[208:211], v[164:167], v[0:15]
  ds_read_b128 v[208:211], v225 offset:9216
  v_exp_f32 v118, v118
  v_exp_f32 v119, v119
  v_cvt_pk_bf16_f32 v168, v112, v113
  v_cvt_pk_bf16_f32 v169, v114, v115
  v_cvt_pk_bf16_f32 v170, v116, v117
  v_cvt_pk_bf16_f32 v171, v118, v119
  s_waitcnt lgkmcnt(7)
  v_mfma_f32_32x32x16_bf16 v[16:31], v[212:215], v[164:167], v[16:31]
  ds_read_b128 v[212:215], v225 offset:11264
  v_exp_f32 v120, v120
  v_exp_f32 v121, v121
  v_exp_f32 v122, v122
  v_exp_f32 v123, v123
  s_waitcnt lgkmcnt(7)
  v_mfma_f32_32x32x16_bf16 v[32:47], v[216:219], v[164:167], v[32:47]
  ds_read_b128 v[216:219], v225 offset:13312
  v_exp_f32 v124, v124
  v_exp_f32 v125, v125
  v_exp_f32 v126, v126
  v_exp_f32 v127, v127
  s_waitcnt lgkmcnt(7)
  v_mfma_f32_32x32x16_bf16 v[48:63], v[220:223], v[164:167], v[48:63]
  ds_read_b128 v[220:223], v225 offset:15360
  v_cvt_pk_bf16_f32 v172, v120, v121
  v_cvt_pk_bf16_f32 v173, v122, v123
  v_cvt_pk_bf16_f32 v174, v124, v125
  v_cvt_pk_bf16_f32 v175, v126, v127
  v_add_f32 v228, v228, v96
  v_add_f32 v229, v229, v97
  v_add_f32 v228, v228, v98
  v_add_f32 v229, v229, v99
  s_waitcnt lgkmcnt(7)
  v_mfma_f32_32x32x16_bf16 v[0:15], v[192:195], v[168:171], v[0:15]
  v_add_f32 v228, v228, v100
  v_add_f32 v229, v229, v101
  v_add_f32 v228, v228, v102
  v_add_f32 v229, v229, v103
  v_add_f32 v228, v228, v104
  v_add_f32 v229, v229, v105
  v_add_f32 v228, v228, v106
  v_add_f32 v229, v229, v107
  s_waitcnt lgkmcnt(6)
  v_mfma_f32_32x32x16_bf16 v[16:31], v[196:199], v[168:171], v[16:31]
  v_add_f32 v228, v228, v108
  v_add_f32 v229, v229, v109
  v_add_f32 v228, v228, v110
  v_add_f32 v229, v229, v111
  v_add_f32 v228, v228, v112
  v_add_f32 v229, v229, v113
  v_add_f32 v228, v228, v114
  v_add_f32 v229, v229, v115
  s_waitcnt lgkmcnt(5)
  v_mfma_f32_32x32x16_bf16 v[32:47], v[200:203], v[168:171], v[32:47]
  v_add_f32 v228, v228, v116
  v_add_f32 v229, v229, v117
  v_add_f32 v228, v228, v118
  v_add_f32 v229, v229, v119
  v_add_f32 v228, v228, v120
  v_add_f32 v229, v229, v121
  v_add_f32 v228, v228, v122
  v_add_f32 v229, v229, v123
  s_waitcnt lgkmcnt(4)
  v_mfma_f32_32x32x16_bf16 v[48:63], v[204:207], v[168:171], v[48:63]
  v_add_f32 v228, v228, v124
  v_add_f32 v229, v229, v125
  v_add_f32 v228, v228, v126
  v_add_f32 v229, v229, v127
  s_waitcnt lgkmcnt(3)
  v_mfma_f32_32x32x16_bf16 v[0:15], v[208:211], v[172:175], v[0:15]
  s_waitcnt lgkmcnt(2)
  v_mfma_f32_32x32x16_bf16 v[16:31], v[212:215], v[172:175], v[16:31]
  s_waitcnt lgkmcnt(1)
  v_mfma_f32_32x32x16_bf16 v[32:47], v[216:219], v[172:175], v[32:47]
  s_waitcnt lgkmcnt(0)
  v_mfma_f32_32x32x16_bf16 v[48:63], v[220:223], v[172:175], v[48:63]
  s_waitcnt vmcnt(8)
  s_barrier
  s_branch .Lat_fin
.Lat0_mask1:
  v_cmp_gt_i32 vcc, 0, v233
  v_cmp_gt_i32 s[80:81], 1, v233
  v_cmp_gt_i32 s[82:83], 2, v233
  v_cmp_gt_i32 s[84:85], 3, v233
  v_cndmask_b32 v64, v176, v238, vcc
  v_cmp_gt_i32 vcc, 8, v233
  v_cndmask_b32 v65, v176, v238, s[80:81]
  v_cmp_gt_i32 s[80:81], 9, v233
  v_cndmask_b32 v66, v176, v238, s[82:83]
  v_cmp_gt_i32 s[82:83], 10, v233
  v_cndmask_b32 v67, v176, v238, s[84:85]
  v_cmp_gt_i32 s[84:85], 11, v233
  v_cndmask_b32 v68, v176, v238, vcc
  v_cmp_gt_i32 vcc, 16, v233
  v_cndmask_b32 v69, v176, v238, s[80:81]
  v_cmp_gt_i32 s[80:81], 17, v233
  v_cndmask_b32 v70, v176, v238, s[82:83]
  v_cmp_gt_i32 s[82:83], 18, v233
  v_cndmask_b32 v71, v176, v238, s[84:85]
  v_cmp_gt_i32 s[84:85], 19, v233
  v_cndmask_b32 v72, v176, v238, vcc
  v_cmp_gt_i32 vcc, 24, v233
  v_cndmask_b32 v73, v176, v238, s[80:81]
  v_cmp_gt_i32 s[80:81], 25, v233
  v_cndmask_b32 v74, v176, v238, s[82:83]
  v_cmp_gt_i32 s[82:83], 26, v233
  v_cndmask_b32 v75, v176, v238, s[84:85]
  v_cmp_gt_i32 s[84:85], 27, v233
  v_cndmask_b32 v76, v176, v238, vcc
  v_cmp_gt_i32 vcc, 32, v233
  v_cndmask_b32 v77, v176, v238, s[80:81]
  v_cmp_gt_i32 s[80:81], 33, v233
  v_cndmask_b32 v78, v176, v238, s[82:83]
  v_cmp_gt_i32 s[82:83], 34, v233
  v_cndmask_b32 v79, v176, v238, s[84:85]
  v_cmp_gt_i32 s[84:85], 35, v233
  v_cndmask_b32 v80, v176, v238, vcc
  v_cmp_gt_i32 vcc, 40, v233
  v_cndmask_b32 v81, v176, v238, s[80:81]
  v_cmp_gt_i32 s[80:81], 41, v233
  v_cndmask_b32 v82, v176, v238, s[82:83]
  v_cmp_gt_i32 s[82:83], 42, v233
  v_cndmask_b32 v83, v176, v238, s[84:85]
  v_cmp_gt_i32 s[84:85], 43, v233
  v_cndmask_b32 v84, v176, v238, vcc
  v_cmp_gt_i32 vcc, 48, v233
  v_cndmask_b32 v85, v176, v238, s[80:81]
  v_cmp_gt_i32 s[80:81], 49, v233
  v_cndmask_b32 v86, v176, v238, s[82:83]
  v_cmp_gt_i32 s[82:83], 50, v233
  v_cndmask_b32 v87, v176, v238, s[84:85]
  v_cmp_gt_i32 s[84:85], 51, v233
  v_cndmask_b32 v88, v176, v238, vcc
  v_cmp_gt_i32 vcc, 56, v233
  v_cndmask_b32 v89, v176, v238, s[80:81]
  v_cmp_gt_i32 s[80:81], 57, v233
  v_cndmask_b32 v90, v176, v238, s[82:83]
  v_cmp_gt_i32 s[82:83], 58, v233
  v_cndmask_b32 v91, v176, v238, s[84:85]
  v_cmp_gt_i32 s[84:85], 59, v233
  v_cndmask_b32 v92, v176, v238, vcc
  v_cndmask_b32 v93, v176, v238, s[80:81]
  v_cndmask_b32 v94, v176, v238, s[82:83]
  v_cndmask_b32 v95, v176, v238, s[84:85]
  v_mfma_f32_32x32x16_bf16 v[64:79], v[192:195], v[128:131], v[64:79]
  ds_read_b128 v[192:195], v224 offset:8192
  v_exp_f32 v96, v96
  v_exp_f32 v97, v97
  v_add_f32 v228, v228, v96
  v_mfma_f32_32x32x16_bf16 v[64:79], v[196:199], v[132:135], v[64:79]
  ds_read_b128 v[196:199], v224 offset:9216
  v_exp_f32 v98, v98
  v_exp_f32 v99, v99
  v_cvt_pk_bf16_f32 v160, v96, v97
  s_add_u32 m0, s70, s77
  s_add_u32 s70, s70, 0x4000
  v_mfma_f32_32x32x16_bf16 v[64:79], v[200:203], v[136:139], v[64:79]
  ds_read_b128 v[200:203], v224 offset:10240
  v_exp_f32 v100, v100
  v_exp_f32 v101, v101
  v_cvt_pk_bf16_f32 v161, v98, v99
  v_mfma_f32_32x32x16_bf16 v[64:79], v[204:207], v[140:143], v[64:79]
  ds_read_b128 v[204:207], v224 offset:11264
  v_exp_f32 v102, v102
  v_exp_f32 v103, v103
  buffer_load_dwordx4 v226, s[36:39], s68 offen offset:0 sc1 lds
  buffer_load_dwordx4 v226, s[36:39], s68 offen offset:1024 sc1 lds
  s_waitcnt lgkmcnt(4)
  v_mfma_f32_32x32x16_bf16 v[64:79], v[208:211], v[144:147], v[64:79]
  ds_read_b128 v[208:211], v224 offset:12288
  v_cvt_pk_bf16_f32 v162, v100, v101
  v_cvt_pk_bf16_f32 v163, v102, v103
  v_exp_f32 v104, v104
  v_add_f32 v229, v229, v97
  v_mfma_f32_32x32x16_bf16 v[64:79], v[212:215], v[148:151], v[64:79]
  ds_read_b128 v[212:215], v224 offset:13312
  v_exp_f32 v105, v105
  v_exp_f32 v106, v106
  v_cvt_pk_bf16_f32 v164, v104, v105
  buffer_load_dwordx4 v226, s[36:39], s68 offen offset:2048 sc1 lds
  buffer_load_dwordx4 v226, s[36:39], s68 offen offset:3072 sc1 lds
  v_mfma_f32_32x32x16_bf16 v[64:79], v[216:219], v[152:155], v[64:79]
  ds_read_b128 v[216:219], v224 offset:14336
  v_exp_f32 v107, v107
  v_exp_f32 v108, v108
  v_cvt_pk_bf16_f32 v165, v106, v107
  v_mfma_f32_32x32x16_bf16 v[64:79], v[220:223], v[156:159], v[64:79]
  ds_read_b128 v[220:223], v224 offset:15360
  v_exp_f32 v109, v109
  v_exp_f32 v110, v110
  s_and_b32 s70, s70, 0xffff
  s_add_u32 s68, s68, 0x4000
  s_waitcnt lgkmcnt(4)
  v_mfma_f32_32x32x16_bf16 v[80:95], v[192:195], v[128:131], v[80:95]
  ds_read_b128 v[192:195], v225 offset:0
  v_add_u32 v224, 0x4000, v224
  v_and_b32 v224, 0xffff, v224
  v_or_b32 v224, 0x10000, v224
  v_exp_f32 v111, v111
  v_mfma_f32_32x32x16_bf16 v[80:95], v[196:199], v[132:135], v[80:95]
  ds_read_b128 v[196:199], v225 offset:2048
  v_cvt_pk_bf16_f32 v166, v108, v109
  v_cvt_pk_bf16_f32 v167, v110, v111
  v_exp_f32 v112, v112
  v_add_f32 v228, v228, v98
  s_add_u32 m0, s69, s78
  s_add_u32 s69, s69, 0x4000
  v_mfma_f32_32x32x16_bf16 v[80:95], v[200:203], v[136:139], v[80:95]
  ds_read_b128 v[200:203], v225 offset:4096
  v_exp_f32 v113, v113
  v_exp_f32 v114, v114
  v_cvt_pk_bf16_f32 v168, v112, v113
  v_mfma_f32_32x32x16_bf16 v[80:95], v[204:207], v[140:143], v[80:95]
  ds_read_b128 v[204:207], v225 offset:6144
  v_exp_f32 v115, v115
  v_exp_f32 v116, v116
  buffer_load_dwordx4 v226, s[32:35], s67 offen offset:0 sc1 lds
  buffer_load_dwordx4 v226, s[32:35], s67 offen offset:1024 sc1 lds
  s_waitcnt lgkmcnt(4)
  v_mfma_f32_32x32x16_bf16 v[80:95], v[208:211], v[144:147], v[80:95]
  ds_read_b128 v[208:211], v225 offset:1024
  v_exp_f32 v117, v117
  v_exp_f32 v118, v118
  v_cvt_pk_bf16_f32 v169, v114, v115
  v_mfma_f32_32x32x16_bf16 v[80:95], v[212:215], v[148:151], v[80:95]
  ds_read_b128 v[212:215], v225 offset:3072
  v_exp_f32 v119, v119
  v_cvt_pk_bf16_f32 v170, v116, v117
  v_cvt_pk_bf16_f32 v171, v118, v119
  v_max3_f32 v230, v64, v65, v66
  buffer_load_dwordx4 v226, s[32:35], s67 offen offset:2048 sc1 lds
  buffer_load_dwordx4 v226, s[32:35], s67 offen offset:3072 sc1 lds
  v_mfma_f32_32x32x16_bf16 v[80:95], v[216:219], v[152:155], v[80:95]
  ds_read_b128 v[216:219], v225 offset:5120
  v_exp_f32 v120, v120
  v_exp_f32 v121, v121
  v_max3_f32 v230, v230, v67, v68
  v_mfma_f32_32x32x16_bf16 v[80:95], v[220:223], v[156:159], v[80:95]
  ds_read_b128 v[220:223], v225 offset:7168
  v_exp_f32 v122, v122
  v_exp_f32 v123, v123
  s_and_b32 s69, s69, 0xffff
  s_add_u32 s67, s67, 0x4000
  s_waitcnt lgkmcnt(4)
  v_mfma_f32_32x32x16_bf16 v[0:15], v[192:195], v[160:163], v[0:15]
  ds_read_b128 v[192:195], v225 offset:8192
  v_exp_f32 v124, v124
  v_exp_f32 v125, v125
  v_cvt_pk_bf16_f32 v172, v120, v121
  v_mfma_f32_32x32x16_bf16 v[16:31], v[196:199], v[160:163], v[16:31]
  ds_read_b128 v[196:199], v225 offset:10240
  v_exp_f32 v126, v126
  v_exp_f32 v127, v127
  v_cvt_pk_bf16_f32 v173, v122, v123
  v_mfma_f32_32x32x16_bf16 v[32:47], v[200:203], v[160:163], v[32:47]
  ds_read_b128 v[200:203], v225 offset:12288
  v_cvt_pk_bf16_f32 v174, v124, v125
  v_cvt_pk_bf16_f32 v175, v126, v127
  v_max3_f32 v230, v230, v69, v70
  v_add_f32 v229, v229, v99
  v_max3_f32 v230, v230, v71, v72
  v_mfma_f32_32x32x16_bf16 v[48:63], v[204:207], v[160:163], v[48:63]
  ds_read_b128 v[204:207], v225 offset:14336
  v_max3_f32 v230, v230, v73, v74
  v_add_f32 v228, v228, v100
  v_max3_f32 v230, v230, v75, v76
  v_add_f32 v229, v229, v101
  s_waitcnt lgkmcnt(4)
  v_mfma_f32_32x32x16_bf16 v[0:15], v[208:211], v[164:167], v[0:15]
  ds_read_b128 v[208:211], v225 offset:9216
  v_max3_f32 v230, v230, v77, v78
  v_add_f32 v228, v228, v102
  v_max_f32 v230, v230, v79
  v_add_f32 v229, v229, v103
  v_max3_f32 v231, v80, v81, v82
  v_mfma_f32_32x32x16_bf16 v[16:31], v[212:215], v[164:167], v[16:31]
  ds_read_b128 v[212:215], v225 offset:11264
  v_max3_f32 v231, v231, v83, v84
  v_add_f32 v228, v228, v104
  v_max3_f32 v231, v231, v85, v86
  v_add_f32 v229, v229, v105
  v_max3_f32 v231, v231, v87, v88
  v_mfma_f32_32x32x16_bf16 v[32:47], v[216:219], v[164:167], v[32:47]
  ds_read_b128 v[216:219], v225 offset:13312
  v_max3_f32 v231, v231, v89, v90
  v_add_f32 v228, v228, v106
  v_max3_f32 v231, v231, v91, v92
  v_add_f32 v229, v229, v107
  v_max3_f32 v231, v231, v93, v94
  v_mfma_f32_32x32x16_bf16 v[48:63], v[220:223], v[164:167], v[48:63]
  ds_read_b128 v[220:223], v225 offset:15360
  v_max3_f32 v231, v231, v95, v230
  v_add_f32 v228, v228, v108
  v_add_f32 v229, v229, v109
  v_add_f32 v228, v228, v110
  s_waitcnt lgkmcnt(4)
  v_mfma_f32_32x32x16_bf16 v[0:15], v[192:195], v[168:171], v[0:15]
  ds_read_b128 v[192:195], v224 offset:0
  v_add_u32 v225, 0x4000, v225
  v_and_b32 v225, 0xffff, v225
  v_add_f32 v229, v229, v111
  v_add_f32 v228, v228, v112
  v_add_f32 v229, v229, v113
  v_mfma_f32_32x32x16_bf16 v[16:31], v[196:199], v[168:171], v[16:31]
  ds_read_b128 v[196:199], v224 offset:1024
  v_add_f32 v228, v228, v114
  v_add_f32 v229, v229, v115
  v_add_f32 v228, v228, v116
  v_add_f32 v229, v229, v117
  v_add_f32 v228, v228, v118
  v_mfma_f32_32x32x16_bf16 v[32:47], v[200:203], v[168:171], v[32:47]
  ds_read_b128 v[200:203], v224 offset:2048
  v_add_f32 v229, v229, v119
  v_add_f32 v228, v228, v120
  v_add_f32 v229, v229, v121
  v_add_f32 v228, v228, v122
  v_add_f32 v229, v229, v123
  v_mfma_f32_32x32x16_bf16 v[48:63], v[204:207], v[168:171], v[48:63]
  ds_read_b128 v[204:207], v224 offset:3072
  v_add_f32 v228, v228, v124
  v_add_f32 v229, v229, v125
  v_add_f32 v228, v228, v126
  v_add_f32 v229, v229, v127
  s_waitcnt lgkmcnt(4)
  v_mfma_f32_32x32x16_bf16 v[0:15], v[208:211], v[172:175], v[0:15]
  ds_read_b128 v[208:211], v224 offset:4096
  v_mfma_f32_32x32x16_bf16 v[16:31], v[212:215], v[172:175], v[16:31]
  ds_read_b128 v[212:215], v224 offset:5120
  v_mfma_f32_32x32x16_bf16 v[32:47], v[216:219], v[172:175], v[32:47]
  ds_read_b128 v[216:219], v224 offset:6144
  v_mfma_f32_32x32x16_bf16 v[48:63], v[220:223], v[172:175], v[48:63]
  ds_read_b128 v[220:223], v224 offset:7168
  s_waitcnt vmcnt(8)
  s_barrier
  s_waitcnt lgkmcnt(4)
  v_cmp_lt_f32 vcc, s76, v231
  s_cbranch_vccnz .Lat0_rarem1
.Lat0_backm1:
.Lat0_tail0:
  s_waitcnt lgkmcnt(0)
  ds_read_b128 v[192:195], v225 offset:0
  ds_read_b128 v[196:199], v225 offset:2048
  ds_read_b128 v[200:203], v225 offset:4096
  ds_read_b128 v[204:207], v225 offset:6144
  ds_read_b128 v[208:211], v225 offset:1024
  ds_read_b128 v[212:215], v225 offset:3072
  ds_read_b128 v[216:219], v225 offset:5120
  ds_read_b128 v[220:223], v225 offset:7168
  s_lshr_b32 s58, s2, 1
  s_xor_b32 s58, s58, s2
  s_and_b32 s58, s58, 1
  s_lshl_b32 s58, s58, 3
  s_add_u32 s58, s58, s31
  s_add_u32 s58, s58, 16
  s_cmp_lg_u32 s3, 0
  s_cbranch_scc1 .Lpi_h0
  s_lshl_b32 s88, s58, 7
  v_mov_b32 v251, s88
  s_mov_b64 exec, 1
  global_atomic_add v250, v251, v249, s[16:17] sc0
  s_mov_b64 exec, -1
.Lpi_h0:
  s_add_u32 m0, s70, s77
  s_add_u32 s70, s70, 0x4000
  buffer_load_dwordx4 v226, s[36:39], s68 offen offset:0 sc1 lds
  buffer_load_dwordx4 v226, s[36:39], s68 offen offset:1024 sc1 lds
  buffer_load_dwordx4 v226, s[36:39], s68 offen offset:2048 sc1 lds
  buffer_load_dwordx4 v226, s[36:39], s68 offen offset:3072 sc1 lds
  s_and_b32 s70, s70, 0xffff
  s_add_u32 s68, s68, 0x4000
  s_add_u32 m0, s69, s78
  s_add_u32 s69, s69, 0x4000
  buffer_load_dwordx4 v226, s[32:35], s67 offen offset:0 sc1 lds
  buffer_load_dwordx4 v226, s[32:35], s67 offen offset:1024 sc1 lds
  buffer_load_dwordx4 v226, s[32:35], s67 offen offset:2048 sc1 lds
  buffer_load_dwordx4 v226, s[32:35], s67 offen offset:3072 sc1 lds
  s_and_b32 s69, s69, 0xffff
  s_add_u32 s67, s67, 0x4000
  v_exp_f32 v64, v64
  v_exp_f32 v65, v65
  s_nop 0
  v_cvt_pk_bf16_f32 v160, v64, v65
  v_exp_f32 v66, v66
  v_exp_f32 v67, v67
  s_nop 0
  v_cvt_pk_bf16_f32 v161, v66, v67
  v_exp_f32 v68, v68
  v_exp_f32 v69, v69
  s_nop 0
  v_cvt_pk_bf16_f32 v162, v68, v69
  v_exp_f32 v70, v70
  v_exp_f32 v71, v71
  s_nop 0
  v_cvt_pk_bf16_f32 v163, v70, v71
  s_waitcnt lgkmcnt(7)
  s_nop 0
  v_mfma_f32_32x32x16_bf16 v[0:15], v[192:195], v[160:163], v[0:15]
  ds_read_b128 v[192:195], v225 offset:8192
  v_exp_f32 v72, v72
  v_exp_f32 v73, v73
  v_exp_f32 v74, v74
  v_exp_f32 v75, v75
  s_waitcnt lgkmcnt(7)
  v_mfma_f32_32x32x16_bf16 v[16:31], v[196:199], v[160:163], v[16:31]
  ds_read_b128 v[196:199], v225 offset:10240
  v_exp_f32 v76, v76
  v_exp_f32 v77, v77
  v_exp_f32 v78, v78
  v_exp_f32 v79, v79
  s_waitcnt lgkmcnt(7)
  v_mfma_f32_32x32x16_bf16 v[32:47], v[200:203], v[160:163], v[32:47]
  ds_read_b128 v[200:203], v225 offset:12288
  v_cvt_pk_bf16_f32 v164, v72, v73
  v_cvt_pk_bf16_f32 v165, v74, v75
  v_cvt_pk_bf16_f32 v166, v76, v77
  v_cvt_pk_bf16_f32 v167, v78, v79
  v_exp_f32 v80, v80
  v_exp_f32 v81, v81
  s_waitcnt lgkmcnt(7)
  v_mfma_f32_32x32x16_bf16 v[48:63], v[204:207], v[160:163], v[48:63]
  ds_read_b128 v[204:207], v225 offset:14336
  v_exp_f32 v82, v82
  v_exp_f32 v83, v83
  v_exp_f32 v84, v84
  v_exp_f32 v85, v85
  s_waitcnt lgkmcnt(7)
  v_mfma_f32_32x32x16_bf16 v[0:15], v[208:211], v[164:167], v[0:15]
  ds_read_b128 v[208:211], v225 offset:9216
  v_exp_f32 v86, v86
  v_exp_f32 v87, v87
  v_cvt_pk_bf16_f32 v168, v80, v81
  v_cvt_pk_bf16_f32 v169, v82, v83
  v_cvt_pk_bf16_f32 v170, v84, v85
  v_cvt_pk_bf16_f32 v171, v86, v87
  s_waitcnt lgkmcnt(7)
  v_mfma_f32_32x32x16_bf16 v[16:31], v[212:215], v[164:167], v[16:31]
  ds_read_b128 v[212:215], v225 offset:11264
  v_exp_f32 v88, v88
  v_exp_f32 v89, v89
  v_exp_f32 v90, v90
  v_exp_f32 v91, v91
  s_waitcnt lgkmcnt(7)
  v_mfma_f32_32x32x16_bf16 v[32:47], v[216:219], v[164:167], v[32:47]
  ds_read_b128 v[216:219], v225 offset:13312
  v_exp_f32 v92, v92
  v_exp_f32 v93, v93
  v_exp_f32 v94, v94
  v_exp_f32 v95, v95
  s_waitcnt lgkmcnt(7)
  v_mfma_f32_32x32x16_bf16 v[48:63], v[220:223], v[164:167], v[48:63]
  ds_read_b128 v[220:223], v225 offset:15360
  v_cvt_pk_bf16_f32 v172, v88, v89
  v_cvt_pk_bf16_f32 v173, v90, v91
  v_cvt_pk_bf16_f32 v174, v92, v93
  v_cvt_pk_bf16_f32 v175, v94, v95
  v_add_f32 v228, v228, v64
  v_add_f32 v229, v229, v65
  v_add_f32 v228, v228, v66
  v_add_f32 v229, v229, v67
  s_waitcnt lgkmcnt(7)
  v_mfma_f32_32x32x16_bf16 v[0:15], v[192:195], v[168:171], v[0:15]
  v_add_f32 v228, v228, v68
  v_add_f32 v229, v229, v69
  v_add_f32 v228, v228, v70
  v_add_f32 v229, v229, v71
  v_add_f32 v228, v228, v72
  v_add_f32 v229, v229, v73
  v_add_f32 v228, v228, v74
  v_add_f32 v229, v229, v75
  s_waitcnt lgkmcnt(6)
  v_mfma_f32_32x32x16_bf16 v[16:31], v[196:199], v[168:171], v[16:31]
  v_add_f32 v228, v228, v76
  v_add_f32 v229, v229, v77
  v_add_f32 v228, v228, v78
  v_add_f32 v229, v229, v79
  v_add_f32 v228, v228, v80
  v_add_f32 v229, v229, v81
  v_add_f32 v228, v228, v82
  v_add_f32 v229, v229, v83
  s_waitcnt lgkmcnt(5)
  v_mfma_f32_32x32x16_bf16 v[32:47], v[200:203], v[168:171], v[32:47]
  v_add_f32 v228, v228, v84
  v_add_f32 v229, v229, v85
  v_add_f32 v228, v228, v86
  v_add_f32 v229, v229, v87
  v_add_f32 v228, v228, v88
  v_add_f32 v229, v229, v89
  v_add_f32 v228, v228, v90
  v_add_f32 v229, v229, v91
  s_waitcnt lgkmcnt(4)
  v_mfma_f32_32x32x16_bf16 v[48:63], v[204:207], v[168:171], v[48:63]
  v_add_f32 v228, v228, v92
  v_add_f32 v229, v229, v93
  v_add_f32 v228, v228, v94
  v_add_f32 v229, v229, v95
  s_waitcnt lgkmcnt(3)
  v_mfma_f32_32x32x16_bf16 v[0:15], v[208:211], v[172:175], v[0:15]
  s_waitcnt lgkmcnt(2)
  v_mfma_f32_32x32x16_bf16 v[16:31], v[212:215], v[172:175], v[16:31]
  s_waitcnt lgkmcnt(1)
  v_mfma_f32_32x32x16_bf16 v[32:47], v[216:219], v[172:175], v[32:47]
  s_waitcnt lgkmcnt(0)
  v_mfma_f32_32x32x16_bf16 v[48:63], v[220:223], v[172:175], v[48:63]
  s_waitcnt vmcnt(8)
  s_barrier
  s_branch .Lat_fin
.Lat0_rarea:
  s_nop 11
  v_mov_b32 v235, v231
  s_nop 1
  v_permlane32_swap_b32 v231, v235
  v_max3_f32 v235, v231, v235, 0
  v_exp_f32 v236, -v235
  v_sub_f32 v96, v96, v235
  v_sub_f32 v97, v97, v235
  v_sub_f32 v98, v98, v235
  v_sub_f32 v99, v99, v235
  v_sub_f32 v100, v100, v235
  v_sub_f32 v101, v101, v235
  v_sub_f32 v102, v102, v235
  v_sub_f32 v103, v103, v235
  v_sub_f32 v104, v104, v235
  v_sub_f32 v105, v105, v235
  v_sub_f32 v106, v106, v235
  v_sub_f32 v107, v107, v235
  v_sub_f32 v108, v108, v235
  v_sub_f32 v109, v109, v235
  v_sub_f32 v110, v110, v235
  v_sub_f32 v111, v111, v235
  v_sub_f32 v112, v112, v235
  v_sub_f32 v113, v113, v235
  v_sub_f32 v114, v114, v235
  v_sub_f32 v115, v115, v235
  v_sub_f32 v116, v116, v235
  v_sub_f32 v117, v117, v235
  v_sub_f32 v118, v118, v235
  v_sub_f32 v119, v119, v235
  v_sub_f32 v120, v120, v235
  v_sub_f32 v121, v121, v235
  v_sub_f32 v122, v122, v235
  v_sub_f32 v123, v123, v235
  v_sub_f32 v124, v124, v235
  v_sub_f32 v125, v125, v235
  v_sub_f32 v126, v126, v235
  v_sub_f32 v127, v127, v235
  v_mul_f32 v0, v0, v236
  v_mul_f32 v1, v1, v236
  v_mul_f32 v2, v2, v236
  v_mul_f32 v3, v3, v236
  v_mul_f32 v4, v4, v236
  v_mul_f32 v5, v5, v236
  v_mul_f32 v6, v6, v236
  v_mul_f32 v7, v7, v236
  v_mul_f32 v8, v8, v236
  v_mul_f32 v9, v9, v236
  v_mul_f32 v10, v10, v236
  v_mul_f32 v11, v11, v236
  v_mul_f32 v12, v12, v236
  v_mul_f32 v13, v13, v236
  v_mul_f32 v14, v14, v236
  v_mul_f32 v15, v15, v236
  v_mul_f32 v16, v16, v236
  v_mul_f32 v17, v17, v236
  v_mul_f32 v18, v18, v236
  v_mul_f32 v19, v19, v236
  v_mul_f32 v20, v20, v236
  v_mul_f32 v21, v21, v236
  v_mul_f32 v22, v22, v236
  v_mul_f32 v23, v23, v236
  v_mul_f32 v24, v24, v236
  v_mul_f32 v25, v25, v236
  v_mul_f32 v26, v26, v236
  v_mul_f32 v27, v27, v236
  v_mul_f32 v28, v28, v236
  v_mul_f32 v29, v29, v236
  v_mul_f32 v30, v30, v236
  v_mul_f32 v31, v31, v236
  v_mul_f32 v32, v32, v236
  v_mul_f32 v33, v33, v236
  v_mul_f32 v34, v34, v236
  v_mul_f32 v35, v35, v236
  v_mul_f32 v36, v36, v236
  v_mul_f32 v37, v37, v236
  v_mul_f32 v38, v38, v236
  v_mul_f32 v39, v39, v236
  v_mul_f32 v40, v40, v236
  v_mul_f32 v41, v41, v236
  v_mul_f32 v42, v42, v236
  v_mul_f32 v43, v43, v236
  v_mul_f32 v44, v44, v236
  v_mul_f32 v45, v45, v236
  v_mul_f32 v46, v46, v236
  v_mul_f32 v47, v47, v236
  v_mul_f32 v48, v48, v236
  v_mul_f32 v49, v49, v236
  v_mul_f32 v50, v50, v236
  v_mul_f32 v51, v51, v236
  v_mul_f32 v52, v52, v236
  v_mul_f32 v53, v53, v236
  v_mul_f32 v54, v54, v236
  v_mul_f32 v55, v55, v236
  v_mul_f32 v56, v56, v236
  v_mul_f32 v57, v57, v236
  v_mul_f32 v58, v58, v236
  v_mul_f32 v59, v59, v236
  v_mul_f32 v60, v60, v236
  v_mul_f32 v61, v61, v236
  v_mul_f32 v62, v62, v236
  v_mul_f32 v63, v63, v236
  v_mul_f32 v228, v228, v236
  v_mul_f32 v229, v229, v236
  v_sub_f32 v176, v176, v235
  v_sub_f32 v177, v177, v235
  v_sub_f32 v178, v178, v235
  v_sub_f32 v179, v179, v235
  v_sub_f32 v180, v180, v235
  v_sub_f32 v181, v181, v235
  v_sub_f32 v182, v182, v235
  v_sub_f32 v183, v183, v235
  v_sub_f32 v184, v184, v235
  v_sub_f32 v185, v185, v235
  v_sub_f32 v186, v186, v235
  v_sub_f32 v187, v187, v235
  v_sub_f32 v188, v188, v235
  v_sub_f32 v189, v189, v235
  v_sub_f32 v190, v190, v235
  v_sub_f32 v191, v191, v235
  s_nop 1
  s_branch .Lat0_backa
.Lat0_rareb:
  s_nop 11
  v_mov_b32 v235, v231
  s_nop 1
  v_permlane32_swap_b32 v231, v235
  v_max3_f32 v235, v231, v235, 0
  v_exp_f32 v236, -v235
  v_sub_f32 v64, v64, v235
  v_sub_f32 v65, v65, v235
  v_sub_f32 v66, v66, v235
  v_sub_f32 v67, v67, v235
  v_sub_f32 v68, v68, v235
  v_sub_f32 v69, v69, v235
  v_sub_f32 v70, v70, v235
  v_sub_f32 v71, v71, v235
  v_sub_f32 v72, v72, v235
  v_sub_f32 v73, v73, v235
  v_sub_f32 v74, v74, v235
  v_sub_f32 v75, v75, v235
  v_sub_f32 v76, v76, v235
  v_sub_f32 v77, v77, v235
  v_sub_f32 v78, v78, v235
  v_sub_f32 v79, v79, v235
  v_sub_f32 v80, v80, v235
  v_sub_f32 v81, v81, v235
  v_sub_f32 v82, v82, v235
  v_sub_f32 v83, v83, v235
  v_sub_f32 v84, v84, v235
  v_sub_f32 v85, v85, v235
  v_sub_f32 v86, v86, v235
  v_sub_f32 v87, v87, v235
  v_sub_f32 v88, v88, v235
  v_sub_f32 v89, v89, v235
  v_sub_f32 v90, v90, v235
  v_sub_f32 v91, v91, v235
  v_sub_f32 v92, v92, v235
  v_sub_f32 v93, v93, v235
  v_sub_f32 v94, v94, v235
  v_sub_f32 v95, v95, v235
  v_mul_f32 v0, v0, v236
  v_mul_f32 v1, v1, v236
  v_mul_f32 v2, v2, v236
  v_mul_f32 v3, v3, v236
  v_mul_f32 v4, v4, v236
  v_mul_f32 v5, v5, v236
  v_mul_f32 v6, v6, v236
  v_mul_f32 v7, v7, v236
  v_mul_f32 v8, v8, v236
  v_mul_f32 v9, v9, v236
  v_mul_f32 v10, v10, v236
  v_mul_f32 v11, v11, v236
  v_mul_f32 v12, v12, v236
  v_mul_f32 v13, v13, v236
  v_mul_f32 v14, v14, v236
  v_mul_f32 v15, v15, v236
  v_mul_f32 v16, v16, v236
  v_mul_f32 v17, v17, v236
  v_mul_f32 v18, v18, v236
  v_mul_f32 v19, v19, v236
  v_mul_f32 v20, v20, v236
  v_mul_f32 v21, v21, v236
  v_mul_f32 v22, v22, v236
  v_mul_f32 v23, v23, v236
  v_mul_f32 v24, v24, v236
  v_mul_f32 v25, v25, v236
  v_mul_f32 v26, v26, v236
  v_mul_f32 v27, v27, v236
  v_mul_f32 v28, v28, v236
  v_mul_f32 v29, v29, v236
  v_mul_f32 v30, v30, v236
  v_mul_f32 v31, v31, v236
  v_mul_f32 v32, v32, v236
  v_mul_f32 v33, v33, v236
  v_mul_f32 v34, v34, v236
  v_mul_f32 v35, v35, v236
  v_mul_f32 v36, v36, v236
  v_mul_f32 v37, v37, v236
  v_mul_f32 v38, v38, v236
  v_mul_f32 v39, v39, v236
  v_mul_f32 v40, v40, v236
  v_mul_f32 v41, v41, v236
  v_mul_f32 v42, v42, v236
  v_mul_f32 v43, v43, v236
  v_mul_f32 v44, v44, v236
  v_mul_f32 v45, v45, v236
  v_mul_f32 v46, v46, v236
  v_mul_f32 v47, v47, v236
  v_mul_f32 v48, v48, v236
  v_mul_f32 v49, v49, v236
  v_mul_f32 v50, v50, v236
  v_mul_f32 v51, v51, v236
  v_mul_f32 v52, v52, v236
  v_mul_f32 v53, v53, v236
  v_mul_f32 v54, v54, v236
  v_mul_f32 v55, v55, v236
  v_mul_f32 v56, v56, v236
  v_mul_f32 v57, v57, v236
  v_mul_f32 v58, v58, v236
  v_mul_f32 v59, v59, v236
  v_mul_f32 v60, v60, v236
  v_mul_f32 v61, v61, v236
  v_mul_f32 v62, v62, v236
  v_mul_f32 v63, v63, v236
  v_mul_f32 v228, v228, v236
  v_mul_f32 v229, v229, v236
  v_sub_f32 v176, v176, v235
  v_sub_f32 v177, v177, v235
  v_sub_f32 v178, v178, v235
  v_sub_f32 v179, v179, v235
  v_sub_f32 v180, v180, v235
  v_sub_f32 v181, v181, v235
  v_sub_f32 v182, v182, v235
  v_sub_f32 v183, v183, v235
  v_sub_f32 v184, v184, v235
  v_sub_f32 v185, v185, v235
  v_sub_f32 v186, v186, v235
  v_sub_f32 v187, v187, v235
  v_sub_f32 v188, v188, v235
  v_sub_f32 v189, v189, v235
  v_sub_f32 v190, v190, v235
  v_sub_f32 v191, v191, v235
  s_nop 1
  s_branch .Lat0_backb
.Lat0_rarem0:
  s_nop 11
  v_mov_b32 v235, v231
  s_nop 1
  v_permlane32_swap_b32 v231, v235
  v_max3_f32 v235, v231, v235, 0
  v_exp_f32 v236, -v235
  v_sub_f32 v96, v96, v235
  v_sub_f32 v97, v97, v235
  v_sub_f32 v98, v98, v235
  v_sub_f32 v99, v99, v235
  v_sub_f32 v100, v100, v235
  v_sub_f32 v101, v101, v235
  v_sub_f32 v102, v102, v235
  v_sub_f32 v103, v103, v235
  v_sub_f32 v104, v104, v235
  v_sub_f32 v105, v105, v235
  v_sub_f32 v106, v106, v235
  v_sub_f32 v107, v107, v235
  v_sub_f32 v108, v108, v235
  v_sub_f32 v109, v109, v235
  v_sub_f32 v110, v110, v235
  v_sub_f32 v111, v111, v235
  v_sub_f32 v112, v112, v235
  v_sub_f32 v113, v113, v235
  v_sub_f32 v114, v114, v235
  v_sub_f32 v115, v115, v235
  v_sub_f32 v116, v116, v235
  v_sub_f32 v117, v117, v235
  v_sub_f32 v118, v118, v235
  v_sub_f32 v119, v119, v235
  v_sub_f32 v120, v120, v235
  v_sub_f32 v121, v121, v235
  v_sub_f32 v122, v122, v235
  v_sub_f32 v123, v123, v235
  v_sub_f32 v124, v124, v235
  v_sub_f32 v125, v125, v235
  v_sub_f32 v126, v126, v235
  v_sub_f32 v127, v127, v235
  v_mul_f32 v0, v0, v236
  v_mul_f32 v1, v1, v236
  v_mul_f32 v2, v2, v236
  v_mul_f32 v3, v3, v236
  v_mul_f32 v4, v4, v236
  v_mul_f32 v5, v5, v236
  v_mul_f32 v6, v6, v236
  v_mul_f32 v7, v7, v236
  v_mul_f32 v8, v8, v236
  v_mul_f32 v9, v9, v236
  v_mul_f32 v10, v10, v236
  v_mul_f32 v11, v11, v236
  v_mul_f32 v12, v12, v236
  v_mul_f32 v13, v13, v236
  v_mul_f32 v14, v14, v236
  v_mul_f32 v15, v15, v236
  v_mul_f32 v16, v16, v236
  v_mul_f32 v17, v17, v236
  v_mul_f32 v18, v18, v236
  v_mul_f32 v19, v19, v236
  v_mul_f32 v20, v20, v236
  v_mul_f32 v21, v21, v236
  v_mul_f32 v22, v22, v236
  v_mul_f32 v23, v23, v236
  v_mul_f32 v24, v24, v236
  v_mul_f32 v25, v25, v236
  v_mul_f32 v26, v26, v236
  v_mul_f32 v27, v27, v236
  v_mul_f32 v28, v28, v236
  v_mul_f32 v29, v29, v236
  v_mul_f32 v30, v30, v236
  v_mul_f32 v31, v31, v236
  v_mul_f32 v32, v32, v236
  v_mul_f32 v33, v33, v236
  v_mul_f32 v34, v34, v236
  v_mul_f32 v35, v35, v236
  v_mul_f32 v36, v36, v236
  v_mul_f32 v37, v37, v236
  v_mul_f32 v38, v38, v236
  v_mul_f32 v39, v39, v236
  v_mul_f32 v40, v40, v236
  v_mul_f32 v41, v41, v236
  v_mul_f32 v42, v42, v236
  v_mul_f32 v43, v43, v236
  v_mul_f32 v44, v44, v236
  v_mul_f32 v45, v45, v236
  v_mul_f32 v46, v46, v236
  v_mul_f32 v47, v47, v236
  v_mul_f32 v48, v48, v236
  v_mul_f32 v49, v49, v236
  v_mul_f32 v50, v50, v236
  v_mul_f32 v51, v51, v236
  v_mul_f32 v52, v52, v236
  v_mul_f32 v53, v53, v236
  v_mul_f32 v54, v54, v236
  v_mul_f32 v55, v55, v236
  v_mul_f32 v56, v56, v236
  v_mul_f32 v57, v57, v236
  v_mul_f32 v58, v58, v236
  v_mul_f32 v59, v59, v236
  v_mul_f32 v60, v60, v236
  v_mul_f32 v61, v61, v236
  v_mul_f32 v62, v62, v236
  v_mul_f32 v63, v63, v236
  v_mul_f32 v228, v228, v236
  v_mul_f32 v229, v229, v236
  v_sub_f32 v176, v176, v235
  v_sub_f32 v177, v177, v235
  v_sub_f32 v178, v178, v235
  v_sub_f32 v179, v179, v235
  v_sub_f32 v180, v180, v235
  v_sub_f32 v181, v181, v235
  v_sub_f32 v182, v182, v235
  v_sub_f32 v183, v183, v235
  v_sub_f32 v184, v184, v235
  v_sub_f32 v185, v185, v235
  v_sub_f32 v186, v186, v235
  v_sub_f32 v187, v187, v235
  v_sub_f32 v188, v188, v235
  v_sub_f32 v189, v189, v235
  v_sub_f32 v190, v190, v235
  v_sub_f32 v191, v191, v235
  s_nop 1
  s_branch .Lat0_backm0
.Lat0_rarem1:
  s_nop 11
  v_mov_b32 v235, v231
  s_nop 1
  v_permlane32_swap_b32 v231, v235
  v_max3_f32 v235, v231, v235, 0
  v_exp_f32 v236, -v235
  v_sub_f32 v64, v64, v235
  v_sub_f32 v65, v65, v235
  v_sub_f32 v66, v66, v235
  v_sub_f32 v67, v67, v235
  v_sub_f32 v68, v68, v235
  v_sub_f32 v69, v69, v235
  v_sub_f32 v70, v70, v235
  v_sub_f32 v71, v71, v235
  v_sub_f32 v72, v72, v235
  v_sub_f32 v73, v73, v235
  v_sub_f32 v74, v74, v235
  v_sub_f32 v75, v75, v235
  v_sub_f32 v76, v76, v235
  v_sub_f32 v77, v77, v235
  v_sub_f32 v78, v78, v235
  v_sub_f32 v79, v79, v235
  v_sub_f32 v80, v80, v235
  v_sub_f32 v81, v81, v235
  v_sub_f32 v82, v82, v235
  v_sub_f32 v83, v83, v235
  v_sub_f32 v84, v84, v235
  v_sub_f32 v85, v85, v235
  v_sub_f32 v86, v86, v235
  v_sub_f32 v87, v87, v235
  v_sub_f32 v88, v88, v235
  v_sub_f32 v89, v89, v235
  v_sub_f32 v90, v90, v235
  v_sub_f32 v91, v91, v235
  v_sub_f32 v92, v92, v235
  v_sub_f32 v93, v93, v235
  v_sub_f32 v94, v94, v235
  v_sub_f32 v95, v95, v235
  v_mul_f32 v0, v0, v236
  v_mul_f32 v1, v1, v236
  v_mul_f32 v2, v2, v236
  v_mul_f32 v3, v3, v236
  v_mul_f32 v4, v4, v236
  v_mul_f32 v5, v5, v236
  v_mul_f32 v6, v6, v236
  v_mul_f32 v7, v7, v236
  v_mul_f32 v8, v8, v236
  v_mul_f32 v9, v9, v236
  v_mul_f32 v10, v10, v236
  v_mul_f32 v11, v11, v236
  v_mul_f32 v12, v12, v236
  v_mul_f32 v13, v13, v236
  v_mul_f32 v14, v14, v236
  v_mul_f32 v15, v15, v236
  v_mul_f32 v16, v16, v236
  v_mul_f32 v17, v17, v236
  v_mul_f32 v18, v18, v236
  v_mul_f32 v19, v19, v236
  v_mul_f32 v20, v20, v236
  v_mul_f32 v21, v21, v236
  v_mul_f32 v22, v22, v236
  v_mul_f32 v23, v23, v236
  v_mul_f32 v24, v24, v236
  v_mul_f32 v25, v25, v236
  v_mul_f32 v26, v26, v236
  v_mul_f32 v27, v27, v236
  v_mul_f32 v28, v28, v236
  v_mul_f32 v29, v29, v236
  v_mul_f32 v30, v30, v236
  v_mul_f32 v31, v31, v236
  v_mul_f32 v32, v32, v236
  v_mul_f32 v33, v33, v236
  v_mul_f32 v34, v34, v236
  v_mul_f32 v35, v35, v236
  v_mul_f32 v36, v36, v236
  v_mul_f32 v37, v37, v236
  v_mul_f32 v38, v38, v236
  v_mul_f32 v39, v39, v236
  v_mul_f32 v40, v40, v236
  v_mul_f32 v41, v41, v236
  v_mul_f32 v42, v42, v236
  v_mul_f32 v43, v43, v236
  v_mul_f32 v44, v44, v236
  v_mul_f32 v45, v45, v236
  v_mul_f32 v46, v46, v236
  v_mul_f32 v47, v47, v236
  v_mul_f32 v48, v48, v236
  v_mul_f32 v49, v49, v236
  v_mul_f32 v50, v50, v236
  v_mul_f32 v51, v51, v236
  v_mul_f32 v52, v52, v236
  v_mul_f32 v53, v53, v236
  v_mul_f32 v54, v54, v236
  v_mul_f32 v55, v55, v236
  v_mul_f32 v56, v56, v236
  v_mul_f32 v57, v57, v236
  v_mul_f32 v58, v58, v236
  v_mul_f32 v59, v59, v236
  v_mul_f32 v60, v60, v236
  v_mul_f32 v61, v61, v236
  v_mul_f32 v62, v62, v236
  v_mul_f32 v63, v63, v236
  v_mul_f32 v228, v228, v236
  v_mul_f32 v229, v229, v236
  v_sub_f32 v176, v176, v235
  v_sub_f32 v177, v177, v235
  v_sub_f32 v178, v178, v235
  v_sub_f32 v179, v179, v235
  v_sub_f32 v180, v180, v235
  v_sub_f32 v181, v181, v235
  v_sub_f32 v182, v182, v235
  v_sub_f32 v183, v183, v235
  v_sub_f32 v184, v184, v235
  v_sub_f32 v185, v185, v235
  v_sub_f32 v186, v186, v235
  v_sub_f32 v187, v187, v235
  v_sub_f32 v188, v188, v235
  v_sub_f32 v189, v189, v235
  v_sub_f32 v190, v190, v235
  v_sub_f32 v191, v191, v235
  s_nop 1
  s_branch .Lat0_backm1
.Lat1_first:
  s_cmp_eq_u32 s3, 6
  s_cselect_b32 s52, s22, s14
  s_cselect_b32 s53, s23, s15
  s_mov_b32 s54, 0x400000
  s_cselect_b32 s54, 1835008, s54
  s_movk_i32 s58, 128
  s_cselect_b32 s58, 56, s58
  s_mul_i32 s58, s58, s2
  s_and_b32 s59, s3, 1
  s_lshl_b32 s59, s59, 6
  s_add_u32 s58, s58, s59
  s_lshl_b32 s58, s58, 7
  v_lshlrev_b32 v235, 7, v255
  buffer_load_dword v248, v235, s[52:55], s58 offen
  s_waitcnt lgkmcnt(7)
  v_mfma_f32_32x32x16_bf16 v[64:79], v[192:195], v[128:131], 0
  ds_read_b128 v[192:195], v224 offset:8192
  s_waitcnt lgkmcnt(7)
  v_mfma_f32_32x32x16_bf16 v[64:79], v[196:199], v[132:135], v[64:79]
  ds_read_b128 v[196:199], v224 offset:9216
  s_waitcnt lgkmcnt(7)
  v_mfma_f32_32x32x16_bf16 v[64:79], v[200:203], v[136:139], v[64:79]
  ds_read_b128 v[200:203], v224 offset:10240
  s_waitcnt lgkmcnt(7)
  v_mfma_f32_32x32x16_bf16 v[64:79], v[204:207], v[140:143], v[64:79]
  ds_read_b128 v[204:207], v224 offset:11264
  s_waitcnt lgkmcnt(7)
  v_mfma_f32_32x32x16_bf16 v[64:79], v[208:211], v[144:147], v[64:79]
  ds_read_b128 v[208:211], v224 offset:12288
  s_waitcnt lgkmcnt(7)
  v_mfma_f32_32x32x16_bf16 v[64:79], v[212:215], v[148:151], v[64:79]
  ds_read_b128 v[212:215], v224 offset:13312
  s_waitcnt lgkmcnt(7)
  v_mfma_f32_32x32x16_bf16 v[64:79], v[216:219], v[152:155], v[64:79]
  ds_read_b128 v[216:219], v224 offset:14336
  s_waitcnt lgkmcnt(7)
  v_mfma_f32_32x32x16_bf16 v[64:79], v[220:223], v[156:159], v[64:79]
  ds_read_b128 v[220:223], v224 offset:15360
  v_add_u32 v224, 0x4000, v224
  v_and_b32 v224, 0xffff, v224
  v_or_b32 v224, 0x10000, v224
  s_waitcnt lgkmcnt(7)
  v_mfma_f32_32x32x16_bf16 v[80:95], v[192:195], v[128:131], 0
  ds_read_b128 v[192:195], v224 offset:0
  s_waitcnt lgkmcnt(7)
  v_mfma_f32_32x32x16_bf16 v[80:95], v[196:199], v[132:135], v[80:95]
  ds_read_b128 v[196:199], v224 offset:1024
  s_waitcnt lgkmcnt(7)
  v_mfma_f32_32x32x16_bf16 v[80:95], v[200:203], v[136:139], v[80:95]
  ds_read_b128 v[200:203], v224 offset:2048
  s_waitcnt lgkmcnt(7)
  v_mfma_f32_32x32x16_bf16 v[80:95], v[204:207], v[140:143], v[80:95]
  ds_read_b128 v[204:207], v224 offset:3072
  s_waitcnt lgkmcnt(7)
  v_mfma_f32_32x32x16_bf16 v[80:95], v[208:211], v[144:147], v[80:95]
  ds_read_b128 v[208:211], v224 offset:4096
  v_max3_f32 v230, v64, v65, v66
  v_max3_f32 v230, v230, v67, v68
  s_waitcnt lgkmcnt(7)
  v_mfma_f32_32x32x16_bf16 v[80:95], v[212:215], v[148:151], v[80:95]
  ds_read_b128 v[212:215], v224 offset:5120
  v_max3_f32 v230, v230, v69, v70
  v_max3_f32 v230, v230, v71, v72
  s_waitcnt lgkmcnt(7)
  v_mfma_f32_32x32x16_bf16 v[80:95], v[216:219], v[152:155], v[80:95]
  ds_read_b128 v[216:219], v224 offset:6144
  v_max3_f32 v230, v230, v73, v74
  v_max3_f32 v230, v230, v75, v76
  s_waitcnt lgkmcnt(7)
  v_mfma_f32_32x32x16_bf16 v[80:95], v[220:223], v[156:159], v[80:95]
  ds_read_b128 v[220:223], v224 offset:7168
  v_max3_f32 v230, v230, v77, v78
  v_max_f32 v230, v230, v79
  s_barrier
  s_nop 7
  v_max3_f32 v231, v80, v81, v82
  v_max3_f32 v231, v231, v83, v84
  v_max3_f32 v231, v231, v85, v86
  v_max3_f32 v231, v231, v87, v88
  v_max3_f32 v231, v231, v89, v90
  v_max3_f32 v231, v231, v91, v92
  v_max3_f32 v231, v231, v93, v94
  v_max3_f32 v231, v231, v95, v230
  v_mov_b32 v235, v231
  s_nop 1
  v_permlane32_swap_b32 v231, v235
  v_max_f32 v231, v231, v235
  v_sub_f32 v176, 0, v231
  v_sub_f32 v64, v64, v231
  v_sub_f32 v65, v65, v231
  v_sub_f32 v66, v66, v231
  v_sub_f32 v67, v67, v231
  v_sub_f32 v68, v68, v231
  v_sub_f32 v69, v69, v231
  v_sub_f32 v70, v70, v231
  v_sub_f32 v71, v71, v231
  v_sub_f32 v72, v72, v231
  v_sub_f32 v73, v73, v231
  v_sub_f32 v74, v74, v231
  v_sub_f32 v75, v75, v231
  v_sub_f32 v76, v76, v231
  v_sub_f32 v77, v77, v231
  v_sub_f32 v78, v78, v231
  v_sub_f32 v79, v79, v231
  v_sub_f32 v80, v80, v231
  v_sub_f32 v81, v81, v231
  v_sub_f32 v82, v82, v231
  v_sub_f32 v83, v83, v231
  v_sub_f32 v84, v84, v231
  v_sub_f32 v85, v85, v231
  v_sub_f32 v86, v86, v231
  v_sub_f32 v87, v87, v231
  v_sub_f32 v88, v88, v231
  v_sub_f32 v89, v89, v231
  v_sub_f32 v90, v90, v231
  v_sub_f32 v91, v91, v231
  v_sub_f32 v92, v92, v231
  v_sub_f32 v93, v93, v231
  v_sub_f32 v94, v94, v231
  v_sub_f32 v95, v95, v231
  v_mov_b32 v177, v176
  v_mov_b32 v178, v176
  v_mov_b32 v179, v176
  v_mov_b32 v180, v176
  v_mov_b32 v181, v176
  v_mov_b32 v182, v176
  v_mov_b32 v183, v176
  v_mov_b32 v184, v176
  v_mov_b32 v185, v176
  v_mov_b32 v186, v176
  v_mov_b32 v187, v176
  v_mov_b32 v188, v176
  v_mov_b32 v189, v176
  v_mov_b32 v190, v176
  v_mov_b32 v191, v176
  s_waitcnt lgkmcnt(4)
  s_cmp_eq_u32 s71, 0
  s_cbranch_scc1 .Lat1_tail0
  s_cmp_eq_u32 s71, 1
  s_cbranch_scc1 .Lat1_mask0
.Lat1_loop:
  v_mfma_f32_32x32x16_bf16 v[96:111], v[192:195], v[128:131], v[176:191]
  ds_read_b128 v[192:195], v224 offset:8192
  v_exp_f32 v64, v64
  v_exp_f32 v65, v65
  v_add_f32 v228, v228, v64
  v_mfma_f32_32x32x16_bf16 v[96:111], v[196:199], v[132:135], v[96:111]
  ds_read_b128 v[196:199], v224 offset:9216
  v_exp_f32 v66, v66
  v_exp_f32 v67, v67
  v_cvt_pk_bf16_f32 v160, v64, v65
  v_mfma_f32_32x32x16_bf16 v[96:111], v[200:203], v[136:139], v[96:111]
  ds_read_b128 v[200:203], v224 offset:10240
  v_exp_f32 v68, v68
  v_exp_f32 v69, v69
  v_cvt_pk_bf16_f32 v161, v66, v67
  v_mfma_f32_32x32x16_bf16 v[96:111], v[204:207], v[140:143], v[96:111]
  ds_read_b128 v[204:207], v224 offset:11264
  v_exp_f32 v70, v70
  v_exp_f32 v71, v71
  s_waitcnt lgkmcnt(4)
  v_mfma_f32_32x32x16_bf16 v[96:111], v[208:211], v[144:147], v[96:111]
  ds_read_b128 v[208:211], v224 offset:12288
  v_cvt_pk_bf16_f32 v162, v68, v69
  v_cvt_pk_bf16_f32 v163, v70, v71
  v_exp_f32 v72, v72
  v_add_f32 v229, v229, v65
  v_mfma_f32_32x32x16_bf16 v[96:111], v[212:215], v[148:151], v[96:111]
  ds_read_b128 v[212:215], v224 offset:13312
  v_exp_f32 v73, v73
  v_exp_f32 v74, v74
  v_cvt_pk_bf16_f32 v164, v72, v73
  v_mfma_f32_32x32x16_bf16 v[96:111], v[216:219], v[152:155], v[96:111]
  ds_read_b128 v[216:219], v224 offset:14336
  v_exp_f32 v75, v75
  v_exp_f32 v76, v76
  v_cvt_pk_bf16_f32 v165, v74, v75
  v_mfma_f32_32x32x16_bf16 v[96:111], v[220:223], v[156:159], v[96:111]
  ds_read_b128 v[220:223], v224 offset:15360
  v_exp_f32 v77, v77
  v_exp_f32 v78, v78
  s_waitcnt lgkmcnt(4)
  v_mfma_f32_32x32x16_bf16 v[112:127], v[192:195], v[128:131], v[176:191]
  ds_read_b128 v[192:195], v225 offset:0
  v_add_u32 v224, 0x4000, v224
  v_and_b32 v224, 0xffff, v224
  v_or_b32 v224, 0x10000, v224
  v_exp_f32 v79, v79
  v_mfma_f32_32x32x16_bf16 v[112:127], v[196:199], v[132:135], v[112:127]
  ds_read_b128 v[196:199], v225 offset:2048
  v_cvt_pk_bf16_f32 v166, v76, v77
  v_cvt_pk_bf16_f32 v167, v78, v79
  v_exp_f32 v80, v80
  v_add_f32 v228, v228, v66
  v_mfma_f32_32x32x16_bf16 v[112:127], v[200:203], v[136:139], v[112:127]
  ds_read_b128 v[200:203], v225 offset:4096
  v_exp_f32 v81, v81
  v_exp_f32 v82, v82
  v_cvt_pk_bf16_f32 v168, v80, v81
  v_mfma_f32_32x32x16_bf16 v[112:127], v[204:207], v[140:143], v[112:127]
  ds_read_b128 v[204:207], v225 offset:6144
  v_exp_f32 v83, v83
  v_exp_f32 v84, v84
  s_waitcnt lgkmcnt(4)
  v_mfma_f32_32x32x16_bf16 v[112:127], v[208:211], v[144:147], v[112:127]
  ds_read_b128 v[208:211], v225 offset:1024
  v_exp_f32 v85, v85
  v_exp_f32 v86, v86
  v_cvt_pk_bf16_f32 v169, v82, v83
  v_mfma_f32_32x32x16_bf16 v[112:127], v[212:215], v[148:151], v[112:127]
  ds_read_b128 v[212:215], v225 offset:3072
  v_exp_f32 v87, v87
  v_cvt_pk_bf16_f32 v170, v84, v85
  v_cvt_pk_bf16_f32 v171, v86, v87
  v_max3_f32 v230, v96, v97, v98
  v_mfma_f32_32x32x16_bf16 v[112:127], v[216:219], v[152:155], v[112:127]
  ds_read_b128 v[216:219], v225 offset:5120
  v_exp_f32 v88, v88
  v_exp_f32 v89, v89
  v_max3_f32 v230, v230, v99, v100
  v_mfma_f32_32x32x16_bf16 v[112:127], v[220:223], v[156:159], v[112:127]
  ds_read_b128 v[220:223], v225 offset:7168
  v_exp_f32 v90, v90
  v_exp_f32 v91, v91
  s_waitcnt lgkmcnt(4)
  v_mfma_f32_32x32x16_bf16 v[0:15], v[192:195], v[160:163], v[0:15]
  ds_read_b128 v[192:195], v225 offset:8192
  v_exp_f32 v92, v92
  v_exp_f32 v93, v93
  v_cvt_pk_bf16_f32 v172, v88, v89
  v_mfma_f32_32x32x16_bf16 v[16:31], v[196:199], v[160:163], v[16:31]
  ds_read_b128 v[196:199], v225 offset:10240
  v_exp_f32 v94, v94
  v_exp_f32 v95, v95
  v_cvt_pk_bf16_f32 v173, v90, v91
  v_mfma_f32_32x32x16_bf16 v[32:47], v[200:203], v[160:163], v[32:47]
  ds_read_b128 v[200:203], v225 offset:12288
  v_cvt_pk_bf16_f32 v174, v92, v93
  v_cvt_pk_bf16_f32 v175, v94, v95
  v_max3_f32 v230, v230, v101, v102
  v_add_f32 v229, v229, v67
  v_max3_f32 v230, v230, v103, v104
  v_mfma_f32_32x32x16_bf16 v[48:63], v[204:207], v[160:163], v[48:63]
  ds_read_b128 v[204:207], v225 offset:14336
  v_max3_f32 v230, v230, v105, v106
  v_add_f32 v228, v228, v68
  v_max3_f32 v230, v230, v107, v108
  v_add_f32 v229, v229, v69
  s_waitcnt lgkmcnt(4)
  v_mfma_f32_32x32x16_bf16 v[0:15], v[208:211], v[164:167], v[0:15]
  ds_read_b128 v[208:211], v225 offset:9216
  v_max3_f32 v230, v230, v109, v110
  v_add_f32 v228, v228, v70
  v_max_f32 v230, v230, v111
  v_add_f32 v229, v229, v71
  v_max3_f32 v231, v112, v113, v114
  v_mfma_f32_32x32x16_bf16 v[16:31], v[212:215], v[164:167], v[16:31]
  ds_read_b128 v[212:215], v225 offset:11264
  v_max3_f32 v231, v231, v115, v116
  v_add_f32 v228, v228, v72
  v_max3_f32 v231, v231, v117, v118
  v_add_f32 v229, v229, v73
  v_max3_f32 v231, v231, v119, v120
  v_mfma_f32_32x32x16_bf16 v[32:47], v[216:219], v[164:167], v[32:47]
  ds_read_b128 v[216:219], v225 offset:13312
  v_max3_f32 v231, v231, v121, v122
  v_add_f32 v228, v228, v74
  v_max3_f32 v231, v231, v123, v124
  v_add_f32 v229, v229, v75
  v_max3_f32 v231, v231, v125, v126
  v_mfma_f32_32x32x16_bf16 v[48:63], v[220:223], v[164:167], v[48:63]
  ds_read_b128 v[220:223], v225 offset:15360
  v_max3_f32 v231, v231, v127, v230
  v_add_f32 v228, v228, v76
  v_add_f32 v229, v229, v77
  v_add_f32 v228, v228, v78
  s_waitcnt lgkmcnt(4)
  v_mfma_f32_32x32x16_bf16 v[0:15], v[192:195], v[168:171], v[0:15]
  ds_read_b128 v[192:195], v224 offset:0
  v_add_u32 v225, 0x4000, v225
  v_and_b32 v225, 0xffff, v225
  v_add_f32 v229, v229, v79
  v_add_f32 v228, v228, v80
  v_add_f32 v229, v229, v81
  v_mfma_f32_32x32x16_bf16 v[16:31], v[196:199], v[168:171], v[16:31]
  ds_read_b128 v[196:199], v224 offset:1024
  v_add_f32 v228, v228, v82
  v_add_f32 v229, v229, v83
  v_add_f32 v228, v228, v84
  v_add_f32 v229, v229, v85
  v_add_f32 v228, v228, v86
  v_mfma_f32_32x32x16_bf16 v[32:47], v[200:203], v[168:171], v[32:47]
  ds_read_b128 v[200:203], v224 offset:2048
  v_add_f32 v229, v229, v87
  v_add_f32 v228, v228, v88
  v_add_f32 v229, v229, v89
  v_add_f32 v228, v228, v90
  v_add_f32 v229, v229, v91
  v_mfma_f32_32x32x16_bf16 v[48:63], v[204:207], v[168:171], v[48:63]
  ds_read_b128 v[204:207], v224 offset:3072
  v_add_f32 v228, v228, v92
  v_add_f32 v229, v229, v93
  v_add_f32 v228, v228, v94
  v_add_f32 v229, v229, v95
  s_waitcnt lgkmcnt(4)
  v_mfma_f32_32x32x16_bf16 v[0:15], v[208:211], v[172:175], v[0:15]
  ds_read_b128 v[208:211], v224 offset:4096
  v_mfma_f32_32x32x16_bf16 v[16:31], v[212:215], v[172:175], v[16:31]
  ds_read_b128 v[212:215], v224 offset:5120
  v_mfma_f32_32x32x16_bf16 v[32:47], v[216:219], v[172:175], v[32:47]
  ds_read_b128 v[216:219], v224 offset:6144
  v_mfma_f32_32x32x16_bf16 v[48:63], v[220:223], v[172:175], v[48:63]
  ds_read_b128 v[220:223], v224 offset:7168
  s_barrier
  s_waitcnt lgkmcnt(4)
  v_cmp_lt_f32 vcc, s76, v231
  s_cbranch_vccnz .Lat1_rarea
.Lat1_backa:
  s_sub_u32 s71, s71, 1
  s_cmp_eq_u32 s71, 1
  s_cbranch_scc1 .Lat1_mask1
  v_mfma_f32_32x32x16_bf16 v[64:79], v[192:195], v[128:131], v[176:191]
  ds_read_b128 v[192:195], v224 offset:8192
  v_exp_f32 v96, v96
  v_exp_f32 v97, v97
  v_add_f32 v228, v228, v96
  v_mfma_f32_32x32x16_bf16 v[64:79], v[196:199], v[132:135], v[64:79]
  ds_read_b128 v[196:199], v224 offset:9216
  v_exp_f32 v98, v98
  v_exp_f32 v99, v99
  v_cvt_pk_bf16_f32 v160, v96, v97
  v_mfma_f32_32x32x16_bf16 v[64:79], v[200:203], v[136:139], v[64:79]
  ds_read_b128 v[200:203], v224 offset:10240
  v_exp_f32 v100, v100
  v_exp_f32 v101, v101
  v_cvt_pk_bf16_f32 v161, v98, v99
  v_mfma_f32_32x32x16_bf16 v[64:79], v[204:207], v[140:143], v[64:79]
  ds_read_b128 v[204:207], v224 offset:11264
  v_exp_f32 v102, v102
  v_exp_f32 v103, v103
  s_waitcnt lgkmcnt(4)
  v_mfma_f32_32x32x16_bf16 v[64:79], v[208:211], v[144:147], v[64:79]
  ds_read_b128 v[208:211], v224 offset:12288
  v_cvt_pk_bf16_f32 v162, v100, v101
  v_cvt_pk_bf16_f32 v163, v102, v103
  v_exp_f32 v104, v104
  v_add_f32 v229, v229, v97
  v_mfma_f32_32x32x16_bf16 v[64:79], v[212:215], v[148:151], v[64:79]
  ds_read_b128 v[212:215], v224 offset:13312
  v_exp_f32 v105, v105
  v_exp_f32 v106, v106
  v_cvt_pk_bf16_f32 v164, v104, v105
  v_mfma_f32_32x32x16_bf16 v[64:79], v[216:219], v[152:155], v[64:79]
  ds_read_b128 v[216:219], v224 offset:14336
  v_exp_f32 v107, v107
  v_exp_f32 v108, v108
  v_cvt_pk_bf16_f32 v165, v106, v107
  v_mfma_f32_32x32x16_bf16 v[64:79], v[220:223], v[156:159], v[64:79]
  ds_read_b128 v[220:223], v224 offset:15360
  v_exp_f32 v109, v109
  v_exp_f32 v110, v110
  s_waitcnt lgkmcnt(4)
  v_mfma_f32_32x32x16_bf16 v[80:95], v[192:195], v[128:131], v[176:191]
  ds_read_b128 v[192:195], v225 offset:0
  v_add_u32 v224, 0x4000, v224
  v_and_b32 v224, 0xffff, v224
  v_or_b32 v224, 0x10000, v224
  v_exp_f32 v111, v111
  v_mfma_f32_32x32x16_bf16 v[80:95], v[196:199], v[132:135], v[80:95]
  ds_read_b128 v[196:199], v225 offset:2048
  v_cvt_pk_bf16_f32 v166, v108, v109
  v_cvt_pk_bf16_f32 v167, v110, v111
  v_exp_f32 v112, v112
  v_add_f32 v228, v228, v98
  v_mfma_f32_32x32x16_bf16 v[80:95], v[200:203], v[136:139], v[80:95]
  ds_read_b128 v[200:203], v225 offset:4096
  v_exp_f32 v113, v113
  v_exp_f32 v114, v114
  v_cvt_pk_bf16_f32 v168, v112, v113
  v_mfma_f32_32x32x16_bf16 v[80:95], v[204:207], v[140:143], v[80:95]
  ds_read_b128 v[204:207], v225 offset:6144
  v_exp_f32 v115, v115
  v_exp_f32 v116, v116
  s_waitcnt lgkmcnt(4)
  v_mfma_f32_32x32x16_bf16 v[80:95], v[208:211], v[144:147], v[80:95]
  ds_read_b128 v[208:211], v225 offset:1024
  v_exp_f32 v117, v117
  v_exp_f32 v118, v118
  v_cvt_pk_bf16_f32 v169, v114, v115
  v_mfma_f32_32x32x16_bf16 v[80:95], v[212:215], v[148:151], v[80:95]
  ds_read_b128 v[212:215], v225 offset:3072
  v_exp_f32 v119, v119
  v_cvt_pk_bf16_f32 v170, v116, v117
  v_cvt_pk_bf16_f32 v171, v118, v119
  v_max3_f32 v230, v64, v65, v66
  v_mfma_f32_32x32x16_bf16 v[80:95], v[216:219], v[152:155], v[80:95]
  ds_read_b128 v[216:219], v225 offset:5120
  v_exp_f32 v120, v120
  v_exp_f32 v121, v121
  v_max3_f32 v230, v230, v67, v68
  v_mfma_f32_32x32x16_bf16 v[80:95], v[220:223], v[156:159], v[80:95]
  ds_read_b128 v[220:223], v225 offset:7168
  v_exp_f32 v122, v122
  v_exp_f32 v123, v123
  s_waitcnt lgkmcnt(4)
  v_mfma_f32_32x32x16_bf16 v[0:15], v[192:195], v[160:163], v[0:15]
  ds_read_b128 v[192:195], v225 offset:8192
  v_exp_f32 v124, v124
  v_exp_f32 v125, v125
  v_cvt_pk_bf16_f32 v172, v120, v121
  v_mfma_f32_32x32x16_bf16 v[16:31], v[196:199], v[160:163], v[16:31]
  ds_read_b128 v[196:199], v225 offset:10240
  v_exp_f32 v126, v126
  v_exp_f32 v127, v127
  v_cvt_pk_bf16_f32 v173, v122, v123
  v_mfma_f32_32x32x16_bf16 v[32:47], v[200:203], v[160:163], v[32:47]
  ds_read_b128 v[200:203], v225 offset:12288
  v_cvt_pk_bf16_f32 v174, v124, v125
  v_cvt_pk_bf16_f32 v175, v126, v127
  v_max3_f32 v230, v230, v69, v70
  v_add_f32 v229, v229, v99
  v_max3_f32 v230, v230, v71, v72
  v_mfma_f32_32x32x16_bf16 v[48:63], v[204:207], v[160:163], v[48:63]
  ds_read_b128 v[204:207], v225 offset:14336
  v_max3_f32 v230, v230, v73, v74
  v_add_f32 v228, v228, v100
  v_max3_f32 v230, v230, v75, v76
  v_add_f32 v229, v229, v101
  s_waitcnt lgkmcnt(4)
  v_mfma_f32_32x32x16_bf16 v[0:15], v[208:211], v[164:167], v[0:15]
  ds_read_b128 v[208:211], v225 offset:9216
  v_max3_f32 v230, v230, v77, v78
  v_add_f32 v228, v228, v102
  v_max_f32 v230, v230, v79
  v_add_f32 v229, v229, v103
  v_max3_f32 v231, v80, v81, v82
  v_mfma_f32_32x32x16_bf16 v[16:31], v[212:215], v[164:167], v[16:31]
  ds_read_b128 v[212:215], v225 offset:11264
  v_max3_f32 v231, v231, v83, v84
  v_add_f32 v228, v228, v104
  v_max3_f32 v231, v231, v85, v86
  v_add_f32 v229, v229, v105
  v_max3_f32 v231, v231, v87, v88
  v_mfma_f32_32x32x16_bf16 v[32:47], v[216:219], v[164:167], v[32:47]
  ds_read_b128 v[216:219], v225 offset:13312
  v_max3_f32 v231, v231, v89, v90
  v_add_f32 v228, v228, v106
  v_max3_f32 v231, v231, v91, v92
  v_add_f32 v229, v229, v107
  v_max3_f32 v231, v231, v93, v94
  v_mfma_f32_32x32x16_bf16 v[48:63], v[220:223], v[164:167], v[48:63]
  ds_read_b128 v[220:223], v225 offset:15360
  v_max3_f32 v231, v231, v95, v230
  v_add_f32 v228, v228, v108
  v_add_f32 v229, v229, v109
  v_add_f32 v228, v228, v110
  s_waitcnt lgkmcnt(4)
  v_mfma_f32_32x32x16_bf16 v[0:15], v[192:195], v[168:171], v[0:15]
  ds_read_b128 v[192:195], v224 offset:0
  v_add_u32 v225, 0x4000, v225
  v_and_b32 v225, 0xffff, v225
  v_add_f32 v229, v229, v111
  v_add_f32 v228, v228, v112
  v_add_f32 v229, v229, v113
  v_mfma_f32_32x32x16_bf16 v[16:31], v[196:199], v[168:171], v[16:31]
  ds_read_b128 v[196:199], v224 offset:1024
  v_add_f32 v228, v228, v114
  v_add_f32 v229, v229, v115
  v_add_f32 v228, v228, v116
  v_add_f32 v229, v229, v117
  v_add_f32 v228, v228, v118
  v_mfma_f32_32x32x16_bf16 v[32:47], v[200:203], v[168:171], v[32:47]
  ds_read_b128 v[200:203], v224 offset:2048
  v_add_f32 v229, v229, v119
  v_add_f32 v228, v228, v120
  v_add_f32 v229, v229, v121
  v_add_f32 v228, v228, v122
  v_add_f32 v229, v229, v123
  v_mfma_f32_32x32x16_bf16 v[48:63], v[204:207], v[168:171], v[48:63]
  ds_read_b128 v[204:207], v224 offset:3072
  v_add_f32 v228, v228, v124
  v_add_f32 v229, v229, v125
  v_add_f32 v228, v228, v126
  v_add_f32 v229, v229, v127
  s_waitcnt lgkmcnt(4)
  v_mfma_f32_32x32x16_bf16 v[0:15], v[208:211], v[172:175], v[0:15]
  ds_read_b128 v[208:211], v224 offset:4096
  v_mfma_f32_32x32x16_bf16 v[16:31], v[212:215], v[172:175], v[16:31]
  ds_read_b128 v[212:215], v224 offset:5120
  v_mfma_f32_32x32x16_bf16 v[32:47], v[216:219], v[172:175], v[32:47]
  ds_read_b128 v[216:219], v224 offset:6144
  v_mfma_f32_32x32x16_bf16 v[48:63], v[220:223], v[172:175], v[48:63]
  ds_read_b128 v[220:223], v224 offset:7168
  s_barrier
  s_waitcnt lgkmcnt(4)
  v_cmp_lt_f32 vcc, s76, v231
  s_cbranch_vccnz .Lat1_rareb
.Lat1_backb:
  s_sub_u32 s71, s71, 1
  s_cmp_lg_u32 s71, 1
  s_cbranch_scc1 .Lat1_loop
.Lat1_mask0:
  v_cmp_gt_i32 vcc, 0, v233
  v_cmp_gt_i32 s[80:81], 1, v233
  v_cmp_gt_i32 s[82:83], 2, v233
  v_cmp_gt_i32 s[84:85], 3, v233
  v_cndmask_b32 v96, v176, v238, vcc
  v_cmp_gt_i32 vcc, 8, v233
  v_cndmask_b32 v97, v176, v238, s[80:81]
  v_cmp_gt_i32 s[80:81], 9, v233
  v_cndmask_b32 v98, v176, v238, s[82:83]
  v_cmp_gt_i32 s[82:83], 10, v233
  v_cndmask_b32 v99, v176, v238, s[84:85]
  v_cmp_gt_i32 s[84:85], 11, v233
  v_cndmask_b32 v100, v176, v238, vcc
  v_cmp_gt_i32 vcc, 16, v233
  v_cndmask_b32 v101, v176, v238, s[80:81]
  v_cmp_gt_i32 s[80:81], 17, v233
  v_cndmask_b32 v102, v176, v238, s[82:83]
  v_cmp_gt_i32 s[82:83], 18, v233
  v_cndmask_b32 v103, v176, v238, s[84:85]
  v_cmp_gt_i32 s[84:85], 19, v233
  v_cndmask_b32 v104, v176, v238, vcc
  v_cmp_gt_i32 vcc, 24, v233
  v_cndmask_b32 v105, v176, v238, s[80:81]
  v_cmp_gt_i32 s[80:81], 25, v233
  v_cndmask_b32 v106, v176, v238, s[82:83]
  v_cmp_gt_i32 s[82:83], 26, v233
  v_cndmask_b32 v107, v176, v238, s[84:85]
  v_cmp_gt_i32 s[84:85], 27, v233
  v_cndmask_b32 v108, v176, v238, vcc
  v_cmp_gt_i32 vcc, 32, v233
  v_cndmask_b32 v109, v176, v238, s[80:81]
  v_cmp_gt_i32 s[80:81], 33, v233
  v_cndmask_b32 v110, v176, v238, s[82:83]
  v_cmp_gt_i32 s[82:83], 34, v233
  v_cndmask_b32 v111, v176, v238, s[84:85]
  v_cmp_gt_i32 s[84:85], 35, v233
  v_cndmask_b32 v112, v176, v238, vcc
  v_cmp_gt_i32 vcc, 40, v233
  v_cndmask_b32 v113, v176, v238, s[80:81]
  v_cmp_gt_i32 s[80:81], 41, v233
  v_cndmask_b32 v114, v176, v238, s[82:83]
  v_cmp_gt_i32 s[82:83], 42, v233
  v_cndmask_b32 v115, v176, v238, s[84:85]
  v_cmp_gt_i32 s[84:85], 43, v233
  v_cndmask_b32 v116, v176, v238, vcc
  v_cmp_gt_i32 vcc, 48, v233
  v_cndmask_b32 v117, v176, v238, s[80:81]
  v_cmp_gt_i32 s[80:81], 49, v233
  v_cndmask_b32 v118, v176, v238, s[82:83]
  v_cmp_gt_i32 s[82:83], 50, v233
  v_cndmask_b32 v119, v176, v238, s[84:85]
  v_cmp_gt_i32 s[84:85], 51, v233
  v_cndmask_b32 v120, v176, v238, vcc
  v_cmp_gt_i32 vcc, 56, v233
  v_cndmask_b32 v121, v176, v238, s[80:81]
  v_cmp_gt_i32 s[80:81], 57, v233
  v_cndmask_b32 v122, v176, v238, s[82:83]
  v_cmp_gt_i32 s[82:83], 58, v233
  v_cndmask_b32 v123, v176, v238, s[84:85]
  v_cmp_gt_i32 s[84:85], 59, v233
  v_cndmask_b32 v124, v176, v238, vcc
  v_cndmask_b32 v125, v176, v238, s[80:81]
  v_cndmask_b32 v126, v176, v238, s[82:83]
  v_cndmask_b32 v127, v176, v238, s[84:85]
  v_mfma_f32_32x32x16_bf16 v[96:111], v[192:195], v[128:131], v[96:111]
  ds_read_b128 v[192:195], v224 offset:8192
  v_exp_f32 v64, v64
  v_exp_f32 v65, v65
  v_add_f32 v228, v228, v64
  v_mfma_f32_32x32x16_bf16 v[96:111], v[196:199], v[132:135], v[96:111]
  ds_read_b128 v[196:199], v224 offset:9216
  v_exp_f32 v66, v66
  v_exp_f32 v67, v67
  v_cvt_pk_bf16_f32 v160, v64, v65
  v_mfma_f32_32x32x16_bf16 v[96:111], v[200:203], v[136:139], v[96:111]
  ds_read_b128 v[200:203], v224 offset:10240
  v_exp_f32 v68, v68
  v_exp_f32 v69, v69
  v_cvt_pk_bf16_f32 v161, v66, v67
  v_mfma_f32_32x32x16_bf16 v[96:111], v[204:207], v[140:143], v[96:111]
  ds_read_b128 v[204:207], v224 offset:11264
  v_exp_f32 v70, v70
  v_exp_f32 v71, v71
  s_waitcnt lgkmcnt(4)
  v_mfma_f32_32x32x16_bf16 v[96:111], v[208:211], v[144:147], v[96:111]
  ds_read_b128 v[208:211], v224 offset:12288
  v_cvt_pk_bf16_f32 v162, v68, v69
  v_cvt_pk_bf16_f32 v163, v70, v71
  v_exp_f32 v72, v72
  v_add_f32 v229, v229, v65
  v_mfma_f32_32x32x16_bf16 v[96:111], v[212:215], v[148:151], v[96:111]
  ds_read_b128 v[212:215], v224 offset:13312
  v_exp_f32 v73, v73
  v_exp_f32 v74, v74
  v_cvt_pk_bf16_f32 v164, v72, v73
  v_mfma_f32_32x32x16_bf16 v[96:111], v[216:219], v[152:155], v[96:111]
  ds_read_b128 v[216:219], v224 offset:14336
  v_exp_f32 v75, v75
  v_exp_f32 v76, v76
  v_cvt_pk_bf16_f32 v165, v74, v75
  v_mfma_f32_32x32x16_bf16 v[96:111], v[220:223], v[156:159], v[96:111]
  ds_read_b128 v[220:223], v224 offset:15360
  v_exp_f32 v77, v77
  v_exp_f32 v78, v78
  s_waitcnt lgkmcnt(4)
  v_mfma_f32_32x32x16_bf16 v[112:127], v[192:195], v[128:131], v[112:127]
  ds_read_b128 v[192:195], v225 offset:0
  v_add_u32 v224, 0x4000, v224
  v_and_b32 v224, 0xffff, v224
  v_or_b32 v224, 0x10000, v224
  v_exp_f32 v79, v79
  v_mfma_f32_32x32x16_bf16 v[112:127], v[196:199], v[132:135], v[112:127]
  ds_read_b128 v[196:199], v225 offset:2048
  v_cvt_pk_bf16_f32 v166, v76, v77
  v_cvt_pk_bf16_f32 v167, v78, v79
  v_exp_f32 v80, v80
  v_add_f32 v228, v228, v66
  v_mfma_f32_32x32x16_bf16 v[112:127], v[200:203], v[136:139], v[112:127]
  ds_read_b128 v[200:203], v225 offset:4096
  v_exp_f32 v81, v81
  v_exp_f32 v82, v82
  v_cvt_pk_bf16_f32 v168, v80, v81
  v_mfma_f32_32x32x16_bf16 v[112:127], v[204:207], v[140:143], v[112:127]
  ds_read_b128 v[204:207], v225 offset:6144
  v_exp_f32 v83, v83
  v_exp_f32 v84, v84
  s_waitcnt lgkmcnt(4)
  v_mfma_f32_32x32x16_bf16 v[112:127], v[208:211], v[144:147], v[112:127]
  ds_read_b128 v[208:211], v225 offset:1024
  v_exp_f32 v85, v85
  v_exp_f32 v86, v86
  v_cvt_pk_bf16_f32 v169, v82, v83
  v_mfma_f32_32x32x16_bf16 v[112:127], v[212:215], v[148:151], v[112:127]
  ds_read_b128 v[212:215], v225 offset:3072
  v_exp_f32 v87, v87
  v_cvt_pk_bf16_f32 v170, v84, v85
  v_cvt_pk_bf16_f32 v171, v86, v87
  v_max3_f32 v230, v96, v97, v98
  v_mfma_f32_32x32x16_bf16 v[112:127], v[216:219], v[152:155], v[112:127]
  ds_read_b128 v[216:219], v225 offset:5120
  v_exp_f32 v88, v88
  v_exp_f32 v89, v89
  v_max3_f32 v230, v230, v99, v100
  v_mfma_f32_32x32x16_bf16 v[112:127], v[220:223], v[156:159], v[112:127]
  ds_read_b128 v[220:223], v225 offset:7168
  v_exp_f32 v90, v90
  v_exp_f32 v91, v91
  s_waitcnt lgkmcnt(4)
  v_mfma_f32_32x32x16_bf16 v[0:15], v[192:195], v[160:163], v[0:15]
  ds_read_b128 v[192:195], v225 offset:8192
  v_exp_f32 v92, v92
  v_exp_f32 v93, v93
  v_cvt_pk_bf16_f32 v172, v88, v89
  v_mfma_f32_32x32x16_bf16 v[16:31], v[196:199], v[160:163], v[16:31]
  ds_read_b128 v[196:199], v225 offset:10240
  v_exp_f32 v94, v94
  v_exp_f32 v95, v95
  v_cvt_pk_bf16_f32 v173, v90, v91
  v_mfma_f32_32x32x16_bf16 v[32:47], v[200:203], v[160:163], v[32:47]
  ds_read_b128 v[200:203], v225 offset:12288
  v_cvt_pk_bf16_f32 v174, v92, v93
  v_cvt_pk_bf16_f32 v175, v94, v95
  v_max3_f32 v230, v230, v101, v102
  v_add_f32 v229, v229, v67
  v_max3_f32 v230, v230, v103, v104
  v_mfma_f32_32x32x16_bf16 v[48:63], v[204:207], v[160:163], v[48:63]
  ds_read_b128 v[204:207], v225 offset:14336
  v_max3_f32 v230, v230, v105, v106
  v_add_f32 v228, v228, v68
  v_max3_f32 v230, v230, v107, v108
  v_add_f32 v229, v229, v69
  s_waitcnt lgkmcnt(4)
  v_mfma_f32_32x32x16_bf16 v[0:15], v[208:211], v[164:167], v[0:15]
  ds_read_b128 v[208:211], v225 offset:9216
  v_max3_f32 v230, v230, v109, v110
  v_add_f32 v228, v228, v70
  v_max_f32 v230, v230, v111
  v_add_f32 v229, v229, v71
  v_max3_f32 v231, v112, v113, v114
  v_mfma_f32_32x32x16_bf16 v[16:31], v[212:215], v[164:167], v[16:31]
  ds_read_b128 v[212:215], v225 offset:11264
  v_max3_f32 v231, v231, v115, v116
  v_add_f32 v228, v228, v72
  v_max3_f32 v231, v231, v117, v118
  v_add_f32 v229, v229, v73
  v_max3_f32 v231, v231, v119, v120
  v_mfma_f32_32x32x16_bf16 v[32:47], v[216:219], v[164:167], v[32:47]
  ds_read_b128 v[216:219], v225 offset:13312
  v_max3_f32 v231, v231, v121, v122
  v_add_f32 v228, v228, v74
  v_max3_f32 v231, v231, v123, v124
  v_add_f32 v229, v229, v75
  v_max3_f32 v231, v231, v125, v126
  v_mfma_f32_32x32x16_bf16 v[48:63], v[220:223], v[164:167], v[48:63]
  ds_read_b128 v[220:223], v225 offset:15360
  v_max3_f32 v231, v231, v127, v230
  v_add_f32 v228, v228, v76
  v_add_f32 v229, v229, v77
  v_add_f32 v228, v228, v78
  s_waitcnt lgkmcnt(4)
  v_mfma_f32_32x32x16_bf16 v[0:15], v[192:195], v[168:171], v[0:15]
  ds_read_b128 v[192:195], v224 offset:0
  v_add_u32 v225, 0x4000, v225
  v_and_b32 v225, 0xffff, v225
  v_add_f32 v229, v229, v79
  v_add_f32 v228, v228, v80
  v_add_f32 v229, v229, v81
  v_mfma_f32_32x32x16_bf16 v[16:31], v[196:199], v[168:171], v[16:31]
  ds_read_b128 v[196:199], v224 offset:1024
  v_add_f32 v228, v228, v82
  v_add_f32 v229, v229, v83
  v_add_f32 v228, v228, v84
  v_add_f32 v229, v229, v85
  v_add_f32 v228, v228, v86
  v_mfma_f32_32x32x16_bf16 v[32:47], v[200:203], v[168:171], v[32:47]
  ds_read_b128 v[200:203], v224 offset:2048
  v_add_f32 v229, v229, v87
  v_add_f32 v228, v228, v88
  v_add_f32 v229, v229, v89
  v_add_f32 v228, v228, v90
  v_add_f32 v229, v229, v91
  v_mfma_f32_32x32x16_bf16 v[48:63], v[204:207], v[168:171], v[48:63]
  ds_read_b128 v[204:207], v224 offset:3072
  v_add_f32 v228, v228, v92
  v_add_f32 v229, v229, v93
  v_add_f32 v228, v228, v94
  v_add_f32 v229, v229, v95
  s_waitcnt lgkmcnt(4)
  v_mfma_f32_32x32x16_bf16 v[0:15], v[208:211], v[172:175], v[0:15]
  ds_read_b128 v[208:211], v224 offset:4096
  v_mfma_f32_32x32x16_bf16 v[16:31], v[212:215], v[172:175], v[16:31]
  ds_read_b128 v[212:215], v224 offset:5120
  v_mfma_f32_32x32x16_bf16 v[32:47], v[216:219], v[172:175], v[32:47]
  ds_read_b128 v[216:219], v224 offset:6144
  v_mfma_f32_32x32x16_bf16 v[48:63], v[220:223], v[172:175], v[48:63]
  ds_read_b128 v[220:223], v224 offset:7168
  s_barrier
  s_waitcnt lgkmcnt(4)
  v_cmp_lt_f32 vcc, s76, v231
  s_cbranch_vccnz .Lat1_rarem0
.Lat1_backm0:
.Lat1_tail1:
  s_waitcnt lgkmcnt(0)
  ds_read_b128 v[192:195], v225 offset:0
  ds_read_b128 v[196:199], v225 offset:2048
  ds_read_b128 v[200:203], v225 offset:4096
  ds_read_b128 v[204:207], v225 offset:6144
  ds_read_b128 v[208:211], v225 offset:1024
  ds_read_b128 v[212:215], v225 offset:3072
  ds_read_b128 v[216:219], v225 offset:5120
  ds_read_b128 v[220:223], v225 offset:7168
  v_exp_f32 v96, v96
  v_exp_f32 v97, v97
  s_nop 0
  v_cvt_pk_bf16_f32 v160, v96, v97
  v_exp_f32 v98, v98
  v_exp_f32 v99, v99
  s_nop 0
  v_cvt_pk_bf16_f32 v161, v98, v99
  v_exp_f32 v100, v100
  v_exp_f32 v101, v101
  s_nop 0
  v_cvt_pk_bf16_f32 v162, v100, v101
  v_exp_f32 v102, v102
  v_exp_f32 v103, v103
  s_nop 0
  v_cvt_pk_bf16_f32 v163, v102, v103
  s_waitcnt lgkmcnt(7)
  s_nop 0
  v_mfma_f32_32x32x16_bf16 v[0:15], v[192:195], v[160:163], v[0:15]
  ds_read_b128 v[192:195], v225 offset:8192
  v_exp_f32 v104, v104
  v_exp_f32 v105, v105
  v_exp_f32 v106, v106
  v_exp_f32 v107, v107
  s_waitcnt lgkmcnt(7)
  v_mfma_f32_32x32x16_bf16 v[16:31], v[196:199], v[160:163], v[16:31]
  ds_read_b128 v[196:199], v225 offset:10240
  v_exp_f32 v108, v108
  v_exp_f32 v109, v109
  v_exp_f32 v110, v110
  v_exp_f32 v111, v111
  s_waitcnt lgkmcnt(7)
  v_mfma_f32_32x32x16_bf16 v[32:47], v[200:203], v[160:163], v[32:47]
  ds_read_b128 v[200:203], v225 offset:12288
  v_cvt_pk_bf16_f32 v164, v104, v105
  v_cvt_pk_bf16_f32 v165, v106, v107
  v_cvt_pk_bf16_f32 v166, v108, v109
  v_cvt_pk_bf16_f32 v167, v110, v111
  v_exp_f32 v112, v112
  v_exp_f32 v113, v113
  s_waitcnt lgkmcnt(7)
  v_mfma_f32_32x32x16_bf16 v[48:63], v[204:207], v[160:163], v[48:63]
  ds_read_b128 v[204:207], v225 offset:14336
  v_exp_f32 v114, v114
  v_exp_f32 v115, v115
  v_exp_f32 v116, v116
  v_exp_f32 v117, v117
  s_waitcnt lgkmcnt(7)
  v_mfma_f32_32x32x16_bf16 v[0:15], v[208:211], v[164:167], v[0:15]
  ds_read_b128 v[208:211], v225 offset:9216
  v_exp_f32 v118, v118
  v_exp_f32 v119, v119
  v_cvt_pk_bf16_f32 v168, v112, v113
  v_cvt_pk_bf16_f32 v169, v114, v115
  v_cvt_pk_bf16_f32 v170, v116, v117
  v_cvt_pk_bf16_f32 v171, v118, v119
  s_waitcnt lgkmcnt(7)
  v_mfma_f32_32x32x16_bf16 v[16:31], v[212:215], v[164:167], v[16:31]
  ds_read_b128 v[212:215], v225 offset:11264
  v_exp_f32 v120, v120
  v_exp_f32 v121, v121
  v_exp_f32 v122, v122
  v_exp_f32 v123, v123
  s_waitcnt lgkmcnt(7)
  v_mfma_f32_32x32x16_bf16 v[32:47], v[216:219], v[164:167], v[32:47]
  ds_read_b128 v[216:219], v225 offset:13312
  v_exp_f32 v124, v124
  v_exp_f32 v125, v125
  v_exp_f32 v126, v126
  v_exp_f32 v127, v127
  s_waitcnt lgkmcnt(7)
  v_mfma_f32_32x32x16_bf16 v[48:63], v[220:223], v[164:167], v[48:63]
  ds_read_b128 v[220:223], v225 offset:15360
  v_cvt_pk_bf16_f32 v172, v120, v121
  v_cvt_pk_bf16_f32 v173, v122, v123
  v_cvt_pk_bf16_f32 v174, v124, v125
  v_cvt_pk_bf16_f32 v175, v126, v127
  v_add_f32 v228, v228, v96
  v_add_f32 v229, v229, v97
  v_add_f32 v228, v228, v98
  v_add_f32 v229, v229, v99
  s_waitcnt lgkmcnt(7)
  v_mfma_f32_32x32x16_bf16 v[0:15], v[192:195], v[168:171], v[0:15]
  v_add_f32 v228, v228, v100
  v_add_f32 v229, v229, v101
  v_add_f32 v228, v228, v102
  v_add_f32 v229, v229, v103
  v_add_f32 v228, v228, v104
  v_add_f32 v229, v229, v105
  v_add_f32 v228, v228, v106
  v_add_f32 v229, v229, v107
  s_waitcnt lgkmcnt(6)
  v_mfma_f32_32x32x16_bf16 v[16:31], v[196:199], v[168:171], v[16:31]
  v_add_f32 v228, v228, v108
  v_add_f32 v229, v229, v109
  v_add_f32 v228, v228, v110
  v_add_f32 v229, v229, v111
  v_add_f32 v228, v228, v112
  v_add_f32 v229, v229, v113
  v_add_f32 v228, v228, v114
  v_add_f32 v229, v229, v115
  s_waitcnt lgkmcnt(5)
  v_mfma_f32_32x32x16_bf16 v[32:47], v[200:203], v[168:171], v[32:47]
  v_add_f32 v228, v228, v116
  v_add_f32 v229, v229, v117
  v_add_f32 v228, v228, v118
  v_add_f32 v229, v229, v119
  v_add_f32 v228, v228, v120
  v_add_f32 v229, v229, v121
  v_add_f32 v228, v228, v122
  v_add_f32 v229, v229, v123
  s_waitcnt lgkmcnt(4)
  v_mfma_f32_32x32x16_bf16 v[48:63], v[204:207], v[168:171], v[48:63]
  v_add_f32 v228, v228, v124
  v_add_f32 v229, v229, v125
  v_add_f32 v228, v228, v126
  v_add_f32 v229, v229, v127
  s_waitcnt lgkmcnt(3)
  v_mfma_f32_32x32x16_bf16 v[0:15], v[208:211], v[172:175], v[0:15]
  s_waitcnt lgkmcnt(2)
  v_mfma_f32_32x32x16_bf16 v[16:31], v[212:215], v[172:175], v[16:31]
  s_waitcnt lgkmcnt(1)
  v_mfma_f32_32x32x16_bf16 v[32:47], v[216:219], v[172:175], v[32:47]
  s_waitcnt lgkmcnt(0)
  v_mfma_f32_32x32x16_bf16 v[48:63], v[220:223], v[172:175], v[48:63]
  s_barrier
  s_branch .Lat_fin
.Lat1_mask1:
  v_cmp_gt_i32 vcc, 0, v233
  v_cmp_gt_i32 s[80:81], 1, v233
  v_cmp_gt_i32 s[82:83], 2, v233
  v_cmp_gt_i32 s[84:85], 3, v233
  v_cndmask_b32 v64, v176, v238, vcc
  v_cmp_gt_i32 vcc, 8, v233
  v_cndmask_b32 v65, v176, v238, s[80:81]
  v_cmp_gt_i32 s[80:81], 9, v233
  v_cndmask_b32 v66, v176, v238, s[82:83]
  v_cmp_gt_i32 s[82:83], 10, v233
  v_cndmask_b32 v67, v176, v238, s[84:85]
  v_cmp_gt_i32 s[84:85], 11, v233
  v_cndmask_b32 v68, v176, v238, vcc
  v_cmp_gt_i32 vcc, 16, v233
  v_cndmask_b32 v69, v176, v238, s[80:81]
  v_cmp_gt_i32 s[80:81], 17, v233
  v_cndmask_b32 v70, v176, v238, s[82:83]
  v_cmp_gt_i32 s[82:83], 18, v233
  v_cndmask_b32 v71, v176, v238, s[84:85]
  v_cmp_gt_i32 s[84:85], 19, v233
  v_cndmask_b32 v72, v176, v238, vcc
  v_cmp_gt_i32 vcc, 24, v233
  v_cndmask_b32 v73, v176, v238, s[80:81]
  v_cmp_gt_i32 s[80:81], 25, v233
  v_cndmask_b32 v74, v176, v238, s[82:83]
  v_cmp_gt_i32 s[82:83], 26, v233
  v_cndmask_b32 v75, v176, v238, s[84:85]
  v_cmp_gt_i32 s[84:85], 27, v233
  v_cndmask_b32 v76, v176, v238, vcc
  v_cmp_gt_i32 vcc, 32, v233
  v_cndmask_b32 v77, v176, v238, s[80:81]
  v_cmp_gt_i32 s[80:81], 33, v233
  v_cndmask_b32 v78, v176, v238, s[82:83]
  v_cmp_gt_i32 s[82:83], 34, v233
  v_cndmask_b32 v79, v176, v238, s[84:85]
  v_cmp_gt_i32 s[84:85], 35, v233
  v_cndmask_b32 v80, v176, v238, vcc
  v_cmp_gt_i32 vcc, 40, v233
  v_cndmask_b32 v81, v176, v238, s[80:81]
  v_cmp_gt_i32 s[80:81], 41, v233
  v_cndmask_b32 v82, v176, v238, s[82:83]
  v_cmp_gt_i32 s[82:83], 42, v233
  v_cndmask_b32 v83, v176, v238, s[84:85]
  v_cmp_gt_i32 s[84:85], 43, v233
  v_cndmask_b32 v84, v176, v238, vcc
  v_cmp_gt_i32 vcc, 48, v233
  v_cndmask_b32 v85, v176, v238, s[80:81]
  v_cmp_gt_i32 s[80:81], 49, v233
  v_cndmask_b32 v86, v176, v238, s[82:83]
  v_cmp_gt_i32 s[82:83], 50, v233
  v_cndmask_b32 v87, v176, v238, s[84:85]
  v_cmp_gt_i32 s[84:85], 51, v233
  v_cndmask_b32 v88, v176, v238, vcc
  v_cmp_gt_i32 vcc, 56, v233
  v_cndmask_b32 v89, v176, v238, s[80:81]
  v_cmp_gt_i32 s[80:81], 57, v233
  v_cndmask_b32 v90, v176, v238, s[82:83]
  v_cmp_gt_i32 s[82:83], 58, v233
  v_cndmask_b32 v91, v176, v238, s[84:85]
  v_cmp_gt_i32 s[84:85], 59, v233
  v_cndmask_b32 v92, v176, v238, vcc
  v_cndmask_b32 v93, v176, v238, s[80:81]
  v_cndmask_b32 v94, v176, v238, s[82:83]
  v_cndmask_b32 v95, v176, v238, s[84:85]
  v_mfma_f32_32x32x16_bf16 v[64:79], v[192:195], v[128:131], v[64:79]
  ds_read_b128 v[192:195], v224 offset:8192
  v_exp_f32 v96, v96
  v_exp_f32 v97, v97
  v_add_f32 v228, v228, v96
  v_mfma_f32_32x32x16_bf16 v[64:79], v[196:199], v[132:135], v[64:79]
  ds_read_b128 v[196:199], v224 offset:9216
  v_exp_f32 v98, v98
  v_exp_f32 v99, v99
  v_cvt_pk_bf16_f32 v160, v96, v97
  v_mfma_f32_32x32x16_bf16 v[64:79], v[200:203], v[136:139], v[64:79]
  ds_read_b128 v[200:203], v224 offset:10240
  v_exp_f32 v100, v100
  v_exp_f32 v101, v101
  v_cvt_pk_bf16_f32 v161, v98, v99
  v_mfma_f32_32x32x16_bf16 v[64:79], v[204:207], v[140:143], v[64:79]
  ds_read_b128 v[204:207], v224 offset:11264
  v_exp_f32 v102, v102
  v_exp_f32 v103, v103
  s_waitcnt lgkmcnt(4)
  v_mfma_f32_32x32x16_bf16 v[64:79], v[208:211], v[144:147], v[64:79]
  ds_read_b128 v[208:211], v224 offset:12288
  v_cvt_pk_bf16_f32 v162, v100, v101
  v_cvt_pk_bf16_f32 v163, v102, v103
  v_exp_f32 v104, v104
  v_add_f32 v229, v229, v97
  v_mfma_f32_32x32x16_bf16 v[64:79], v[212:215], v[148:151], v[64:79]
  ds_read_b128 v[212:215], v224 offset:13312
  v_exp_f32 v105, v105
  v_exp_f32 v106, v106
  v_cvt_pk_bf16_f32 v164, v104, v105
  v_mfma_f32_32x32x16_bf16 v[64:79], v[216:219], v[152:155], v[64:79]
  ds_read_b128 v[216:219], v224 offset:14336
  v_exp_f32 v107, v107
  v_exp_f32 v108, v108
  v_cvt_pk_bf16_f32 v165, v106, v107
  v_mfma_f32_32x32x16_bf16 v[64:79], v[220:223], v[156:159], v[64:79]
  ds_read_b128 v[220:223], v224 offset:15360
  v_exp_f32 v109, v109
  v_exp_f32 v110, v110
  s_waitcnt lgkmcnt(4)
  v_mfma_f32_32x32x16_bf16 v[80:95], v[192:195], v[128:131], v[80:95]
  ds_read_b128 v[192:195], v225 offset:0
  v_add_u32 v224, 0x4000, v224
  v_and_b32 v224, 0xffff, v224
  v_or_b32 v224, 0x10000, v224
  v_exp_f32 v111, v111
  v_mfma_f32_32x32x16_bf16 v[80:95], v[196:199], v[132:135], v[80:95]
  ds_read_b128 v[196:199], v225 offset:2048
  v_cvt_pk_bf16_f32 v166, v108, v109
  v_cvt_pk_bf16_f32 v167, v110, v111
  v_exp_f32 v112, v112
  v_add_f32 v228, v228, v98
  v_mfma_f32_32x32x16_bf16 v[80:95], v[200:203], v[136:139], v[80:95]
  ds_read_b128 v[200:203], v225 offset:4096
  v_exp_f32 v113, v113
  v_exp_f32 v114, v114
  v_cvt_pk_bf16_f32 v168, v112, v113
  v_mfma_f32_32x32x16_bf16 v[80:95], v[204:207], v[140:143], v[80:95]
  ds_read_b128 v[204:207], v225 offset:6144
  v_exp_f32 v115, v115
  v_exp_f32 v116, v116
  s_waitcnt lgkmcnt(4)
  v_mfma_f32_32x32x16_bf16 v[80:95], v[208:211], v[144:147], v[80:95]
  ds_read_b128 v[208:211], v225 offset:1024
  v_exp_f32 v117, v117
  v_exp_f32 v118, v118
  v_cvt_pk_bf16_f32 v169, v114, v115
  v_mfma_f32_32x32x16_bf16 v[80:95], v[212:215], v[148:151], v[80:95]
  ds_read_b128 v[212:215], v225 offset:3072
  v_exp_f32 v119, v119
  v_cvt_pk_bf16_f32 v170, v116, v117
  v_cvt_pk_bf16_f32 v171, v118, v119
  v_max3_f32 v230, v64, v65, v66
  v_mfma_f32_32x32x16_bf16 v[80:95], v[216:219], v[152:155], v[80:95]
  ds_read_b128 v[216:219], v225 offset:5120
  v_exp_f32 v120, v120
  v_exp_f32 v121, v121
  v_max3_f32 v230, v230, v67, v68
  v_mfma_f32_32x32x16_bf16 v[80:95], v[220:223], v[156:159], v[80:95]
  ds_read_b128 v[220:223], v225 offset:7168
  v_exp_f32 v122, v122
  v_exp_f32 v123, v123
  s_waitcnt lgkmcnt(4)
  v_mfma_f32_32x32x16_bf16 v[0:15], v[192:195], v[160:163], v[0:15]
  ds_read_b128 v[192:195], v225 offset:8192
  v_exp_f32 v124, v124
  v_exp_f32 v125, v125
  v_cvt_pk_bf16_f32 v172, v120, v121
  v_mfma_f32_32x32x16_bf16 v[16:31], v[196:199], v[160:163], v[16:31]
  ds_read_b128 v[196:199], v225 offset:10240
  v_exp_f32 v126, v126
  v_exp_f32 v127, v127
  v_cvt_pk_bf16_f32 v173, v122, v123
  v_mfma_f32_32x32x16_bf16 v[32:47], v[200:203], v[160:163], v[32:47]
  ds_read_b128 v[200:203], v225 offset:12288
  v_cvt_pk_bf16_f32 v174, v124, v125
  v_cvt_pk_bf16_f32 v175, v126, v127
  v_max3_f32 v230, v230, v69, v70
  v_add_f32 v229, v229, v99
  v_max3_f32 v230, v230, v71, v72
  v_mfma_f32_32x32x16_bf16 v[48:63], v[204:207], v[160:163], v[48:63]
  ds_read_b128 v[204:207], v225 offset:14336
  v_max3_f32 v230, v230, v73, v74
  v_add_f32 v228, v228, v100
  v_max3_f32 v230, v230, v75, v76
  v_add_f32 v229, v229, v101
  s_waitcnt lgkmcnt(4)
  v_mfma_f32_32x32x16_bf16 v[0:15], v[208:211], v[164:167], v[0:15]
  ds_read_b128 v[208:211], v225 offset:9216
  v_max3_f32 v230, v230, v77, v78
  v_add_f32 v228, v228, v102
  v_max_f32 v230, v230, v79
  v_add_f32 v229, v229, v103
  v_max3_f32 v231, v80, v81, v82
  v_mfma_f32_32x32x16_bf16 v[16:31], v[212:215], v[164:167], v[16:31]
  ds_read_b128 v[212:215], v225 offset:11264
  v_max3_f32 v231, v231, v83, v84
  v_add_f32 v228, v228, v104
  v_max3_f32 v231, v231, v85, v86
  v_add_f32 v229, v229, v105
  v_max3_f32 v231, v231, v87, v88
  v_mfma_f32_32x32x16_bf16 v[32:47], v[216:219], v[164:167], v[32:47]
  ds_read_b128 v[216:219], v225 offset:13312
  v_max3_f32 v231, v231, v89, v90
  v_add_f32 v228, v228, v106
  v_max3_f32 v231, v231, v91, v92
  v_add_f32 v229, v229, v107
  v_max3_f32 v231, v231, v93, v94
  v_mfma_f32_32x32x16_bf16 v[48:63], v[220:223], v[164:167], v[48:63]
  ds_read_b128 v[220:223], v225 offset:15360
  v_max3_f32 v231, v231, v95, v230
  v_add_f32 v228, v228, v108
  v_add_f32 v229, v229, v109
  v_add_f32 v228, v228, v110
  s_waitcnt lgkmcnt(4)
  v_mfma_f32_32x32x16_bf16 v[0:15], v[192:195], v[168:171], v[0:15]
  ds_read_b128 v[192:195], v224 offset:0
  v_add_u32 v225, 0x4000, v225
  v_and_b32 v225, 0xffff, v225
  v_add_f32 v229, v229, v111
  v_add_f32 v228, v228, v112
  v_add_f32 v229, v229, v113
  v_mfma_f32_32x32x16_bf16 v[16:31], v[196:199], v[168:171], v[16:31]
  ds_read_b128 v[196:199], v224 offset:1024
  v_add_f32 v228, v228, v114
  v_add_f32 v229, v229, v115
  v_add_f32 v228, v228, v116
  v_add_f32 v229, v229, v117
  v_add_f32 v228, v228, v118
  v_mfma_f32_32x32x16_bf16 v[32:47], v[200:203], v[168:171], v[32:47]
  ds_read_b128 v[200:203], v224 offset:2048
  v_add_f32 v229, v229, v119
  v_add_f32 v228, v228, v120
  v_add_f32 v229, v229, v121
  v_add_f32 v228, v228, v122
  v_add_f32 v229, v229, v123
  v_mfma_f32_32x32x16_bf16 v[48:63], v[204:207], v[168:171], v[48:63]
  ds_read_b128 v[204:207], v224 offset:3072
  v_add_f32 v228, v228, v124
  v_add_f32 v229, v229, v125
  v_add_f32 v228, v228, v126
  v_add_f32 v229, v229, v127
  s_waitcnt lgkmcnt(4)
  v_mfma_f32_32x32x16_bf16 v[0:15], v[208:211], v[172:175], v[0:15]
  ds_read_b128 v[208:211], v224 offset:4096
  v_mfma_f32_32x32x16_bf16 v[16:31], v[212:215], v[172:175], v[16:31]
  ds_read_b128 v[212:215], v224 offset:5120
  v_mfma_f32_32x32x16_bf16 v[32:47], v[216:219], v[172:175], v[32:47]
  ds_read_b128 v[216:219], v224 offset:6144
  v_mfma_f32_32x32x16_bf16 v[48:63], v[220:223], v[172:175], v[48:63]
  ds_read_b128 v[220:223], v224 offset:7168
  s_barrier
  s_waitcnt lgkmcnt(4)
  v_cmp_lt_f32 vcc, s76, v231
  s_cbranch_vccnz .Lat1_rarem1
.Lat1_backm1:
.Lat1_tail0:
  s_waitcnt lgkmcnt(0)
  ds_read_b128 v[192:195], v225 offset:0
  ds_read_b128 v[196:199], v225 offset:2048
  ds_read_b128 v[200:203], v225 offset:4096
  ds_read_b128 v[204:207], v225 offset:6144
  ds_read_b128 v[208:211], v225 offset:1024
  ds_read_b128 v[212:215], v225 offset:3072
  ds_read_b128 v[216:219], v225 offset:5120
  ds_read_b128 v[220:223], v225 offset:7168
  v_exp_f32 v64, v64
  v_exp_f32 v65, v65
  s_nop 0
  v_cvt_pk_bf16_f32 v160, v64, v65
  v_exp_f32 v66, v66
  v_exp_f32 v67, v67
  s_nop 0
  v_cvt_pk_bf16_f32 v161, v66, v67
  v_exp_f32 v68, v68
  v_exp_f32 v69, v69
  s_nop 0
  v_cvt_pk_bf16_f32 v162, v68, v69
  v_exp_f32 v70, v70
  v_exp_f32 v71, v71
  s_nop 0
  v_cvt_pk_bf16_f32 v163, v70, v71
  s_waitcnt lgkmcnt(7)
  s_nop 0
  v_mfma_f32_32x32x16_bf16 v[0:15], v[192:195], v[160:163], v[0:15]
  ds_read_b128 v[192:195], v225 offset:8192
  v_exp_f32 v72, v72
  v_exp_f32 v73, v73
  v_exp_f32 v74, v74
  v_exp_f32 v75, v75
  s_waitcnt lgkmcnt(7)
  v_mfma_f32_32x32x16_bf16 v[16:31], v[196:199], v[160:163], v[16:31]
  ds_read_b128 v[196:199], v225 offset:10240
  v_exp_f32 v76, v76
  v_exp_f32 v77, v77
  v_exp_f32 v78, v78
  v_exp_f32 v79, v79
  s_waitcnt lgkmcnt(7)
  v_mfma_f32_32x32x16_bf16 v[32:47], v[200:203], v[160:163], v[32:47]
  ds_read_b128 v[200:203], v225 offset:12288
  v_cvt_pk_bf16_f32 v164, v72, v73
  v_cvt_pk_bf16_f32 v165, v74, v75
  v_cvt_pk_bf16_f32 v166, v76, v77
  v_cvt_pk_bf16_f32 v167, v78, v79
  v_exp_f32 v80, v80
  v_exp_f32 v81, v81
  s_waitcnt lgkmcnt(7)
  v_mfma_f32_32x32x16_bf16 v[48:63], v[204:207], v[160:163], v[48:63]
  ds_read_b128 v[204:207], v225 offset:14336
  v_exp_f32 v82, v82
  v_exp_f32 v83, v83
  v_exp_f32 v84, v84
  v_exp_f32 v85, v85
  s_waitcnt lgkmcnt(7)
  v_mfma_f32_32x32x16_bf16 v[0:15], v[208:211], v[164:167], v[0:15]
  ds_read_b128 v[208:211], v225 offset:9216
  v_exp_f32 v86, v86
  v_exp_f32 v87, v87
  v_cvt_pk_bf16_f32 v168, v80, v81
  v_cvt_pk_bf16_f32 v169, v82, v83
  v_cvt_pk_bf16_f32 v170, v84, v85
  v_cvt_pk_bf16_f32 v171, v86, v87
  s_waitcnt lgkmcnt(7)
  v_mfma_f32_32x32x16_bf16 v[16:31], v[212:215], v[164:167], v[16:31]
  ds_read_b128 v[212:215], v225 offset:11264
  v_exp_f32 v88, v88
  v_exp_f32 v89, v89
  v_exp_f32 v90, v90
  v_exp_f32 v91, v91
  s_waitcnt lgkmcnt(7)
  v_mfma_f32_32x32x16_bf16 v[32:47], v[216:219], v[164:167], v[32:47]
  ds_read_b128 v[216:219], v225 offset:13312
  v_exp_f32 v92, v92
  v_exp_f32 v93, v93
  v_exp_f32 v94, v94
  v_exp_f32 v95, v95
  s_waitcnt lgkmcnt(7)
  v_mfma_f32_32x32x16_bf16 v[48:63], v[220:223], v[164:167], v[48:63]
  ds_read_b128 v[220:223], v225 offset:15360
  v_cvt_pk_bf16_f32 v172, v88, v89
  v_cvt_pk_bf16_f32 v173, v90, v91
  v_cvt_pk_bf16_f32 v174, v92, v93
  v_cvt_pk_bf16_f32 v175, v94, v95
  v_add_f32 v228, v228, v64
  v_add_f32 v229, v229, v65
  v_add_f32 v228, v228, v66
  v_add_f32 v229, v229, v67
  s_waitcnt lgkmcnt(7)
  v_mfma_f32_32x32x16_bf16 v[0:15], v[192:195], v[168:171], v[0:15]
  v_add_f32 v228, v228, v68
  v_add_f32 v229, v229, v69
  v_add_f32 v228, v228, v70
  v_add_f32 v229, v229, v71
  v_add_f32 v228, v228, v72
  v_add_f32 v229, v229, v73
  v_add_f32 v228, v228, v74
  v_add_f32 v229, v229, v75
  s_waitcnt lgkmcnt(6)
  v_mfma_f32_32x32x16_bf16 v[16:31], v[196:199], v[168:171], v[16:31]
  v_add_f32 v228, v228, v76
  v_add_f32 v229, v229, v77
  v_add_f32 v228, v228, v78
  v_add_f32 v229, v229, v79
  v_add_f32 v228, v228, v80
  v_add_f32 v229, v229, v81
  v_add_f32 v228, v228, v82
  v_add_f32 v229, v229, v83
  s_waitcnt lgkmcnt(5)
  v_mfma_f32_32x32x16_bf16 v[32:47], v[200:203], v[168:171], v[32:47]
  v_add_f32 v228, v228, v84
  v_add_f32 v229, v229, v85
  v_add_f32 v228, v228, v86
  v_add_f32 v229, v229, v87
  v_add_f32 v228, v228, v88
  v_add_f32 v229, v229, v89
  v_add_f32 v228, v228, v90
  v_add_f32 v229, v229, v91
  s_waitcnt lgkmcnt(4)
  v_mfma_f32_32x32x16_bf16 v[48:63], v[204:207], v[168:171], v[48:63]
  v_add_f32 v228, v228, v92
  v_add_f32 v229, v229, v93
  v_add_f32 v228, v228, v94
  v_add_f32 v229, v229, v95
  s_waitcnt lgkmcnt(3)
  v_mfma_f32_32x32x16_bf16 v[0:15], v[208:211], v[172:175], v[0:15]
  s_waitcnt lgkmcnt(2)
  v_mfma_f32_32x32x16_bf16 v[16:31], v[212:215], v[172:175], v[16:31]
  s_waitcnt lgkmcnt(1)
  v_mfma_f32_32x32x16_bf16 v[32:47], v[216:219], v[172:175], v[32:47]
  s_waitcnt lgkmcnt(0)
  v_mfma_f32_32x32x16_bf16 v[48:63], v[220:223], v[172:175], v[48:63]
  s_barrier
  s_branch .Lat_fin
.Lat1_rarea:
  s_nop 11
  v_mov_b32 v235, v231
  s_nop 1
  v_permlane32_swap_b32 v231, v235
  v_max3_f32 v235, v231, v235, 0
  v_exp_f32 v236, -v235
  v_sub_f32 v96, v96, v235
  v_sub_f32 v97, v97, v235
  v_sub_f32 v98, v98, v235
  v_sub_f32 v99, v99, v235
  v_sub_f32 v100, v100, v235
  v_sub_f32 v101, v101, v235
  v_sub_f32 v102, v102, v235
  v_sub_f32 v103, v103, v235
  v_sub_f32 v104, v104, v235
  v_sub_f32 v105, v105, v235
  v_sub_f32 v106, v106, v235
  v_sub_f32 v107, v107, v235
  v_sub_f32 v108, v108, v235
  v_sub_f32 v109, v109, v235
  v_sub_f32 v110, v110, v235
  v_sub_f32 v111, v111, v235
  v_sub_f32 v112, v112, v235
  v_sub_f32 v113, v113, v235
  v_sub_f32 v114, v114, v235
  v_sub_f32 v115, v115, v235
  v_sub_f32 v116, v116, v235
  v_sub_f32 v117, v117, v235
  v_sub_f32 v118, v118, v235
  v_sub_f32 v119, v119, v235
  v_sub_f32 v120, v120, v235
  v_sub_f32 v121, v121, v235
  v_sub_f32 v122, v122, v235
  v_sub_f32 v123, v123, v235
  v_sub_f32 v124, v124, v235
  v_sub_f32 v125, v125, v235
  v_sub_f32 v126, v126, v235
  v_sub_f32 v127, v127, v235
  v_mul_f32 v0, v0, v236
  v_mul_f32 v1, v1, v236
  v_mul_f32 v2, v2, v236
  v_mul_f32 v3, v3, v236
  v_mul_f32 v4, v4, v236
  v_mul_f32 v5, v5, v236
  v_mul_f32 v6, v6, v236
  v_mul_f32 v7, v7, v236
  v_mul_f32 v8, v8, v236
  v_mul_f32 v9, v9, v236
  v_mul_f32 v10, v10, v236
  v_mul_f32 v11, v11, v236
  v_mul_f32 v12, v12, v236
  v_mul_f32 v13, v13, v236
  v_mul_f32 v14, v14, v236
  v_mul_f32 v15, v15, v236
  v_mul_f32 v16, v16, v236
  v_mul_f32 v17, v17, v236
  v_mul_f32 v18, v18, v236
  v_mul_f32 v19, v19, v236
  v_mul_f32 v20, v20, v236
  v_mul_f32 v21, v21, v236
  v_mul_f32 v22, v22, v236
  v_mul_f32 v23, v23, v236
  v_mul_f32 v24, v24, v236
  v_mul_f32 v25, v25, v236
  v_mul_f32 v26, v26, v236
  v_mul_f32 v27, v27, v236
  v_mul_f32 v28, v28, v236
  v_mul_f32 v29, v29, v236
  v_mul_f32 v30, v30, v236
  v_mul_f32 v31, v31, v236
  v_mul_f32 v32, v32, v236
  v_mul_f32 v33, v33, v236
  v_mul_f32 v34, v34, v236
  v_mul_f32 v35, v35, v236
  v_mul_f32 v36, v36, v236
  v_mul_f32 v37, v37, v236
  v_mul_f32 v38, v38, v236
  v_mul_f32 v39, v39, v236
  v_mul_f32 v40, v40, v236
  v_mul_f32 v41, v41, v236
  v_mul_f32 v42, v42, v236
  v_mul_f32 v43, v43, v236
  v_mul_f32 v44, v44, v236
  v_mul_f32 v45, v45, v236
  v_mul_f32 v46, v46, v236
  v_mul_f32 v47, v47, v236
  v_mul_f32 v48, v48, v236
  v_mul_f32 v49, v49, v236
  v_mul_f32 v50, v50, v236
  v_mul_f32 v51, v51, v236
  v_mul_f32 v52, v52, v236
  v_mul_f32 v53, v53, v236
  v_mul_f32 v54, v54, v236
  v_mul_f32 v55, v55, v236
  v_mul_f32 v56, v56, v236
  v_mul_f32 v57, v57, v236
  v_mul_f32 v58, v58, v236
  v_mul_f32 v59, v59, v236
  v_mul_f32 v60, v60, v236
  v_mul_f32 v61, v61, v236
  v_mul_f32 v62, v62, v236
  v_mul_f32 v63, v63, v236
  v_mul_f32 v228, v228, v236
  v_mul_f32 v229, v229, v236
  v_sub_f32 v176, v176, v235
  v_sub_f32 v177, v177, v235
  v_sub_f32 v178, v178, v235
  v_sub_f32 v179, v179, v235
  v_sub_f32 v180, v180, v235
  v_sub_f32 v181, v181, v235
  v_sub_f32 v182, v182, v235
  v_sub_f32 v183, v183, v235
  v_sub_f32 v184, v184, v235
  v_sub_f32 v185, v185, v235
  v_sub_f32 v186, v186, v235
  v_sub_f32 v187, v187, v235
  v_sub_f32 v188, v188, v235
  v_sub_f32 v189, v189, v235
  v_sub_f32 v190, v190, v235
  v_sub_f32 v191, v191, v235
  s_nop 1
  s_branch .Lat1_backa
.Lat1_rareb:
  s_nop 11
  v_mov_b32 v235, v231
  s_nop 1
  v_permlane32_swap_b32 v231, v235
  v_max3_f32 v235, v231, v235, 0
  v_exp_f32 v236, -v235
  v_sub_f32 v64, v64, v235
  v_sub_f32 v65, v65, v235
  v_sub_f32 v66, v66, v235
  v_sub_f32 v67, v67, v235
  v_sub_f32 v68, v68, v235
  v_sub_f32 v69, v69, v235
  v_sub_f32 v70, v70, v235
  v_sub_f32 v71, v71, v235
  v_sub_f32 v72, v72, v235
  v_sub_f32 v73, v73, v235
  v_sub_f32 v74, v74, v235
  v_sub_f32 v75, v75, v235
  v_sub_f32 v76, v76, v235
  v_sub_f32 v77, v77, v235
  v_sub_f32 v78, v78, v235
  v_sub_f32 v79, v79, v235
  v_sub_f32 v80, v80, v235
  v_sub_f32 v81, v81, v235
  v_sub_f32 v82, v82, v235
  v_sub_f32 v83, v83, v235
  v_sub_f32 v84, v84, v235
  v_sub_f32 v85, v85, v235
  v_sub_f32 v86, v86, v235
  v_sub_f32 v87, v87, v235
  v_sub_f32 v88, v88, v235
  v_sub_f32 v89, v89, v235
  v_sub_f32 v90, v90, v235
  v_sub_f32 v91, v91, v235
  v_sub_f32 v92, v92, v235
  v_sub_f32 v93, v93, v235
  v_sub_f32 v94, v94, v235
  v_sub_f32 v95, v95, v235
  v_mul_f32 v0, v0, v236
  v_mul_f32 v1, v1, v236
  v_mul_f32 v2, v2, v236
  v_mul_f32 v3, v3, v236
  v_mul_f32 v4, v4, v236
  v_mul_f32 v5, v5, v236
  v_mul_f32 v6, v6, v236
  v_mul_f32 v7, v7, v236
  v_mul_f32 v8, v8, v236
  v_mul_f32 v9, v9, v236
  v_mul_f32 v10, v10, v236
  v_mul_f32 v11, v11, v236
  v_mul_f32 v12, v12, v236
  v_mul_f32 v13, v13, v236
  v_mul_f32 v14, v14, v236
  v_mul_f32 v15, v15, v236
  v_mul_f32 v16, v16, v236
  v_mul_f32 v17, v17, v236
  v_mul_f32 v18, v18, v236
  v_mul_f32 v19, v19, v236
  v_mul_f32 v20, v20, v236
  v_mul_f32 v21, v21, v236
  v_mul_f32 v22, v22, v236
  v_mul_f32 v23, v23, v236
  v_mul_f32 v24, v24, v236
  v_mul_f32 v25, v25, v236
  v_mul_f32 v26, v26, v236
  v_mul_f32 v27, v27, v236
  v_mul_f32 v28, v28, v236
  v_mul_f32 v29, v29, v236
  v_mul_f32 v30, v30, v236
  v_mul_f32 v31, v31, v236
  v_mul_f32 v32, v32, v236
  v_mul_f32 v33, v33, v236
  v_mul_f32 v34, v34, v236
  v_mul_f32 v35, v35, v236
  v_mul_f32 v36, v36, v236
  v_mul_f32 v37, v37, v236
  v_mul_f32 v38, v38, v236
  v_mul_f32 v39, v39, v236
  v_mul_f32 v40, v40, v236
  v_mul_f32 v41, v41, v236
  v_mul_f32 v42, v42, v236
  v_mul_f32 v43, v43, v236
  v_mul_f32 v44, v44, v236
  v_mul_f32 v45, v45, v236
  v_mul_f32 v46, v46, v236
  v_mul_f32 v47, v47, v236
  v_mul_f32 v48, v48, v236
  v_mul_f32 v49, v49, v236
  v_mul_f32 v50, v50, v236
  v_mul_f32 v51, v51, v236
  v_mul_f32 v52, v52, v236
  v_mul_f32 v53, v53, v236
  v_mul_f32 v54, v54, v236
  v_mul_f32 v55, v55, v236
  v_mul_f32 v56, v56, v236
  v_mul_f32 v57, v57, v236
  v_mul_f32 v58, v58, v236
  v_mul_f32 v59, v59, v236
  v_mul_f32 v60, v60, v236
  v_mul_f32 v61, v61, v236
  v_mul_f32 v62, v62, v236
  v_mul_f32 v63, v63, v236
  v_mul_f32 v228, v228, v236
  v_mul_f32 v229, v229, v236
  v_sub_f32 v176, v176, v235
  v_sub_f32 v177, v177, v235
  v_sub_f32 v178, v178, v235
  v_sub_f32 v179, v179, v235
  v_sub_f32 v180, v180, v235
  v_sub_f32 v181, v181, v235
  v_sub_f32 v182, v182, v235
  v_sub_f32 v183, v183, v235
  v_sub_f32 v184, v184, v235
  v_sub_f32 v185, v185, v235
  v_sub_f32 v186, v186, v235
  v_sub_f32 v187, v187, v235
  v_sub_f32 v188, v188, v235
  v_sub_f32 v189, v189, v235
  v_sub_f32 v190, v190, v235
  v_sub_f32 v191, v191, v235
  s_nop 1
  s_branch .Lat1_backb
.Lat1_rarem0:
  s_nop 11
  v_mov_b32 v235, v231
  s_nop 1
  v_permlane32_swap_b32 v231, v235
  v_max3_f32 v235, v231, v235, 0
  v_exp_f32 v236, -v235
  v_sub_f32 v96, v96, v235
  v_sub_f32 v97, v97, v235
  v_sub_f32 v98, v98, v235
  v_sub_f32 v99, v99, v235
  v_sub_f32 v100, v100, v235
  v_sub_f32 v101, v101, v235
  v_sub_f32 v102, v102, v235
  v_sub_f32 v103, v103, v235
  v_sub_f32 v104, v104, v235
  v_sub_f32 v105, v105, v235
  v_sub_f32 v106, v106, v235
  v_sub_f32 v107, v107, v235
  v_sub_f32 v108, v108, v235
  v_sub_f32 v109, v109, v235
  v_sub_f32 v110, v110, v235
  v_sub_f32 v111, v111, v235
  v_sub_f32 v112, v112, v235
  v_sub_f32 v113, v113, v235
  v_sub_f32 v114, v114, v235
  v_sub_f32 v115, v115, v235
  v_sub_f32 v116, v116, v235
  v_sub_f32 v117, v117, v235
  v_sub_f32 v118, v118, v235
  v_sub_f32 v119, v119, v235
  v_sub_f32 v120, v120, v235
  v_sub_f32 v121, v121, v235
  v_sub_f32 v122, v122, v235
  v_sub_f32 v123, v123, v235
  v_sub_f32 v124, v124, v235
  v_sub_f32 v125, v125, v235
  v_sub_f32 v126, v126, v235
  v_sub_f32 v127, v127, v235
  v_mul_f32 v0, v0, v236
  v_mul_f32 v1, v1, v236
  v_mul_f32 v2, v2, v236
  v_mul_f32 v3, v3, v236
  v_mul_f32 v4, v4, v236
  v_mul_f32 v5, v5, v236
  v_mul_f32 v6, v6, v236
  v_mul_f32 v7, v7, v236
  v_mul_f32 v8, v8, v236
  v_mul_f32 v9, v9, v236
  v_mul_f32 v10, v10, v236
  v_mul_f32 v11, v11, v236
  v_mul_f32 v12, v12, v236
  v_mul_f32 v13, v13, v236
  v_mul_f32 v14, v14, v236
  v_mul_f32 v15, v15, v236
  v_mul_f32 v16, v16, v236
  v_mul_f32 v17, v17, v236
  v_mul_f32 v18, v18, v236
  v_mul_f32 v19, v19, v236
  v_mul_f32 v20, v20, v236
  v_mul_f32 v21, v21, v236
  v_mul_f32 v22, v22, v236
  v_mul_f32 v23, v23, v236
  v_mul_f32 v24, v24, v236
  v_mul_f32 v25, v25, v236
  v_mul_f32 v26, v26, v236
  v_mul_f32 v27, v27, v236
  v_mul_f32 v28, v28, v236
  v_mul_f32 v29, v29, v236
  v_mul_f32 v30, v30, v236
  v_mul_f32 v31, v31, v236
  v_mul_f32 v32, v32, v236
  v_mul_f32 v33, v33, v236
  v_mul_f32 v34, v34, v236
  v_mul_f32 v35, v35, v236
  v_mul_f32 v36, v36, v236
  v_mul_f32 v37, v37, v236
  v_mul_f32 v38, v38, v236
  v_mul_f32 v39, v39, v236
  v_mul_f32 v40, v40, v236
  v_mul_f32 v41, v41, v236
  v_mul_f32 v42, v42, v236
  v_mul_f32 v43, v43, v236
  v_mul_f32 v44, v44, v236
  v_mul_f32 v45, v45, v236
  v_mul_f32 v46, v46, v236
  v_mul_f32 v47, v47, v236
  v_mul_f32 v48, v48, v236
  v_mul_f32 v49, v49, v236
  v_mul_f32 v50, v50, v236
  v_mul_f32 v51, v51, v236
  v_mul_f32 v52, v52, v236
  v_mul_f32 v53, v53, v236
  v_mul_f32 v54, v54, v236
  v_mul_f32 v55, v55, v236
  v_mul_f32 v56, v56, v236
  v_mul_f32 v57, v57, v236
  v_mul_f32 v58, v58, v236
  v_mul_f32 v59, v59, v236
  v_mul_f32 v60, v60, v236
  v_mul_f32 v61, v61, v236
  v_mul_f32 v62, v62, v236
  v_mul_f32 v63, v63, v236
  v_mul_f32 v228, v228, v236
  v_mul_f32 v229, v229, v236
  v_sub_f32 v176, v176, v235
  v_sub_f32 v177, v177, v235
  v_sub_f32 v178, v178, v235
  v_sub_f32 v179, v179, v235
  v_sub_f32 v180, v180, v235
  v_sub_f32 v181, v181, v235
  v_sub_f32 v182, v182, v235
  v_sub_f32 v183, v183, v235
  v_sub_f32 v184, v184, v235
  v_sub_f32 v185, v185, v235
  v_sub_f32 v186, v186, v235
  v_sub_f32 v187, v187, v235
  v_sub_f32 v188, v188, v235
  v_sub_f32 v189, v189, v235
  v_sub_f32 v190, v190, v235
  v_sub_f32 v191, v191, v235
  s_nop 1
  s_branch .Lat1_backm0
.Lat1_rarem1:
  s_nop 11
  v_mov_b32 v235, v231
  s_nop 1
  v_permlane32_swap_b32 v231, v235
  v_max3_f32 v235, v231, v235, 0
  v_exp_f32 v236, -v235
  v_sub_f32 v64, v64, v235
  v_sub_f32 v65, v65, v235
  v_sub_f32 v66, v66, v235
  v_sub_f32 v67, v67, v235
  v_sub_f32 v68, v68, v235
  v_sub_f32 v69, v69, v235
  v_sub_f32 v70, v70, v235
  v_sub_f32 v71, v71, v235
  v_sub_f32 v72, v72, v235
  v_sub_f32 v73, v73, v235
  v_sub_f32 v74, v74, v235
  v_sub_f32 v75, v75, v235
  v_sub_f32 v76, v76, v235
  v_sub_f32 v77, v77, v235
  v_sub_f32 v78, v78, v235
  v_sub_f32 v79, v79, v235
  v_sub_f32 v80, v80, v235
  v_sub_f32 v81, v81, v235
  v_sub_f32 v82, v82, v235
  v_sub_f32 v83, v83, v235
  v_sub_f32 v84, v84, v235
  v_sub_f32 v85, v85, v235
  v_sub_f32 v86, v86, v235
  v_sub_f32 v87, v87, v235
  v_sub_f32 v88, v88, v235
  v_sub_f32 v89, v89, v235
  v_sub_f32 v90, v90, v235
  v_sub_f32 v91, v91, v235
  v_sub_f32 v92, v92, v235
  v_sub_f32 v93, v93, v235
  v_sub_f32 v94, v94, v235
  v_sub_f32 v95, v95, v235
  v_mul_f32 v0, v0, v236
  v_mul_f32 v1, v1, v236
  v_mul_f32 v2, v2, v236
  v_mul_f32 v3, v3, v236
  v_mul_f32 v4, v4, v236
  v_mul_f32 v5, v5, v236
  v_mul_f32 v6, v6, v236
  v_mul_f32 v7, v7, v236
  v_mul_f32 v8, v8, v236
  v_mul_f32 v9, v9, v236
  v_mul_f32 v10, v10, v236
  v_mul_f32 v11, v11, v236
  v_mul_f32 v12, v12, v236
  v_mul_f32 v13, v13, v236
  v_mul_f32 v14, v14, v236
  v_mul_f32 v15, v15, v236
  v_mul_f32 v16, v16, v236
  v_mul_f32 v17, v17, v236
  v_mul_f32 v18, v18, v236
  v_mul_f32 v19, v19, v236
  v_mul_f32 v20, v20, v236
  v_mul_f32 v21, v21, v236
  v_mul_f32 v22, v22, v236
  v_mul_f32 v23, v23, v236
  v_mul_f32 v24, v24, v236
  v_mul_f32 v25, v25, v236
  v_mul_f32 v26, v26, v236
  v_mul_f32 v27, v27, v236
  v_mul_f32 v28, v28, v236
  v_mul_f32 v29, v29, v236
  v_mul_f32 v30, v30, v236
  v_mul_f32 v31, v31, v236
  v_mul_f32 v32, v32, v236
  v_mul_f32 v33, v33, v236
  v_mul_f32 v34, v34, v236
  v_mul_f32 v35, v35, v236
  v_mul_f32 v36, v36, v236
  v_mul_f32 v37, v37, v236
  v_mul_f32 v38, v38, v236
  v_mul_f32 v39, v39, v236
  v_mul_f32 v40, v40, v236
  v_mul_f32 v41, v41, v236
  v_mul_f32 v42, v42, v236
  v_mul_f32 v43, v43, v236
  v_mul_f32 v44, v44, v236
  v_mul_f32 v45, v45, v236
  v_mul_f32 v46, v46, v236
  v_mul_f32 v47, v47, v236
  v_mul_f32 v48, v48, v236
  v_mul_f32 v49, v49, v236
  v_mul_f32 v50, v50, v236
  v_mul_f32 v51, v51, v236
  v_mul_f32 v52, v52, v236
  v_mul_f32 v53, v53, v236
  v_mul_f32 v54, v54, v236
  v_mul_f32 v55, v55, v236
  v_mul_f32 v56, v56, v236
  v_mul_f32 v57, v57, v236
  v_mul_f32 v58, v58, v236
  v_mul_f32 v59, v59, v236
  v_mul_f32 v60, v60, v236
  v_mul_f32 v61, v61, v236
  v_mul_f32 v62, v62, v236
  v_mul_f32 v63, v63, v236
  v_mul_f32 v228, v228, v236
  v_mul_f32 v229, v229, v236
  v_sub_f32 v176, v176, v235
  v_sub_f32 v177, v177, v235
  v_sub_f32 v178, v178, v235
  v_sub_f32 v179, v179, v235
  v_sub_f32 v180, v180, v235
  v_sub_f32 v181, v181, v235
  v_sub_f32 v182, v182, v235
  v_sub_f32 v183, v183, v235
  v_sub_f32 v184, v184, v235
  v_sub_f32 v185, v185, v235
  v_sub_f32 v186, v186, v235
  v_sub_f32 v187, v187, v235
  v_sub_f32 v188, v188, v235
  v_sub_f32 v189, v189, v235
  v_sub_f32 v190, v190, v235
  v_sub_f32 v191, v191, v235
  s_nop 1
  s_branch .Lat1_backm1
.Lat_fin:
  v_add_f32 v228, v228, v229
  v_mov_b32 v235, v228
  s_nop 1
  v_permlane32_swap_b32 v228, v235
  v_add_f32 v228, v228, v235
  v_rcp_f32 v228, v228
  s_nop 3
  v_mul_f32 v0, v0, v228
  v_mul_f32 v1, v1, v228
  v_mul_f32 v2, v2, v228
  v_mul_f32 v3, v3, v228
  v_mul_f32 v4, v4, v228
  v_mul_f32 v5, v5, v228
  v_mul_f32 v6, v6, v228
  v_mul_f32 v7, v7, v228
  v_cvt_pk_bf16_f32 v64, v0, v1
  v_cvt_pk_bf16_f32 v65, v2, v3
  v_cvt_pk_bf16_f32 v66, v4, v5
  v_cvt_pk_bf16_f32 v67, v6, v7
  buffer_store_dwordx4 v[64:67], v254, s[40:43], s72 offen offset:0 sc1
  v_mul_f32 v8, v8, v228
  v_mul_f32 v9, v9, v228
  v_mul_f32 v10, v10, v228
  v_mul_f32 v11, v11, v228
  v_mul_f32 v12, v12, v228
  v_mul_f32 v13, v13, v228
  v_mul_f32 v14, v14, v228
  v_mul_f32 v15, v15, v228
  v_cvt_pk_bf16_f32 v68, v8, v9
  v_cvt_pk_bf16_f32 v69, v10, v11
  v_cvt_pk_bf16_f32 v70, v12, v13
  v_cvt_pk_bf16_f32 v71, v14, v15
  buffer_store_dwordx4 v[68:71], v254, s[40:43], s72 offen offset:1024 sc1
  v_mul_f32 v16, v16, v228
  v_mul_f32 v17, v17, v228
  v_mul_f32 v18, v18, v228
  v_mul_f32 v19, v19, v228
  v_mul_f32 v20, v20, v228
  v_mul_f32 v21, v21, v228
  v_mul_f32 v22, v22, v228
  v_mul_f32 v23, v23, v228
  v_cvt_pk_bf16_f32 v72, v16, v17
  v_cvt_pk_bf16_f32 v73, v18, v19
  v_cvt_pk_bf16_f32 v74, v20, v21
  v_cvt_pk_bf16_f32 v75, v22, v23
  buffer_store_dwordx4 v[72:75], v254, s[40:43], s72 offen offset:2048 sc1
  v_mul_f32 v24, v24, v228
  v_mul_f32 v25, v25, v228
  v_mul_f32 v26, v26, v228
  v_mul_f32 v27, v27, v228
  v_mul_f32 v28, v28, v228
  v_mul_f32 v29, v29, v228
  v_mul_f32 v30, v30, v228
  v_mul_f32 v31, v31, v228
  v_cvt_pk_bf16_f32 v76, v24, v25
  v_cvt_pk_bf16_f32 v77, v26, v27
  v_cvt_pk_bf16_f32 v78, v28, v29
  v_cvt_pk_bf16_f32 v79, v30, v31
  buffer_store_dwordx4 v[76:79], v254, s[40:43], s72 offen offset:3072 sc1
  v_mul_f32 v32, v32, v228
  v_mul_f32 v33, v33, v228
  v_mul_f32 v34, v34, v228
  v_mul_f32 v35, v35, v228
  v_mul_f32 v36, v36, v228
  v_mul_f32 v37, v37, v228
  v_mul_f32 v38, v38, v228
  v_mul_f32 v39, v39, v228
  v_cvt_pk_bf16_f32 v80, v32, v33
  v_cvt_pk_bf16_f32 v81, v34, v35
  v_cvt_pk_bf16_f32 v82, v36, v37
  v_cvt_pk_bf16_f32 v83, v38, v39
  buffer_store_dwordx4 v[80:83], v254, s[40:43], s73 offen offset:0 sc1
  v_mul_f32 v40, v40, v228
  v_mul_f32 v41, v41, v228
  v_mul_f32 v42, v42, v228
  v_mul_f32 v43, v43, v228
  v_mul_f32 v44, v44, v228
  v_mul_f32 v45, v45, v228
  v_mul_f32 v46, v46, v228
  v_mul_f32 v47, v47, v228
  v_cvt_pk_bf16_f32 v84, v40, v41
  v_cvt_pk_bf16_f32 v85, v42, v43
  v_cvt_pk_bf16_f32 v86, v44, v45
  v_cvt_pk_bf16_f32 v87, v46, v47
  buffer_store_dwordx4 v[84:87], v254, s[40:43], s73 offen offset:1024 sc1
  v_mul_f32 v48, v48, v228
  v_mul_f32 v49, v49, v228
  v_mul_f32 v50, v50, v228
  v_mul_f32 v51, v51, v228
  v_mul_f32 v52, v52, v228
  v_mul_f32 v53, v53, v228
  v_mul_f32 v54, v54, v228
  v_mul_f32 v55, v55, v228
  v_cvt_pk_bf16_f32 v88, v48, v49
  v_cvt_pk_bf16_f32 v89, v50, v51
  v_cvt_pk_bf16_f32 v90, v52, v53
  v_cvt_pk_bf16_f32 v91, v54, v55
  buffer_store_dwordx4 v[88:91], v254, s[40:43], s73 offen offset:2048 sc1
  v_mul_f32 v56, v56, v228
  v_mul_f32 v57, v57, v228
  v_mul_f32 v58, v58, v228
  v_mul_f32 v59, v59, v228
  v_mul_f32 v60, v60, v228
  v_mul_f32 v61, v61, v228
  v_mul_f32 v62, v62, v228
  v_mul_f32 v63, v63, v228
  v_cvt_pk_bf16_f32 v92, v56, v57
  v_cvt_pk_bf16_f32 v93, v58, v59
  v_cvt_pk_bf16_f32 v94, v60, v61
  v_cvt_pk_bf16_f32 v95, v62, v63
  buffer_store_dwordx4 v[92:95], v254, s[40:43], s73 offen offset:3072 sc1
  s_cmp_lg_u32 s57, 0
  s_cbranch_scc1 .Lat_g1
  s_cmp_lg_u32 s3, 0
  s_cbranch_scc1 .Lok_h
  v_readfirstlane_b32 s86, v250
  s_nop 0
  s_cmp_lt_u32 s86, 14
  s_cbranch_scc1 .Lspin_h
.Lok_h:
  s_sub_u32 s65, s65, 2
  s_bitcmp1_b32 s2, 0
  s_cselect_b32 s82, 10, 4
  s_bfe_u32 s59, s30, 0x10003
  s_mul_i32 s82, s82, s59
  s_lshr_b32 s59, s30, 4
  s_mul_i32 s59, s59, 14
  s_add_u32 s82, s82, s59
  s_and_b32 s58, s30, 3
  v_lshrrev_b32 v90, 4, v255
  v_and_b32 v91, 15, v255
  v_lshlrev_b32 v92, 1, v90
  v_xor_b32 v91, v91, v92
  v_lshlrev_b32 v90, 10, v90
  v_lshl_add_u32 v90, v91, 4, v90
  s_lshl_b32 s59, s3, 13
  s_lshl_b32 s60, s58, 8
  s_add_u32 s59, s59, s60
  v_add_u32 v96, s59, v90
  v_xor_b32 v90, 128, v96
  v_add_u32 v97, 3072, v90
  s_cmp_lg_u32 s65, 0
  s_cbranch_scc1 .Ldrain_1
  s_waitcnt vmcnt(0)
.Ldrain_1:
  s_cmp_eq_u32 s65, 0
  s_cbranch_scc1 .Lat_sk0
  s_add_u32 m0, s70, s77
  s_add_u32 s70, s70, 0x4000
  buffer_load_dwordx4 v226, s[36:39], s68 offen offset:0 sc1 lds
  buffer_load_dwordx4 v226, s[36:39], s68 offen offset:1024 sc1 lds
  buffer_load_dwordx4 v226, s[36:39], s68 offen offset:2048 sc1 lds
  buffer_load_dwordx4 v226, s[36:39], s68 offen offset:3072 sc1 lds
  s_and_b32 s70, s70, 0xffff
  s_add_u32 s68, s68, 0x4000
  s_add_u32 m0, s69, s78
  s_add_u32 s69, s69, 0x4000
  buffer_load_dwordx4 v226, s[32:35], s67 offen offset:0 sc1 lds
  buffer_load_dwordx4 v226, s[32:35], s67 offen offset:1024 sc1 lds
  buffer_load_dwordx4 v226, s[32:35], s67 offen offset:2048 sc1 lds
  buffer_load_dwordx4 v226, s[32:35], s67 offen offset:3072 sc1 lds
  s_and_b32 s69, s69, 0xffff
  s_add_u32 s67, s67, 0x4000
  s_sub_u32 s65, s65, 1
  s_cmp_lg_u32 s65, 0
  s_cbranch_scc1 .Ldrain_2
  s_waitcnt vmcnt(0)
.Ldrain_2:
  s_waitcnt vmcnt(16)
  s_barrier
.Lat_sk0:
  s_cmp_eq_u32 s65, 0
  s_cbranch_scc1 .Lat_warm
.Lat_ld:
  s_add_u32 m0, s70, s77
  s_add_u32 s70, s70, 0x4000
  buffer_load_dwordx4 v226, s[36:39], s68 offen offset:0 sc1 lds
  buffer_load_dwordx4 v226, s[36:39], s68 offen offset:1024 sc1 lds
  buffer_load_dwordx4 v226, s[36:39], s68 offen offset:2048 sc1 lds
  buffer_load_dwordx4 v226, s[36:39], s68 offen offset:3072 sc1 lds
  s_and_b32 s70, s70, 0xffff
  s_add_u32 s68, s68, 0x4000
  s_add_u32 m0, s69, s78
  s_add_u32 s69, s69, 0x4000
  buffer_load_dwordx4 v226, s[32:35], s67 offen offset:0 sc1 lds
  buffer_load_dwordx4 v226, s[32:35], s67 offen offset:1024 sc1 lds
  buffer_load_dwordx4 v226, s[32:35], s67 offen offset:2048 sc1 lds
  buffer_load_dwordx4 v226, s[32:35], s67 offen offset:3072 sc1 lds
  s_and_b32 s69, s69, 0xffff
  s_add_u32 s67, s67, 0x4000
  s_sub_u32 s65, s65, 1
  s_cmp_lg_u32 s65, 0
  s_cbranch_scc1 .Ldrain_3
  s_waitcnt vmcnt(0)
.Ldrain_3:
  s_waitcnt vmcnt(8)
  s_barrier
  s_cmp_eq_u32 s65, 0
  s_cbranch_scc0 .Lat_ld
.Lat_warm:
  s_lshr_b32 s69, s30, 3
  s_lshr_b32 s71, s2, 1
  s_xor_b32 s71, s71, s2
  s_and_b32 s71, s71, 1
  s_lshl_b32 s71, s71, 3
  s_add_u32 s71, s71, s31
  s_and_b32 s58, s30, 3
  s_lshl_b32 s70, s71, 2
  s_add_u32 s70, s70, s58
  s_lshl_b32 s68, s3, 11
  s_mul_i32 s59, s71, 1507328
  s_add_u32 s59, s59, 0x3200000
  s_add_u32 s32, s28, s59
  s_addc_u32 s33, s29, 0
  s_mov_b32 s34, 1507328
  s_mov_b32 s35, 0x00020000
  s_mov_b32 s60, s82
  s_lshl_b32 s59, s60, 16
  s_add_u32 s36, s22, s59
  s_addc_u32 s37, s23, 0
  s_sub_u32 s38, 1835008, s59
  s_mov_b32 s39, 0x00020000
  s_lshl_b32 s72, s60, 12
  s_add_u32 s72, s72, 0x40000
  s_mov_b32 s64, 0
  s_mov_b32 s67, s72
  s_lshl_b32 s59, s69, 20
  s_add_u32 s44, s14, s59
  s_addc_u32 s45, s15, 0
  s_mov_b32 s46, 0x100000
  s_mov_b32 s47, 0x00020000
  s_lshr_b32 s59, s3, 1
  s_mul_i32 s59, s59, 376832
  s_and_b32 s60, s3, 1
  s_lshl_b32 s60, s60, 11
  s_add_u32 s59, s59, s60
  v_add_u32 v98, s59, v254
  v_bfe_u32 v90, v255, 2, 3
  v_lshrrev_b32 v91, 5, v255
  v_lshl_add_u32 v91, v91, 4, v90
  v_lshlrev_b32 v91, 8, v91
  v_and_b32 v92, 1, v255
  v_lshl_add_u32 v91, v92, 3, v91
  v_bfe_u32 v92, v255, 1, 1
  s_and_b32 s59, s3, 1
  s_lshl_b32 s59, s59, 3
  v_add_u32 v92, s59, v92
  v_lshlrev_b32 v90, 1, v90
  v_xor_b32 v92, v92, v90
  v_lshl_add_u32 v100, v92, 4, v91
  v_xor_b32 v103, 32, v100
  v_xor_b32 v106, 64, v100
  v_xor_b32 v109, 96, v100
  v_lshrrev_b32 v90, 4, v255
  v_lshlrev_b32 v90, 9, v90
  v_and_b32 v91, 15, v255
  v_lshl_add_u32 v90, v91, 4, v90
  s_lshr_b32 s59, s3, 1
  s_lshl_b32 s59, s59, 12
  s_add_u32 s59, s59, 16384
  v_add_u32 v80, s59, v90
  v_add_u32 v83, s68, v254
  v_add_u32 v101, 0x10000, v100
  v_add_u32 v102, 0x20000, v100
  v_add_u32 v104, 0x10000, v103
  v_add_u32 v105, 0x20000, v103
  v_add_u32 v107, 0x10000, v106
  v_add_u32 v108, 0x20000, v106
  v_add_u32 v110, 0x10000, v109
  v_add_u32 v111, 0x20000, v109
  v_add_u32 v81, 0x10000, v80
  v_add_u32 v82, 0x20000, v80
  v_add_u32 v84, 0x10000, v83
  v_add_u32 v85, 0x20000, v83
  v_lshlrev_b32 v91, 10, v91
  v_lshrrev_b32 v90, 4, v255
  v_lshl_add_u32 v90, v90, 3, v91
  s_lshl_b32 s59, s71, 17
  s_and_b32 s60, s69, 1
  s_lshl_b32 s60, s60, 16
  s_add_u32 s59, s59, s60
  s_lshr_b32 s60, s3, 1
  s_lshl_b32 s60, s60, 14
  s_add_u32 s59, s59, s60
  s_lshl_b32 s60, s58, 8
  s_add_u32 s59, s59, s60
  s_lshr_b32 s60, s69, 1
  s_lshl_b32 s60, s60, 7
  s_add_u32 s59, s59, s60
  s_and_b32 s60, s3, 1
  s_lshl_b32 s60, s60, 6
  s_add_u32 s59, s59, s60
  v_add_u32 v99, s59, v90
  s_mov_b32 s48, s4
  s_mov_b32 s49, s5
  s_mov_b32 s50, 0x200000
  s_mov_b32 s51, 0x00020000
  s_mov_b32 s52, s24
  s_mov_b32 s53, s25
  s_mov_b32 s54, 0x200000
  s_mov_b32 s55, 0x00020000
  s_add_u32 m0, s68, 0x20000
  s_nop 0
  buffer_load_dwordx4 v96, s[36:39], s64 offen offset:0 lds
  buffer_load_dwordx4 v97, s[36:39], s64 offen offset:1024 lds
  s_add_u32 m0, s68, 0x24000
  s_nop 0
  buffer_load_dwordx4 v98, s[32:35], s67 offen offset:0 sc1 lds
  buffer_load_dwordx4 v98, s[32:35], s67 offen offset:1024 sc1 lds
  s_add_u32 s58, s64, 0x8000
  s_add_u32 s59, s67, 753664
  s_add_u32 m0, s68, 0x22000
  s_nop 0
  buffer_load_dwordx4 v96, s[36:39], s58 offen offset:0 lds
  buffer_load_dwordx4 v97, s[36:39], s58 offen offset:1024 lds
  s_add_u32 m0, s68, 0x26000
  s_nop 0
  buffer_load_dwordx4 v98, s[32:35], s59 offen offset:0 sc1 lds
  buffer_load_dwordx4 v98, s[32:35], s59 offen offset:1024 sc1 lds
  s_add_u32 s64, s64, 0x10000
  s_add_u32 s67, s67, 4096
  s_barrier
  s_add_u32 m0, s68, 0x0
  s_nop 0
  buffer_load_dwordx4 v96, s[36:39], s64 offen offset:0 lds
  buffer_load_dwordx4 v97, s[36:39], s64 offen offset:1024 lds
  s_add_u32 m0, s68, 0x4000
  s_nop 0
  buffer_load_dwordx4 v98, s[32:35], s67 offen offset:0 sc1 lds
  buffer_load_dwordx4 v98, s[32:35], s67 offen offset:1024 sc1 lds
  s_add_u32 s58, s64, 0x8000
  s_add_u32 s59, s67, 753664
  s_add_u32 m0, s68, 0x2000
  s_nop 0
  buffer_load_dwordx4 v96, s[36:39], s58 offen offset:0 lds
  buffer_load_dwordx4 v97, s[36:39], s58 offen offset:1024 lds
  s_add_u32 m0, s68, 0x6000
  s_nop 0
  buffer_load_dwordx4 v98, s[32:35], s59 offen offset:0 sc1 lds
  buffer_load_dwordx4 v98, s[32:35], s59 offen offset:1024 sc1 lds
  s_add_u32 s64, s64, 0x10000
  s_add_u32 s67, s67, 4096
  s_add_u32 m0, s68, 0x10000
  s_nop 0
  buffer_load_dwordx4 v96, s[36:39], s64 offen offset:0 lds
  buffer_load_dwordx4 v97, s[36:39], s64 offen offset:1024 lds
  s_add_u32 m0, s68, 0x14000
  s_nop 0
  buffer_load_dwordx4 v98, s[32:35], s67 offen offset:0 sc1 lds
  buffer_load_dwordx4 v98, s[32:35], s67 offen offset:1024 sc1 lds
  s_add_u32 s58, s64, 0x8000
  s_add_u32 s59, s67, 753664
  s_add_u32 m0, s68, 0x12000
  s_nop 0
  buffer_load_dwordx4 v96, s[36:39], s58 offen offset:0 lds
  buffer_load_dwordx4 v97, s[36:39], s58 offen offset:1024 lds
  s_add_u32 m0, s68, 0x16000
  s_nop 0
  buffer_load_dwordx4 v98, s[32:35], s59 offen offset:0 sc1 lds
  buffer_load_dwordx4 v98, s[32:35], s59 offen offset:1024 sc1 lds
  s_add_u32 s64, s64, 0x10000
  s_add_u32 s67, s67, 4096
  s_add_u32 m0, s68, 0x18000
  s_nop 0
  buffer_load_dwordx4 v96, s[36:39], s64 offen offset:0 lds
  buffer_load_dwordx4 v97, s[36:39], s64 offen offset:1024 lds
  s_add_u32 m0, s68, 0x1c000
  s_nop 0
  buffer_load_dwordx4 v98, s[32:35], s67 offen offset:0 sc1 lds
  buffer_load_dwordx4 v98, s[32:35], s67 offen offset:1024 sc1 lds
  s_add_u32 s58, s64, 0x8000
  s_add_u32 s59, s67, 753664
  s_add_u32 m0, s68, 0x1a000
  s_nop 0
  buffer_load_dwordx4 v96, s[36:39], s58 offen offset:0 lds
  buffer_load_dwordx4 v97, s[36:39], s58 offen offset:1024 lds
  s_add_u32 m0, s68, 0x1e000
  s_nop 0
  buffer_load_dwordx4 v98, s[32:35], s59 offen offset:0 sc1 lds
  buffer_load_dwordx4 v98, s[32:35], s59 offen offset:1024 sc1 lds
  s_add_u32 s64, s64, 0x10000
  s_add_u32 s67, s67, 4096
  s_barrier
  s_branch .Lat_done
.Lat_g1:
  s_cmp_eq_u32 s65, 0
  s_cbranch_scc1 .Lat_g1b
  s_barrier
.Lat_g1b:
  s_bitcmp1_b32 s2, 0
  s_cselect_b32 s82, 10, 4
  s_bfe_u32 s59, s30, 0x10003
  s_mul_i32 s82, s82, s59
  s_lshr_b32 s59, s30, 4
  s_mul_i32 s59, s59, 14
  s_add_u32 s82, s82, s59
  s_and_b32 s58, s30, 3
  v_lshrrev_b32 v90, 4, v255
  v_and_b32 v91, 15, v255
  v_lshlrev_b32 v92, 1, v90
  v_xor_b32 v91, v91, v92
  v_lshlrev_b32 v90, 10, v90
  v_lshl_add_u32 v90, v91, 4, v90
  s_lshl_b32 s59, s3, 13
  s_lshl_b32 s60, s58, 8
  s_add_u32 s59, s59, s60
  v_add_u32 v96, s59, v90
  v_xor_b32 v90, 128, v96
  v_add_u32 v97, 3072, v90
  s_lshr_b32 s69, s30, 3
  s_lshr_b32 s71, s2, 1
  s_xor_b32 s71, s71, s2
  s_and_b32 s71, s71, 1
  s_lshl_b32 s71, s71, 3
  s_add_u32 s71, s71, s31
  s_and_b32 s58, s30, 3
  s_lshl_b32 s70, s71, 2
  s_add_u32 s70, s70, s58
  s_lshl_b32 s68, s3, 11
  s_mul_i32 s59, s71, 1507328
  s_add_u32 s59, s59, 0x3200000
  s_add_u32 s32, s28, s59
  s_addc_u32 s33, s29, 0
  s_mov_b32 s34, 1507328
  s_mov_b32 s35, 0x00020000
  s_mov_b32 s60, s82
  s_lshl_b32 s59, s60, 16
  s_add_u32 s36, s22, s59
  s_addc_u32 s37, s23, 0
  s_sub_u32 s38, 1835008, s59
  s_mov_b32 s39, 0x00020000
  s_lshl_b32 s72, s60, 12
  s_add_u32 s72, s72, 0x40000
  s_mov_b32 s64, 0
  s_mov_b32 s67, s72
  s_lshl_b32 s59, s69, 20
  s_add_u32 s44, s14, s59
  s_addc_u32 s45, s15, 0
  s_mov_b32 s46, 0x100000
  s_mov_b32 s47, 0x00020000
  s_lshr_b32 s59, s3, 1
  s_mul_i32 s59, s59, 376832
  s_and_b32 s60, s3, 1
  s_lshl_b32 s60, s60, 11
  s_add_u32 s59, s59, s60
  v_add_u32 v98, s59, v254
  v_bfe_u32 v90, v255, 2, 3
  v_lshrrev_b32 v91, 5, v255
  v_lshl_add_u32 v91, v91, 4, v90
  v_lshlrev_b32 v91, 8, v91
  v_and_b32 v92, 1, v255
  v_lshl_add_u32 v91, v92, 3, v91
  v_bfe_u32 v92, v255, 1, 1
  s_and_b32 s59, s3, 1
  s_lshl_b32 s59, s59, 3
  v_add_u32 v92, s59, v92
  v_lshlrev_b32 v90, 1, v90
  v_xor_b32 v92, v92, v90
  v_lshl_add_u32 v100, v92, 4, v91
  v_xor_b32 v103, 32, v100
  v_xor_b32 v106, 64, v100
  v_xor_b32 v109, 96, v100
  v_lshrrev_b32 v90, 4, v255
  v_lshlrev_b32 v90, 9, v90
  v_and_b32 v91, 15, v255
  v_lshl_add_u32 v90, v91, 4, v90
  s_lshr_b32 s59, s3, 1
  s_lshl_b32 s59, s59, 12
  s_add_u32 s59, s59, 16384
  v_add_u32 v80, s59, v90
  v_add_u32 v83, s68, v254
  v_add_u32 v101, 0x10000, v100
  v_add_u32 v102, 0x20000, v100
  v_add_u32 v104, 0x10000, v103
  v_add_u32 v105, 0x20000, v103
  v_add_u32 v107, 0x10000, v106
  v_add_u32 v108, 0x20000, v106
  v_add_u32 v110, 0x10000, v109
  v_add_u32 v111, 0x20000, v109
  v_add_u32 v81, 0x10000, v80
  v_add_u32 v82, 0x20000, v80
  v_add_u32 v84, 0x10000, v83
  v_add_u32 v85, 0x20000, v83
  v_lshlrev_b32 v91, 10, v91
  v_lshrrev_b32 v90, 4, v255
  v_lshl_add_u32 v90, v90, 3, v91
  s_lshl_b32 s59, s71, 17
  s_and_b32 s60, s69, 1
  s_lshl_b32 s60, s60, 16
  s_add_u32 s59, s59, s60
  s_lshr_b32 s60, s3, 1
  s_lshl_b32 s60, s60, 14
  s_add_u32 s59, s59, s60
  s_lshl_b32 s60, s58, 8
  s_add_u32 s59, s59, s60
  s_lshr_b32 s60, s69, 1
  s_lshl_b32 s60, s60, 7
  s_add_u32 s59, s59, s60
  s_and_b32 s60, s3, 1
  s_lshl_b32 s60, s60, 6
  s_add_u32 s59, s59, s60
  v_add_u32 v99, s59, v90
  s_mov_b32 s48, s4
  s_mov_b32 s49, s5
  s_mov_b32 s50, 0x200000
  s_mov_b32 s51, 0x00020000
  s_mov_b32 s52, s24
  s_mov_b32 s53, s25
  s_mov_b32 s54, 0x200000
  s_mov_b32 s55, 0x00020000
  s_add_u32 s64, s64, 0x10000
  s_add_u32 s67, s67, 4096
  s_add_u32 s64, s64, 0x10000
  s_add_u32 s67, s67, 4096
  s_add_u32 s64, s64, 0x10000
  s_add_u32 s67, s67, 4096
  s_add_u32 s64, s64, 0x10000
  s_add_u32 s67, s67, 4096
.Lat_done:
  s_waitcnt vmcnt(0)
  s_barrier
  ds_read_b64_tr_b16 v[32:33], v102 offset:0
  ds_read_b64_tr_b16 v[34:35], v102 offset:2048
  ds_read_b128 v[48:51], v82 offset:0
  ds_read_b64_tr_b16 v[36:37], v105 offset:0
  ds_read_b64_tr_b16 v[38:39], v105 offset:2048
  ds_read_b128 v[52:55], v82 offset:256
  ds_read_b64_tr_b16 v[40:41], v108 offset:0
  ds_read_b64_tr_b16 v[42:43], v108 offset:2048
  ds_read_b64_tr_b16 v[44:45], v111 offset:0
  ds_read_b64_tr_b16 v[46:47], v111 offset:2048
  s_lshl_b32 s58, s31, 2
  s_add_u32 s58, s58, s69
  s_add_u32 s60, s58, 32
  s_lshl_b32 s59, s69, 1
  s_sub_u32 s59, s59, s58
  s_add_u32 s59, s59, 92
  s_cmp_lg_u32 s3, 0
  s_cbranch_scc1 .Lsig_ctx
  s_lshl_b32 s88, s60, 7
  v_mov_b32 v234, s88
  s_lshl_b32 s88, s59, 7
  v_writelane_b32 v234, s88, 1
  s_mov_b64 exec, 3
  global_atomic_add v234, v253, s[16:17]
  s_mov_b64 exec, -1
.Lsig_ctx:
  s_lshl_b32 s61, s71, 2
  s_add_u32 s61, s61, s69
  s_add_u32 s61, s61, 32
  s_cmp_lg_u32 s3, 0
  s_cbranch_scc1 .Lpi_ctx
  s_lshl_b32 s88, s61, 7
  v_mov_b32 v251, s88
  s_mov_b64 exec, 1
  global_atomic_add v250, v251, v249, s[16:17] sc0
  s_mov_b64 exec, -1
.Lpi_ctx:
  buffer_load_dwordx2 v[86:87], v99, s[48:51], 0 offen
  buffer_load_dwordx2 v[88:89], v99, s[48:51], 0 offen offset:32
  s_bitcmp1_b32 s2, 0
  s_cbranch_scc1 .Lo_odd
.Lo_even:
  s_add_u32 m0, s68, 0x8000
  s_nop 0
  buffer_load_dwordx4 v96, s[36:39], s64 offen offset:0 lds
  buffer_load_dwordx4 v97, s[36:39], s64 offen offset:1024 lds
  s_add_u32 m0, s68, 0xc000
  s_nop 0
  buffer_load_dwordx4 v98, s[32:35], s67 offen offset:0 sc1 lds
  buffer_load_dwordx4 v98, s[32:35], s67 offen offset:1024 sc1 lds
  s_add_u32 s64, s64, 0x10000
  s_add_u32 s67, s67, 4096
  s_waitcnt lgkmcnt(7)
  v_mfma_f32_16x16x32_bf16 v[0:3], v[32:35], v[48:51], 0
  ds_read_b64_tr_b16 v[56:57], v102 offset:8192
  ds_read_b64_tr_b16 v[58:59], v102 offset:10240
  s_waitcnt lgkmcnt(6)
  v_mfma_f32_16x16x32_bf16 v[16:19], v[32:35], v[52:55], 0
  ds_read_b128 v[72:75], v82 offset:2048
  ds_read_b64_tr_b16 v[60:61], v105 offset:8192
  v_mfma_f32_16x16x32_bf16 v[4:7], v[36:39], v[48:51], 0
  ds_read_b64_tr_b16 v[62:63], v105 offset:10240
  ds_read_b128 v[76:79], v82 offset:2304
  v_mfma_f32_16x16x32_bf16 v[20:23], v[36:39], v[52:55], 0
  ds_read_b64_tr_b16 v[64:65], v108 offset:8192
  ds_read_b64_tr_b16 v[66:67], v108 offset:10240
  s_waitcnt lgkmcnt(10)
  v_mfma_f32_16x16x32_bf16 v[8:11], v[40:43], v[48:51], 0
  ds_read_b64_tr_b16 v[68:69], v111 offset:8192
  ds_read_b64_tr_b16 v[70:71], v111 offset:10240
  v_mfma_f32_16x16x32_bf16 v[24:27], v[40:43], v[52:55], 0
  s_waitcnt lgkmcnt(10)
  v_mfma_f32_16x16x32_bf16 v[12:15], v[44:47], v[48:51], 0
  v_mfma_f32_16x16x32_bf16 v[28:31], v[44:47], v[52:55], 0
  s_waitcnt vmcnt(6) lgkmcnt(0)
  v_mfma_f32_16x16x32_bf16 v[0:3], v[56:59], v[72:75], v[0:3]
  s_barrier
  ds_read_b64_tr_b16 v[32:33], v100 offset:0
  ds_read_b64_tr_b16 v[34:35], v100 offset:2048
  v_mfma_f32_16x16x32_bf16 v[16:19], v[56:59], v[76:79], v[16:19]
  ds_read_b128 v[48:51], v80 offset:0
  ds_read_b64_tr_b16 v[36:37], v103 offset:0
  v_mfma_f32_16x16x32_bf16 v[4:7], v[60:63], v[72:75], v[4:7]
  ds_read_b64_tr_b16 v[38:39], v103 offset:2048
  ds_read_b128 v[52:55], v80 offset:256
  v_mfma_f32_16x16x32_bf16 v[20:23], v[60:63], v[76:79], v[20:23]
  ds_read_b64_tr_b16 v[40:41], v106 offset:0
  ds_read_b64_tr_b16 v[42:43], v106 offset:2048
  v_mfma_f32_16x16x32_bf16 v[8:11], v[64:67], v[72:75], v[8:11]
  ds_read_b64_tr_b16 v[44:45], v109 offset:0
  ds_read_b64_tr_b16 v[46:47], v109 offset:2048
  v_mfma_f32_16x16x32_bf16 v[24:27], v[64:67], v[76:79], v[24:27]
  s_add_u32 m0, s68, 0x20000
  s_nop 0
  buffer_load_dwordx4 v96, s[36:39], s64 offen offset:0 lds
  v_mfma_f32_16x16x32_bf16 v[12:15], v[68:71], v[72:75], v[12:15]
  v_mfma_f32_16x16x32_bf16 v[28:31], v[68:71], v[76:79], v[28:31]
  buffer_load_dwordx4 v97, s[36:39], s64 offen offset:1024 lds
  s_add_u32 m0, s68, 0x24000
  s_waitcnt lgkmcnt(7)
  v_mfma_f32_16x16x32_bf16 v[0:3], v[32:35], v[48:51], v[0:3]
  ds_read_b64_tr_b16 v[56:57], v100 offset:8192
  ds_read_b64_tr_b16 v[58:59], v100 offset:10240
  s_waitcnt lgkmcnt(6)
  v_mfma_f32_16x16x32_bf16 v[16:19], v[32:35], v[52:55], v[16:19]
  ds_read_b128 v[72:75], v80 offset:2048
  ds_read_b64_tr_b16 v[60:61], v103 offset:8192
  v_mfma_f32_16x16x32_bf16 v[4:7], v[36:39], v[48:51], v[4:7]
  ds_read_b64_tr_b16 v[62:63], v103 offset:10240
  ds_read_b128 v[76:79], v80 offset:2304
  v_mfma_f32_16x16x32_bf16 v[20:23], v[36:39], v[52:55], v[20:23]
  ds_read_b64_tr_b16 v[64:65], v106 offset:8192
  ds_read_b64_tr_b16 v[66:67], v106 offset:10240
  s_waitcnt lgkmcnt(10)
  v_mfma_f32_16x16x32_bf16 v[8:11], v[40:43], v[48:51], v[8:11]
  ds_read_b64_tr_b16 v[68:69], v109 offset:8192
  ds_read_b64_tr_b16 v[70:71], v109 offset:10240
  v_mfma_f32_16x16x32_bf16 v[24:27], v[40:43], v[52:55], v[24:27]
  buffer_load_dwordx4 v98, s[32:35], s67 offen offset:0 sc1 lds
  s_waitcnt lgkmcnt(10)
  v_mfma_f32_16x16x32_bf16 v[12:15], v[44:47], v[48:51], v[12:15]
  v_mfma_f32_16x16x32_bf16 v[28:31], v[44:47], v[52:55], v[28:31]
  buffer_load_dwordx4 v98, s[32:35], s67 offen offset:1024 sc1 lds
  s_add_u32 s64, s64, 0x10000
  s_add_u32 s67, s67, 4096
  s_waitcnt vmcnt(10) lgkmcnt(0)
  v_mfma_f32_16x16x32_bf16 v[0:3], v[56:59], v[72:75], v[0:3]
  s_barrier
  ds_read_b64_tr_b16 v[32:33], v101 offset:0
  ds_read_b64_tr_b16 v[34:35], v101 offset:2048
  v_mfma_f32_16x16x32_bf16 v[16:19], v[56:59], v[76:79], v[16:19]
  ds_read_b128 v[48:51], v81 offset:0
  ds_read_b64_tr_b16 v[36:37], v104 offset:0
  v_mfma_f32_16x16x32_bf16 v[4:7], v[60:63], v[72:75], v[4:7]
  ds_read_b64_tr_b16 v[38:39], v104 offset:2048
  ds_read_b128 v[52:55], v81 offset:256
  v_mfma_f32_16x16x32_bf16 v[20:23], v[60:63], v[76:79], v[20:23]
  ds_read_b64_tr_b16 v[40:41], v107 offset:0
  ds_read_b64_tr_b16 v[42:43], v107 offset:2048
  v_mfma_f32_16x16x32_bf16 v[8:11], v[64:67], v[72:75], v[8:11]
  ds_read_b64_tr_b16 v[44:45], v110 offset:0
  ds_read_b64_tr_b16 v[46:47], v110 offset:2048
  v_mfma_f32_16x16x32_bf16 v[24:27], v[64:67], v[76:79], v[24:27]
  s_add_u32 m0, s68, 0x0
  s_nop 0
  buffer_load_dwordx4 v96, s[36:39], s64 offen offset:0 lds
  v_mfma_f32_16x16x32_bf16 v[12:15], v[68:71], v[72:75], v[12:15]
  v_mfma_f32_16x16x32_bf16 v[28:31], v[68:71], v[76:79], v[28:31]
  buffer_load_dwordx4 v97, s[36:39], s64 offen offset:1024 lds
  s_add_u32 m0, s68, 0x4000
  s_waitcnt lgkmcnt(7)
  v_mfma_f32_16x16x32_bf16 v[0:3], v[32:35], v[48:51], v[0:3]
  ds_read_b64_tr_b16 v[56:57], v101 offset:8192
  ds_read_b64_tr_b16 v[58:59], v101 offset:10240
  s_waitcnt lgkmcnt(6)
  v_mfma_f32_16x16x32_bf16 v[16:19], v[32:35], v[52:55], v[16:19]
  ds_read_b128 v[72:75], v81 offset:2048
  ds_read_b64_tr_b16 v[60:61], v104 offset:8192
  v_mfma_f32_16x16x32_bf16 v[4:7], v[36:39], v[48:51], v[4:7]
  ds_read_b64_tr_b16 v[62:63], v104 offset:10240
  ds_read_b128 v[76:79], v81 offset:2304
  v_mfma_f32_16x16x32_bf16 v[20:23], v[36:39], v[52:55], v[20:23]
  ds_read_b64_tr_b16 v[64:65], v107 offset:8192
  ds_read_b64_tr_b16 v[66:67], v107 offset:10240
  s_waitcnt lgkmcnt(10)
  v_mfma_f32_16x16x32_bf16 v[8:11], v[40:43], v[48:51], v[8:11]
  ds_read_b64_tr_b16 v[68:69], v110 offset:8192
  ds_read_b64_tr_b16 v[70:71], v110 offset:10240
  v_mfma_f32_16x16x32_bf16 v[24:27], v[40:43], v[52:55], v[24:27]
  buffer_load_dwordx4 v98, s[32:35], s67 offen offset:0 sc1 lds
  s_waitcnt lgkmcnt(10)
  v_mfma_f32_16x16x32_bf16 v[12:15], v[44:47], v[48:51], v[12:15]
  v_mfma_f32_16x16x32_bf16 v[28:31], v[44:47], v[52:55], v[28:31]
  buffer_load_dwordx4 v98, s[32:35], s67 offen offset:1024 sc1 lds
  s_add_u32 s64, s64, 0x10000
  s_add_u32 s67, s67, 4096
  s_waitcnt vmcnt(14) lgkmcnt(0)
  v_mfma_f32_16x16x32_bf16 v[0:3], v[56:59], v[72:75], v[0:3]
  s_barrier
  ds_read_b64_tr_b16 v[32:33], v101 offset:32768
  ds_read_b64_tr_b16 v[34:35], v101 offset:34816
  v_mfma_f32_16x16x32_bf16 v[16:19], v[56:59], v[76:79], v[16:19]
  ds_read_b128 v[48:51], v81 offset:32768
  ds_read_b64_tr_b16 v[36:37], v104 offset:32768
  v_mfma_f32_16x16x32_bf16 v[4:7], v[60:63], v[72:75], v[4:7]
  ds_read_b64_tr_b16 v[38:39], v104 offset:34816
  ds_read_b128 v[52:55], v81 offset:33024
  v_mfma_f32_16x16x32_bf16 v[20:23], v[60:63], v[76:79], v[20:23]
  ds_read_b64_tr_b16 v[40:41], v107 offset:32768
  ds_read_b64_tr_b16 v[42:43], v107 offset:34816
  v_mfma_f32_16x16x32_bf16 v[8:11], v[64:67], v[72:75], v[8:11]
  ds_read_b64_tr_b16 v[44:45], v110 offset:32768
  ds_read_b64_tr_b16 v[46:47], v110 offset:34816
  v_mfma_f32_16x16x32_bf16 v[24:27], v[64:67], v[76:79], v[24:27]
  s_add_u32 m0, s68, 0x10000
  s_nop 0
  buffer_load_dwordx4 v96, s[36:39], s64 offen offset:0 lds
  v_mfma_f32_16x16x32_bf16 v[12:15], v[68:71], v[72:75], v[12:15]
  v_mfma_f32_16x16x32_bf16 v[28:31], v[68:71], v[76:79], v[28:31]
  buffer_load_dwordx4 v97, s[36:39], s64 offen offset:1024 lds
  s_add_u32 m0, s68, 0x14000
  s_waitcnt lgkmcnt(7)
  v_mfma_f32_16x16x32_bf16 v[0:3], v[32:35], v[48:51], v[0:3]
  ds_read_b64_tr_b16 v[56:57], v101 offset:40960
  ds_read_b64_tr_b16 v[58:59], v101 offset:43008
  s_waitcnt lgkmcnt(6)
  v_mfma_f32_16x16x32_bf16 v[16:19], v[32:35], v[52:55], v[16:19]
  ds_read_b128 v[72:75], v81 offset:34816
  ds_read_b64_tr_b16 v[60:61], v104 offset:40960
  v_mfma_f32_16x16x32_bf16 v[4:7], v[36:39], v[48:51], v[4:7]
  ds_read_b64_tr_b16 v[62:63], v104 offset:43008
  ds_read_b128 v[76:79], v81 offset:35072
  v_mfma_f32_16x16x32_bf16 v[20:23], v[36:39], v[52:55], v[20:23]
  ds_read_b64_tr_b16 v[64:65], v107 offset:40960
  ds_read_b64_tr_b16 v[66:67], v107 offset:43008
  s_waitcnt lgkmcnt(10)
  v_mfma_f32_16x16x32_bf16 v[8:11], v[40:43], v[48:51], v[8:11]
  ds_read_b64_tr_b16 v[68:69], v110 offset:40960
  ds_read_b64_tr_b16 v[70:71], v110 offset:43008
  v_mfma_f32_16x16x32_bf16 v[24:27], v[40:43], v[52:55], v[24:27]
  buffer_load_dwordx4 v98, s[32:35], s67 offen offset:0 sc1 lds
  s_waitcnt lgkmcnt(10)
  v_mfma_f32_16x16x32_bf16 v[12:15], v[44:47], v[48:51], v[12:15]
  v_mfma_f32_16x16x32_bf16 v[28:31], v[44:47], v[52:55], v[28:31]
  buffer_load_dwordx4 v98, s[32:35], s67 offen offset:1024 sc1 lds
  s_add_u32 s64, s64, 0x10000
  s_add_u32 s67, s67, 4096
  s_waitcnt vmcnt(12) lgkmcnt(0)
  v_mfma_f32_16x16x32_bf16 v[0:3], v[56:59], v[72:75], v[0:3]
  s_barrier
  ds_read_b64_tr_b16 v[32:33], v100 offset:32768
  ds_read_b64_tr_b16 v[34:35], v100 offset:34816
  v_mfma_f32_16x16x32_bf16 v[16:19], v[56:59], v[76:79], v[16:19]
  ds_read_b128 v[48:51], v80 offset:32768
  ds_read_b64_tr_b16 v[36:37], v103 offset:32768
  v_mfma_f32_16x16x32_bf16 v[4:7], v[60:63], v[72:75], v[4:7]
  ds_read_b64_tr_b16 v[38:39], v103 offset:34816
  ds_read_b128 v[52:55], v80 offset:33024
  v_mfma_f32_16x16x32_bf16 v[20:23], v[60:63], v[76:79], v[20:23]
  ds_read_b64_tr_b16 v[40:41], v106 offset:32768
  ds_read_b64_tr_b16 v[42:43], v106 offset:34816
  v_mfma_f32_16x16x32_bf16 v[8:11], v[64:67], v[72:75], v[8:11]
  ds_read_b64_tr_b16 v[44:45], v109 offset:32768
  ds_read_b64_tr_b16 v[46:47], v109 offset:34816
  v_mfma_f32_16x16x32_bf16 v[24:27], v[64:67], v[76:79], v[24:27]
  s_add_u32 m0, s68, 0x18000
  s_nop 0
  buffer_load_dwordx4 v96, s[36:39], s64 offen offset:0 lds
  v_mfma_f32_16x16x32_bf16 v[12:15], v[68:71], v[72:75], v[12:15]
  v_mfma_f32_16x16x32_bf16 v[28:31], v[68:71], v[76:79], v[28:31]
  buffer_load_dwordx4 v97, s[36:39], s64 offen offset:1024 lds
  s_add_u32 m0, s68, 0x1c000
  s_waitcnt lgkmcnt(7)
  v_mfma_f32_16x16x32_bf16 v[0:3], v[32:35], v[48:51], v[0:3]
  ds_read_b64_tr_b16 v[56:57], v100 offset:40960
  ds_read_b64_tr_b16 v[58:59], v100 offset:43008
  s_waitcnt lgkmcnt(6)
  v_mfma_f32_16x16x32_bf16 v[16:19], v[32:35], v[52:55], v[16:19]
  ds_read_b128 v[72:75], v80 offset:34816
  ds_read_b64_tr_b16 v[60:61], v103 offset:40960
  v_mfma_f32_16x16x32_bf16 v[4:7], v[36:39], v[48:51], v[4:7]
  ds_read_b64_tr_b16 v[62:63], v103 offset:43008
  ds_read_b128 v[76:79], v80 offset:35072
  v_mfma_f32_16x16x32_bf16 v[20:23], v[36:39], v[52:55], v[20:23]
  ds_read_b64_tr_b16 v[64:65], v106 offset:40960
  ds_read_b64_tr_b16 v[66:67], v106 offset:43008
  s_waitcnt lgkmcnt(10)
  v_mfma_f32_16x16x32_bf16 v[8:11], v[40:43], v[48:51], v[8:11]
  ds_read_b64_tr_b16 v[68:69], v109 offset:40960
  ds_read_b64_tr_b16 v[70:71], v109 offset:43008
  v_mfma_f32_16x16x32_bf16 v[24:27], v[40:43], v[52:55], v[24:27]
  buffer_load_dwordx4 v98, s[32:35], s67 offen offset:0 sc1 lds
  s_waitcnt lgkmcnt(10)
  v_mfma_f32_16x16x32_bf16 v[12:15], v[44:47], v[48:51], v[12:15]
  v_mfma_f32_16x16x32_bf16 v[28:31], v[44:47], v[52:55], v[28:31]
  buffer_load_dwordx4 v98, s[32:35], s67 offen offset:1024 sc1 lds
  s_add_u32 s64, s64, 0x10000
  s_add_u32 s67, s67, 4096
  s_waitcnt vmcnt(12) lgkmcnt(0)
  v_mfma_f32_16x16x32_bf16 v[0:3], v[56:59], v[72:75], v[0:3]
  s_barrier
  ds_read_b64_tr_b16 v[32:33], v102 offset:0
  ds_read_b64_tr_b16 v[34:35], v102 offset:2048
  v_mfma_f32_16x16x32_bf16 v[16:19], v[56:59], v[76:79], v[16:19]
  ds_read_b128 v[48:51], v82 offset:0
  ds_read_b64_tr_b16 v[36:37], v105 offset:0
  v_mfma_f32_16x16x32_bf16 v[4:7], v[60:63], v[72:75], v[4:7]
  ds_read_b64_tr_b16 v[38:39], v105 offset:2048
  ds_read_b128 v[52:55], v82 offset:256
  v_mfma_f32_16x16x32_bf16 v[20:23], v[60:63], v[76:79], v[20:23]
  ds_read_b64_tr_b16 v[40:41], v108 offset:0
  ds_read_b64_tr_b16 v[42:43], v108 offset:2048
  v_mfma_f32_16x16x32_bf16 v[8:11], v[64:67], v[72:75], v[8:11]
  ds_read_b64_tr_b16 v[44:45], v111 offset:0
  ds_read_b64_tr_b16 v[46:47], v111 offset:2048
  v_mfma_f32_16x16x32_bf16 v[24:27], v[64:67], v[76:79], v[24:27]
  s_add_u32 m0, s68, 0x8000
  s_nop 0
  buffer_load_dwordx4 v96, s[36:39], s64 offen offset:0 lds
  v_mfma_f32_16x16x32_bf16 v[12:15], v[68:71], v[72:75], v[12:15]
  v_mfma_f32_16x16x32_bf16 v[28:31], v[68:71], v[76:79], v[28:31]
  buffer_load_dwordx4 v97, s[36:39], s64 offen offset:1024 lds
  s_add_u32 m0, s68, 0xc000
  s_waitcnt lgkmcnt(7)
  v_mfma_f32_16x16x32_bf16 v[0:3], v[32:35], v[48:51], v[0:3]
  ds_read_b64_tr_b16 v[56:57], v102 offset:8192
  ds_read_b64_tr_b16 v[58:59], v102 offset:10240
  s_waitcnt lgkmcnt(6)
  v_mfma_f32_16x16x32_bf16 v[16:19], v[32:35], v[52:55], v[16:19]
  ds_read_b128 v[72:75], v82 offset:2048
  ds_read_b64_tr_b16 v[60:61], v105 offset:8192
  v_mfma_f32_16x16x32_bf16 v[4:7], v[36:39], v[48:51], v[4:7]
  ds_read_b64_tr_b16 v[62:63], v105 offset:10240
  ds_read_b128 v[76:79], v82 offset:2304
  v_mfma_f32_16x16x32_bf16 v[20:23], v[36:39], v[52:55], v[20:23]
  ds_read_b64_tr_b16 v[64:65], v108 offset:8192
  ds_read_b64_tr_b16 v[66:67], v108 offset:10240
  s_waitcnt lgkmcnt(10)
  v_mfma_f32_16x16x32_bf16 v[8:11], v[40:43], v[48:51], v[8:11]
  ds_read_b64_tr_b16 v[68:69], v111 offset:8192
  ds_read_b64_tr_b16 v[70:71], v111 offset:10240
  v_mfma_f32_16x16x32_bf16 v[24:27], v[40:43], v[52:55], v[24:27]
  buffer_load_dwordx4 v98, s[32:35], s67 offen offset:0 sc1 lds
  s_waitcnt lgkmcnt(10)
  v_mfma_f32_16x16x32_bf16 v[12:15], v[44:47], v[48:51], v[12:15]
  v_mfma_f32_16x16x32_bf16 v[28:31], v[44:47], v[52:55], v[28:31]
  buffer_load_dwordx4 v98, s[32:35], s67 offen offset:1024 sc1 lds
  s_lshl_b32 s67, s69, 16
  s_mov_b32 s64, 0
  s_waitcnt vmcnt(12) lgkmcnt(0)
  s_cmp_lg_u32 s3, 0
  s_cbranch_scc1 .Lok_ctx10
  v_readfirstlane_b32 s86, v250
  s_nop 0
  s_cmp_lt_u32 s86, 8
  s_cbranch_scc1 .Lspin_ctx10
.Lok_ctx10:
  v_mfma_f32_16x16x32_bf16 v[0:3], v[56:59], v[72:75], v[0:3]
  s_barrier
  ds_read_b64_tr_b16 v[32:33], v100 offset:0
  ds_read_b64_tr_b16 v[34:35], v100 offset:2048
  v_mfma_f32_16x16x32_bf16 v[16:19], v[56:59], v[76:79], v[16:19]
  ds_read_b128 v[48:51], v80 offset:0
  ds_read_b64_tr_b16 v[36:37], v103 offset:0
  v_mfma_f32_16x16x32_bf16 v[4:7], v[60:63], v[72:75], v[4:7]
  ds_read_b64_tr_b16 v[38:39], v103 offset:2048
  ds_read_b128 v[52:55], v80 offset:256
  v_mfma_f32_16x16x32_bf16 v[20:23], v[60:63], v[76:79], v[20:23]
  ds_read_b64_tr_b16 v[40:41], v106 offset:0
  ds_read_b64_tr_b16 v[42:43], v106 offset:2048
  v_mfma_f32_16x16x32_bf16 v[8:11], v[64:67], v[72:75], v[8:11]
  ds_read_b64_tr_b16 v[44:45], v109 offset:0
  ds_read_b64_tr_b16 v[46:47], v109 offset:2048
  v_mfma_f32_16x16x32_bf16 v[24:27], v[64:67], v[76:79], v[24:27]
  s_add_u32 m0, s68, 0x20000
  s_nop 0
  buffer_load_dwordx4 v96, s[44:47], s64 offen offset:0 lds
  v_mfma_f32_16x16x32_bf16 v[12:15], v[68:71], v[72:75], v[12:15]
  v_mfma_f32_16x16x32_bf16 v[28:31], v[68:71], v[76:79], v[28:31]
  buffer_load_dwordx4 v97, s[44:47], s64 offen offset:1024 lds
  s_add_u32 m0, s68, 0x24000
  s_waitcnt lgkmcnt(7)
  v_mfma_f32_16x16x32_bf16 v[0:3], v[32:35], v[48:51], v[0:3]
  ds_read_b64_tr_b16 v[56:57], v100 offset:8192
  ds_read_b64_tr_b16 v[58:59], v100 offset:10240
  s_waitcnt lgkmcnt(6)
  v_mfma_f32_16x16x32_bf16 v[16:19], v[32:35], v[52:55], v[16:19]
  ds_read_b128 v[72:75], v80 offset:2048
  ds_read_b64_tr_b16 v[60:61], v103 offset:8192
  v_mfma_f32_16x16x32_bf16 v[4:7], v[36:39], v[48:51], v[4:7]
  ds_read_b64_tr_b16 v[62:63], v103 offset:10240
  ds_read_b128 v[76:79], v80 offset:2304
  v_mfma_f32_16x16x32_bf16 v[20:23], v[36:39], v[52:55], v[20:23]
  ds_read_b64_tr_b16 v[64:65], v106 offset:8192
  ds_read_b64_tr_b16 v[66:67], v106 offset:10240
  s_waitcnt lgkmcnt(10)
  v_mfma_f32_16x16x32_bf16 v[8:11], v[40:43], v[48:51], v[8:11]
  ds_read_b64_tr_b16 v[68:69], v109 offset:8192
  ds_read_b64_tr_b16 v[70:71], v109 offset:10240
  v_mfma_f32_16x16x32_bf16 v[24:27], v[40:43], v[52:55], v[24:27]
  buffer_load_dwordx4 v98, s[32:35], s67 offen offset:0 sc1 lds
  s_waitcnt lgkmcnt(10)
  v_mfma_f32_16x16x32_bf16 v[12:15], v[44:47], v[48:51], v[12:15]
  v_mfma_f32_16x16x32_bf16 v[28:31], v[44:47], v[52:55], v[28:31]
  buffer_load_dwordx4 v98, s[32:35], s67 offen offset:1024 sc1 lds
  s_add_u32 s64, s64, 0x10000
  s_add_u32 s67, s67, 4096
  s_waitcnt vmcnt(12) lgkmcnt(0)
  v_mfma_f32_16x16x32_bf16 v[0:3], v[56:59], v[72:75], v[0:3]
  s_barrier
  ds_read_b64_tr_b16 v[32:33], v101 offset:0
  ds_read_b64_tr_b16 v[34:35], v101 offset:2048
  v_mfma_f32_16x16x32_bf16 v[16:19], v[56:59], v[76:79], v[16:19]
  ds_read_b128 v[48:51], v81 offset:0
  ds_read_b64_tr_b16 v[36:37], v104 offset:0
  v_mfma_f32_16x16x32_bf16 v[4:7], v[60:63], v[72:75], v[4:7]
  ds_read_b64_tr_b16 v[38:39], v104 offset:2048
  ds_read_b128 v[52:55], v81 offset:256
  v_mfma_f32_16x16x32_bf16 v[20:23], v[60:63], v[76:79], v[20:23]
  ds_read_b64_tr_b16 v[40:41], v107 offset:0
  ds_read_b64_tr_b16 v[42:43], v107 offset:2048
  v_mfma_f32_16x16x32_bf16 v[8:11], v[64:67], v[72:75], v[8:11]
  ds_read_b64_tr_b16 v[44:45], v110 offset:0
  ds_read_b64_tr_b16 v[46:47], v110 offset:2048
  v_mfma_f32_16x16x32_bf16 v[24:27], v[64:67], v[76:79], v[24:27]
  s_add_u32 m0, s68, 0x0
  s_nop 0
  buffer_load_dwordx4 v96, s[44:47], s64 offen offset:0 lds
  v_mfma_f32_16x16x32_bf16 v[12:15], v[68:71], v[72:75], v[12:15]
  v_mfma_f32_16x16x32_bf16 v[28:31], v[68:71], v[76:79], v[28:31]
  buffer_load_dwordx4 v97, s[44:47], s64 offen offset:1024 lds
  s_add_u32 m0, s68, 0x4000
  s_waitcnt lgkmcnt(7)
  v_mfma_f32_16x16x32_bf16 v[0:3], v[32:35], v[48:51], v[0:3]
  ds_read_b64_tr_b16 v[56:57], v101 offset:8192
  ds_read_b64_tr_b16 v[58:59], v101 offset:10240
  s_waitcnt lgkmcnt(6)
  v_mfma_f32_16x16x32_bf16 v[16:19], v[32:35], v[52:55], v[16:19]
  ds_read_b128 v[72:75], v81 offset:2048
  ds_read_b64_tr_b16 v[60:61], v104 offset:8192
  v_mfma_f32_16x16x32_bf16 v[4:7], v[36:39], v[48:51], v[4:7]
  ds_read_b64_tr_b16 v[62:63], v104 offset:10240
  ds_read_b128 v[76:79], v81 offset:2304
  v_mfma_f32_16x16x32_bf16 v[20:23], v[36:39], v[52:55], v[20:23]
  ds_read_b64_tr_b16 v[64:65], v107 offset:8192
  ds_read_b64_tr_b16 v[66:67], v107 offset:10240
  s_waitcnt lgkmcnt(10)
  v_mfma_f32_16x16x32_bf16 v[8:11], v[40:43], v[48:51], v[8:11]
  ds_read_b64_tr_b16 v[68:69], v110 offset:8192
  ds_read_b64_tr_b16 v[70:71], v110 offset:10240
  v_mfma_f32_16x16x32_bf16 v[24:27], v[40:43], v[52:55], v[24:27]
  buffer_load_dwordx4 v98, s[32:35], s67 offen offset:0 sc1 lds
  s_waitcnt lgkmcnt(10)
  v_mfma_f32_16x16x32_bf16 v[12:15], v[44:47], v[48:51], v[12:15]
  v_mfma_f32_16x16x32_bf16 v[28:31], v[44:47], v[52:55], v[28:31]
  buffer_load_dwordx4 v98, s[32:35], s67 offen offset:1024 sc1 lds
  s_add_u32 s64, s64, 0x10000
  s_add_u32 s67, s67, 4096
  s_waitcnt vmcnt(12) lgkmcnt(0)
  v_mfma_f32_16x16x32_bf16 v[0:3], v[56:59], v[72:75], v[0:3]
  s_barrier
  ds_read_b64_tr_b16 v[32:33], v101 offset:32768
  ds_read_b64_tr_b16 v[34:35], v101 offset:34816
  v_mfma_f32_16x16x32_bf16 v[16:19], v[56:59], v[76:79], v[16:19]
  ds_read_b128 v[48:51], v81 offset:32768
  ds_read_b64_tr_b16 v[36:37], v104 offset:32768
  v_mfma_f32_16x16x32_bf16 v[4:7], v[60:63], v[72:75], v[4:7]
  ds_read_b64_tr_b16 v[38:39], v104 offset:34816
  ds_read_b128 v[52:55], v81 offset:33024
  v_mfma_f32_16x16x32_bf16 v[20:23], v[60:63], v[76:79], v[20:23]
  ds_read_b64_tr_b16 v[40:41], v107 offset:32768
  ds_read_b64_tr_b16 v[42:43], v107 offset:34816
  v_mfma_f32_16x16x32_bf16 v[8:11], v[64:67], v[72:75], v[8:11]
  ds_read_b64_tr_b16 v[44:45], v110 offset:32768
  ds_read_b64_tr_b16 v[46:47], v110 offset:34816
  v_mfma_f32_16x16x32_bf16 v[24:27], v[64:67], v[76:79], v[24:27]
  s_add_u32 m0, s68, 0x10000
  s_nop 0
  buffer_load_dwordx4 v96, s[44:47], s64 offen offset:0 lds
  v_mfma_f32_16x16x32_bf16 v[12:15], v[68:71], v[72:75], v[12:15]
  v_mfma_f32_16x16x32_bf16 v[28:31], v[68:71], v[76:79], v[28:31]
  buffer_load_dwordx4 v97, s[44:47], s64 offen offset:1024 lds
  s_add_u32 m0, s68, 0x14000
  s_waitcnt lgkmcnt(7)
  v_mfma_f32_16x16x32_bf16 v[0:3], v[32:35], v[48:51], v[0:3]
  ds_read_b64_tr_b16 v[56:57], v101 offset:40960
  ds_read_b64_tr_b16 v[58:59], v101 offset:43008
  s_waitcnt lgkmcnt(6)
  v_mfma_f32_16x16x32_bf16 v[16:19], v[32:35], v[52:55], v[16:19]
  ds_read_b128 v[72:75], v81 offset:34816
  ds_read_b64_tr_b16 v[60:61], v104 offset:40960
  v_mfma_f32_16x16x32_bf16 v[4:7], v[36:39], v[48:51], v[4:7]
  ds_read_b64_tr_b16 v[62:63], v104 offset:43008
  ds_read_b128 v[76:79], v81 offset:35072
  v_mfma_f32_16x16x32_bf16 v[20:23], v[36:39], v[52:55], v[20:23]
  ds_read_b64_tr_b16 v[64:65], v107 offset:40960
  ds_read_b64_tr_b16 v[66:67], v107 offset:43008
  s_waitcnt lgkmcnt(10)
  v_mfma_f32_16x16x32_bf16 v[8:11], v[40:43], v[48:51], v[8:11]
  ds_read_b64_tr_b16 v[68:69], v110 offset:40960
  ds_read_b64_tr_b16 v[70:71], v110 offset:43008
  v_mfma_f32_16x16x32_bf16 v[24:27], v[40:43], v[52:55], v[24:27]
  buffer_load_dwordx4 v98, s[32:35], s67 offen offset:0 sc1 lds
  s_waitcnt lgkmcnt(10)
  v_mfma_f32_16x16x32_bf16 v[12:15], v[44:47], v[48:51], v[12:15]
  v_mfma_f32_16x16x32_bf16 v[28:31], v[44:47], v[52:55], v[28:31]
  buffer_load_dwordx4 v98, s[32:35], s67 offen offset:1024 sc1 lds
  s_add_u32 s64, s64, 0x10000
  s_add_u32 s67, s67, 4096
  s_waitcnt vmcnt(12) lgkmcnt(0)
  v_mfma_f32_16x16x32_bf16 v[0:3], v[56:59], v[72:75], v[0:3]
  s_barrier
  ds_read_b64_tr_b16 v[32:33], v100 offset:32768
  ds_read_b64_tr_b16 v[34:35], v100 offset:34816
  v_mfma_f32_16x16x32_bf16 v[16:19], v[56:59], v[76:79], v[16:19]
  ds_read_b128 v[48:51], v80 offset:32768
  ds_read_b64_tr_b16 v[36:37], v103 offset:32768
  v_mfma_f32_16x16x32_bf16 v[4:7], v[60:63], v[72:75], v[4:7]
  ds_read_b64_tr_b16 v[38:39], v103 offset:34816
  ds_read_b128 v[52:55], v80 offset:33024
  v_mfma_f32_16x16x32_bf16 v[20:23], v[60:63], v[76:79], v[20:23]
  ds_read_b64_tr_b16 v[40:41], v106 offset:32768
  ds_read_b64_tr_b16 v[42:43], v106 offset:34816
  v_mfma_f32_16x16x32_bf16 v[8:11], v[64:67], v[72:75], v[8:11]
  ds_read_b64_tr_b16 v[44:45], v109 offset:32768
  ds_read_b64_tr_b16 v[46:47], v109 offset:34816
  v_mfma_f32_16x16x32_bf16 v[24:27], v[64:67], v[76:79], v[24:27]
  s_add_u32 m0, s68, 0x18000
  s_nop 0
  buffer_load_dwordx4 v96, s[44:47], s64 offen offset:0 lds
  v_mfma_f32_16x16x32_bf16 v[12:15], v[68:71], v[72:75], v[12:15]
  v_mfma_f32_16x16x32_bf16 v[28:31], v[68:71], v[76:79], v[28:31]
  buffer_load_dwordx4 v97, s[44:47], s64 offen offset:1024 lds
  s_add_u32 m0, s68, 0x1c000
  s_waitcnt lgkmcnt(7)
  v_mfma_f32_16x16x32_bf16 v[0:3], v[32:35], v[48:51], v[0:3]
  ds_read_b64_tr_b16 v[56:57], v100 offset:40960
  ds_read_b64_tr_b16 v[58:59], v100 offset:43008
  s_waitcnt lgkmcnt(6)
  v_mfma_f32_16x16x32_bf16 v[16:19], v[32:35], v[52:55], v[16:19]
  ds_read_b128 v[72:75], v80 offset:34816
  ds_read_b64_tr_b16 v[60:61], v103 offset:40960
  v_mfma_f32_16x16x32_bf16 v[4:7], v[36:39], v[48:51], v[4:7]
  ds_read_b64_tr_b16 v[62:63], v103 offset:43008
  ds_read_b128 v[76:79], v80 offset:35072
  v_mfma_f32_16x16x32_bf16 v[20:23], v[36:39], v[52:55], v[20:23]
  ds_read_b64_tr_b16 v[64:65], v106 offset:40960
  ds_read_b64_tr_b16 v[66:67], v106 offset:43008
  s_waitcnt lgkmcnt(10)
  v_mfma_f32_16x16x32_bf16 v[8:11], v[40:43], v[48:51], v[8:11]
  ds_read_b64_tr_b16 v[68:69], v109 offset:40960
  ds_read_b64_tr_b16 v[70:71], v109 offset:43008
  v_mfma_f32_16x16x32_bf16 v[24:27], v[40:43], v[52:55], v[24:27]
  buffer_load_dwordx4 v98, s[32:35], s67 offen offset:0 sc1 lds
  s_waitcnt lgkmcnt(10)
  v_mfma_f32_16x16x32_bf16 v[12:15], v[44:47], v[48:51], v[12:15]
  v_mfma_f32_16x16x32_bf16 v[28:31], v[44:47], v[52:55], v[28:31]
  buffer_load_dwordx4 v98, s[32:35], s67 offen offset:1024 sc1 lds
  s_add_u32 s64, s64, 0x10000
  s_add_u32 s67, s67, 4096
  s_waitcnt vmcnt(12) lgkmcnt(0)
  v_mfma_f32_16x16x32_bf16 v[0:3], v[56:59], v[72:75], v[0:3]
  s_barrier
  ds_read_b64_tr_b16 v[32:33], v102 offset:0
  ds_read_b64_tr_b16 v[34:35], v102 offset:2048
  v_mfma_f32_16x16x32_bf16 v[16:19], v[56:59], v[76:79], v[16:19]
  ds_read_b128 v[48:51], v82 offset:0
  ds_read_b64_tr_b16 v[36:37], v105 offset:0
  v_mfma_f32_16x16x32_bf16 v[4:7], v[60:63], v[72:75], v[4:7]
  ds_read_b64_tr_b16 v[38:39], v105 offset:2048
  ds_read_b128 v[52:55], v82 offset:256
  v_mfma_f32_16x16x32_bf16 v[20:23], v[60:63], v[76:79], v[20:23]
  ds_read_b64_tr_b16 v[40:41], v108 offset:0
  ds_read_b64_tr_b16 v[42:43], v108 offset:2048
  v_mfma_f32_16x16x32_bf16 v[8:11], v[64:67], v[72:75], v[8:11]
  ds_read_b64_tr_b16 v[44:45], v111 offset:0
  ds_read_b64_tr_b16 v[46:47], v111 offset:2048
  v_mfma_f32_16x16x32_bf16 v[24:27], v[64:67], v[76:79], v[24:27]
  s_add_u32 m0, s68, 0x8000
  s_nop 0
  buffer_load_dwordx4 v96, s[44:47], s64 offen offset:0 lds
  v_mfma_f32_16x16x32_bf16 v[12:15], v[68:71], v[72:75], v[12:15]
  v_mfma_f32_16x16x32_bf16 v[28:31], v[68:71], v[76:79], v[28:31]
  buffer_load_dwordx4 v97, s[44:47], s64 offen offset:1024 lds
  s_add_u32 m0, s68, 0xc000
  s_waitcnt lgkmcnt(7)
  v_mfma_f32_16x16x32_bf16 v[0:3], v[32:35], v[48:51], v[0:3]
  ds_read_b64_tr_b16 v[56:57], v102 offset:8192
  ds_read_b64_tr_b16 v[58:59], v102 offset:10240
  s_waitcnt lgkmcnt(6)
  v_mfma_f32_16x16x32_bf16 v[16:19], v[32:35], v[52:55], v[16:19]
  ds_read_b128 v[72:75], v82 offset:2048
  ds_read_b64_tr_b16 v[60:61], v105 offset:8192
  v_mfma_f32_16x16x32_bf16 v[4:7], v[36:39], v[48:51], v[4:7]
  ds_read_b64_tr_b16 v[62:63], v105 offset:10240
  ds_read_b128 v[76:79], v82 offset:2304
  v_mfma_f32_16x16x32_bf16 v[20:23], v[36:39], v[52:55], v[20:23]
  ds_read_b64_tr_b16 v[64:65], v108 offset:8192
  ds_read_b64_tr_b16 v[66:67], v108 offset:10240
  s_waitcnt lgkmcnt(10)
  v_mfma_f32_16x16x32_bf16 v[8:11], v[40:43], v[48:51], v[8:11]
  ds_read_b64_tr_b16 v[68:69], v111 offset:8192
  ds_read_b64_tr_b16 v[70:71], v111 offset:10240
  v_mfma_f32_16x16x32_bf16 v[24:27], v[40:43], v[52:55], v[24:27]
  buffer_load_dwordx4 v98, s[32:35], s67 offen offset:0 sc1 lds
  s_waitcnt lgkmcnt(10)
  v_mfma_f32_16x16x32_bf16 v[12:15], v[44:47], v[48:51], v[12:15]
  v_mfma_f32_16x16x32_bf16 v[28:31], v[44:47], v[52:55], v[28:31]
  buffer_load_dwordx4 v98, s[32:35], s67 offen offset:1024 sc1 lds
  s_add_u32 s64, s64, 0x10000
  s_add_u32 s67, s67, 4096
  s_waitcnt vmcnt(12) lgkmcnt(0)
  v_mfma_f32_16x16x32_bf16 v[0:3], v[56:59], v[72:75], v[0:3]
  s_barrier
  ds_read_b64_tr_b16 v[32:33], v100 offset:0
  ds_read_b64_tr_b16 v[34:35], v100 offset:2048
  v_mfma_f32_16x16x32_bf16 v[16:19], v[56:59], v[76:79], v[16:19]
  ds_read_b128 v[48:51], v80 offset:0
  ds_read_b64_tr_b16 v[36:37], v103 offset:0
  v_mfma_f32_16x16x32_bf16 v[4:7], v[60:63], v[72:75], v[4:7]
  ds_read_b64_tr_b16 v[38:39], v103 offset:2048
  ds_read_b128 v[52:55], v80 offset:256
  v_mfma_f32_16x16x32_bf16 v[20:23], v[60:63], v[76:79], v[20:23]
  ds_read_b64_tr_b16 v[40:41], v106 offset:0
  ds_read_b64_tr_b16 v[42:43], v106 offset:2048
  v_mfma_f32_16x16x32_bf16 v[8:11], v[64:67], v[72:75], v[8:11]
  ds_read_b64_tr_b16 v[44:45], v109 offset:0
  ds_read_b64_tr_b16 v[46:47], v109 offset:2048
  v_mfma_f32_16x16x32_bf16 v[24:27], v[64:67], v[76:79], v[24:27]
  s_add_u32 m0, s68, 0x20000
  s_nop 0
  buffer_load_dwordx4 v96, s[44:47], s64 offen offset:0 lds
  v_mfma_f32_16x16x32_bf16 v[12:15], v[68:71], v[72:75], v[12:15]
  v_mfma_f32_16x16x32_bf16 v[28:31], v[68:71], v[76:79], v[28:31]
  buffer_load_dwordx4 v97, s[44:47], s64 offen offset:1024 lds
  s_add_u32 m0, s68, 0x24000
  s_waitcnt lgkmcnt(7)
  v_mfma_f32_16x16x32_bf16 v[0:3], v[32:35], v[48:51], v[0:3]
  ds_read_b64_tr_b16 v[56:57], v100 offset:8192
  ds_read_b64_tr_b16 v[58:59], v100 offset:10240
  s_waitcnt lgkmcnt(6)
  v_mfma_f32_16x16x32_bf16 v[16:19], v[32:35], v[52:55], v[16:19]
  ds_read_b128 v[72:75], v80 offset:2048
  ds_read_b64_tr_b16 v[60:61], v103 offset:8192
  v_mfma_f32_16x16x32_bf16 v[4:7], v[36:39], v[48:51], v[4:7]
  ds_read_b64_tr_b16 v[62:63], v103 offset:10240
  ds_read_b128 v[76:79], v80 offset:2304
  v_mfma_f32_16x16x32_bf16 v[20:23], v[36:39], v[52:55], v[20:23]
  ds_read_b64_tr_b16 v[64:65], v106 offset:8192
  ds_read_b64_tr_b16 v[66:67], v106 offset:10240
  s_waitcnt lgkmcnt(10)
  v_mfma_f32_16x16x32_bf16 v[8:11], v[40:43], v[48:51], v[8:11]
  ds_read_b64_tr_b16 v[68:69], v109 offset:8192
  ds_read_b64_tr_b16 v[70:71], v109 offset:10240
  v_mfma_f32_16x16x32_bf16 v[24:27], v[40:43], v[52:55], v[24:27]
  buffer_load_dwordx4 v98, s[32:35], s67 offen offset:0 sc1 lds
  s_waitcnt lgkmcnt(10)
  v_mfma_f32_16x16x32_bf16 v[12:15], v[44:47], v[48:51], v[12:15]
  v_mfma_f32_16x16x32_bf16 v[28:31], v[44:47], v[52:55], v[28:31]
  buffer_load_dwordx4 v98, s[32:35], s67 offen offset:1024 sc1 lds
  s_add_u32 s64, s64, 0x10000
  s_add_u32 s67, s67, 4096
  s_waitcnt vmcnt(12) lgkmcnt(0)
  v_mfma_f32_16x16x32_bf16 v[0:3], v[56:59], v[72:75], v[0:3]
  s_barrier
  ds_read_b64_tr_b16 v[32:33], v101 offset:0
  ds_read_b64_tr_b16 v[34:35], v101 offset:2048
  v_mfma_f32_16x16x32_bf16 v[16:19], v[56:59], v[76:79], v[16:19]
  ds_read_b128 v[48:51], v81 offset:0
  ds_read_b64_tr_b16 v[36:37], v104 offset:0
  v_mfma_f32_16x16x32_bf16 v[4:7], v[60:63], v[72:75], v[4:7]
  ds_read_b64_tr_b16 v[38:39], v104 offset:2048
  ds_read_b128 v[52:55], v81 offset:256
  v_mfma_f32_16x16x32_bf16 v[20:23], v[60:63], v[76:79], v[20:23]
  ds_read_b64_tr_b16 v[40:41], v107 offset:0
  ds_read_b64_tr_b16 v[42:43], v107 offset:2048
  v_mfma_f32_16x16x32_bf16 v[8:11], v[64:67], v[72:75], v[8:11]
  ds_read_b64_tr_b16 v[44:45], v110 offset:0
  ds_read_b64_tr_b16 v[46:47], v110 offset:2048
  v_mfma_f32_16x16x32_bf16 v[24:27], v[64:67], v[76:79], v[24:27]
  s_add_u32 m0, s68, 0x0
  s_nop 0
  buffer_load_dwordx4 v96, s[44:47], s64 offen offset:0 lds
  v_mfma_f32_16x16x32_bf16 v[12:15], v[68:71], v[72:75], v[12:15]
  v_mfma_f32_16x16x32_bf16 v[28:31], v[68:71], v[76:79], v[28:31]
  buffer_load_dwordx4 v97, s[44:47], s64 offen offset:1024 lds
  s_add_u32 m0, s68, 0x4000
  s_waitcnt lgkmcnt(7)
  v_mfma_f32_16x16x32_bf16 v[0:3], v[32:35], v[48:51], v[0:3]
  ds_read_b64_tr_b16 v[56:57], v101 offset:8192
  ds_read_b64_tr_b16 v[58:59], v101 offset:10240
  s_waitcnt lgkmcnt(6)
  v_mfma_f32_16x16x32_bf16 v[16:19], v[32:35], v[52:55], v[16:19]
  ds_read_b128 v[72:75], v81 offset:2048
  ds_read_b64_tr_b16 v[60:61], v104 offset:8192
  v_mfma_f32_16x16x32_bf16 v[4:7], v[36:39], v[48:51], v[4:7]
  ds_read_b64_tr_b16 v[62:63], v104 offset:10240
  ds_read_b128 v[76:79], v81 offset:2304
  v_mfma_f32_16x16x32_bf16 v[20:23], v[36:39], v[52:55], v[20:23]
  ds_read_b64_tr_b16 v[64:65], v107 offset:8192
  ds_read_b64_tr_b16 v[66:67], v107 offset:10240
  s_waitcnt lgkmcnt(10)
  v_mfma_f32_16x16x32_bf16 v[8:11], v[40:43], v[48:51], v[8:11]
  ds_read_b64_tr_b16 v[68:69], v110 offset:8192
  ds_read_b64_tr_b16 v[70:71], v110 offset:10240
  v_mfma_f32_16x16x32_bf16 v[24:27], v[40:43], v[52:55], v[24:27]
  buffer_load_dwordx4 v98, s[32:35], s67 offen offset:0 sc1 lds
  s_waitcnt lgkmcnt(10)
  v_mfma_f32_16x16x32_bf16 v[12:15], v[44:47], v[48:51], v[12:15]
  v_mfma_f32_16x16x32_bf16 v[28:31], v[44:47], v[52:55], v[28:31]
  buffer_load_dwordx4 v98, s[32:35], s67 offen offset:1024 sc1 lds
  s_add_u32 s64, s64, 0x10000
  s_add_u32 s67, s67, 4096
  s_waitcnt vmcnt(12) lgkmcnt(0)
  v_mfma_f32_16x16x32_bf16 v[0:3], v[56:59], v[72:75], v[0:3]
  s_barrier
  ds_read_b64_tr_b16 v[32:33], v101 offset:32768
  ds_read_b64_tr_b16 v[34:35], v101 offset:34816
  v_mfma_f32_16x16x32_bf16 v[16:19], v[56:59], v[76:79], v[16:19]
  ds_read_b128 v[48:51], v81 offset:32768
  ds_read_b64_tr_b16 v[36:37], v104 offset:32768
  v_mfma_f32_16x16x32_bf16 v[4:7], v[60:63], v[72:75], v[4:7]
  ds_read_b64_tr_b16 v[38:39], v104 offset:34816
  ds_read_b128 v[52:55], v81 offset:33024
  v_mfma_f32_16x16x32_bf16 v[20:23], v[60:63], v[76:79], v[20:23]
  ds_read_b64_tr_b16 v[40:41], v107 offset:32768
  ds_read_b64_tr_b16 v[42:43], v107 offset:34816
  v_mfma_f32_16x16x32_bf16 v[8:11], v[64:67], v[72:75], v[8:11]
  ds_read_b64_tr_b16 v[44:45], v110 offset:32768
  ds_read_b64_tr_b16 v[46:47], v110 offset:34816
  v_mfma_f32_16x16x32_bf16 v[24:27], v[64:67], v[76:79], v[24:27]
  s_add_u32 m0, s68, 0x10000
  s_nop 0
  buffer_load_dwordx4 v96, s[44:47], s64 offen offset:0 lds
  v_mfma_f32_16x16x32_bf16 v[12:15], v[68:71], v[72:75], v[12:15]
  v_mfma_f32_16x16x32_bf16 v[28:31], v[68:71], v[76:79], v[28:31]
  buffer_load_dwordx4 v97, s[44:47], s64 offen offset:1024 lds
  s_add_u32 m0, s68, 0x14000
  s_waitcnt lgkmcnt(7)
  v_mfma_f32_16x16x32_bf16 v[0:3], v[32:35], v[48:51], v[0:3]
  ds_read_b64_tr_b16 v[56:57], v101 offset:40960
  ds_read_b64_tr_b16 v[58:59], v101 offset:43008
  s_waitcnt lgkmcnt(6)
  v_mfma_f32_16x16x32_bf16 v[16:19], v[32:35], v[52:55], v[16:19]
  ds_read_b128 v[72:75], v81 offset:34816
  ds_read_b64_tr_b16 v[60:61], v104 offset:40960
  v_mfma_f32_16x16x32_bf16 v[4:7], v[36:39], v[48:51], v[4:7]
  ds_read_b64_tr_b16 v[62:63], v104 offset:43008
  ds_read_b128 v[76:79], v81 offset:35072
  v_mfma_f32_16x16x32_bf16 v[20:23], v[36:39], v[52:55], v[20:23]
  ds_read_b64_tr_b16 v[64:65], v107 offset:40960
  ds_read_b64_tr_b16 v[66:67], v107 offset:43008
  s_waitcnt lgkmcnt(10)
  v_mfma_f32_16x16x32_bf16 v[8:11], v[40:43], v[48:51], v[8:11]
  ds_read_b64_tr_b16 v[68:69], v110 offset:40960
  ds_read_b64_tr_b16 v[70:71], v110 offset:43008
  v_mfma_f32_16x16x32_bf16 v[24:27], v[40:43], v[52:55], v[24:27]
  buffer_load_dwordx4 v98, s[32:35], s67 offen offset:0 sc1 lds
  s_waitcnt lgkmcnt(10)
  v_mfma_f32_16x16x32_bf16 v[12:15], v[44:47], v[48:51], v[12:15]
  v_mfma_f32_16x16x32_bf16 v[28:31], v[44:47], v[52:55], v[28:31]
  buffer_load_dwordx4 v98, s[32:35], s67 offen offset:1024 sc1 lds
  s_add_u32 s64, s64, 0x10000
  s_add_u32 s67, s67, 4096
  s_waitcnt vmcnt(12) lgkmcnt(0)
  v_mfma_f32_16x16x32_bf16 v[0:3], v[56:59], v[72:75], v[0:3]
  s_barrier
  ds_read_b64_tr_b16 v[32:33], v100 offset:32768
  ds_read_b64_tr_b16 v[34:35], v100 offset:34816
  v_mfma_f32_16x16x32_bf16 v[16:19], v[56:59], v[76:79], v[16:19]
  ds_read_b128 v[48:51], v80 offset:32768
  ds_read_b64_tr_b16 v[36:37], v103 offset:32768
  v_mfma_f32_16x16x32_bf16 v[4:7], v[60:63], v[72:75], v[4:7]
  ds_read_b64_tr_b16 v[38:39], v103 offset:34816
  ds_read_b128 v[52:55], v80 offset:33024
  v_mfma_f32_16x16x32_bf16 v[20:23], v[60:63], v[76:79], v[20:23]
  ds_read_b64_tr_b16 v[40:41], v106 offset:32768
  ds_read_b64_tr_b16 v[42:43], v106 offset:34816
  v_mfma_f32_16x16x32_bf16 v[8:11], v[64:67], v[72:75], v[8:11]
  ds_read_b64_tr_b16 v[44:45], v109 offset:32768
  ds_read_b64_tr_b16 v[46:47], v109 offset:34816
  v_mfma_f32_16x16x32_bf16 v[24:27], v[64:67], v[76:79], v[24:27]
  s_add_u32 m0, s68, 0x18000
  s_nop 0
  buffer_load_dwordx4 v96, s[44:47], s64 offen offset:0 lds
  v_mfma_f32_16x16x32_bf16 v[12:15], v[68:71], v[72:75], v[12:15]
  v_mfma_f32_16x16x32_bf16 v[28:31], v[68:71], v[76:79], v[28:31]
  buffer_load_dwordx4 v97, s[44:47], s64 offen offset:1024 lds
  s_add_u32 m0, s68, 0x1c000
  s_waitcnt lgkmcnt(7)
  v_mfma_f32_16x16x32_bf16 v[0:3], v[32:35], v[48:51], v[0:3]
  ds_read_b64_tr_b16 v[56:57], v100 offset:40960
  ds_read_b64_tr_b16 v[58:59], v100 offset:43008
  s_waitcnt lgkmcnt(6)
  v_mfma_f32_16x16x32_bf16 v[16:19], v[32:35], v[52:55], v[16:19]
  ds_read_b128 v[72:75], v80 offset:34816
  ds_read_b64_tr_b16 v[60:61], v103 offset:40960
  v_mfma_f32_16x16x32_bf16 v[4:7], v[36:39], v[48:51], v[4:7]
  ds_read_b64_tr_b16 v[62:63], v103 offset:43008
  ds_read_b128 v[76:79], v80 offset:35072
  v_mfma_f32_16x16x32_bf16 v[20:23], v[36:39], v[52:55], v[20:23]
  ds_read_b64_tr_b16 v[64:65], v106 offset:40960
  ds_read_b64_tr_b16 v[66:67], v106 offset:43008
  s_waitcnt lgkmcnt(10)
  v_mfma_f32_16x16x32_bf16 v[8:11], v[40:43], v[48:51], v[8:11]
  ds_read_b64_tr_b16 v[68:69], v109 offset:40960
  ds_read_b64_tr_b16 v[70:71], v109 offset:43008
  v_mfma_f32_16x16x32_bf16 v[24:27], v[40:43], v[52:55], v[24:27]
  buffer_load_dwordx4 v98, s[32:35], s67 offen offset:0 sc1 lds
  s_waitcnt lgkmcnt(10)
  v_mfma_f32_16x16x32_bf16 v[12:15], v[44:47], v[48:51], v[12:15]
  v_mfma_f32_16x16x32_bf16 v[28:31], v[44:47], v[52:55], v[28:31]
  buffer_load_dwordx4 v98, s[32:35], s67 offen offset:1024 sc1 lds
  s_add_u32 s64, s64, 0x10000
  s_add_u32 s67, s67, 4096
  s_waitcnt vmcnt(12) lgkmcnt(0)
  v_mfma_f32_16x16x32_bf16 v[0:3], v[56:59], v[72:75], v[0:3]
  s_barrier
  ds_read_b64_tr_b16 v[32:33], v102 offset:0
  ds_read_b64_tr_b16 v[34:35], v102 offset:2048
  v_mfma_f32_16x16x32_bf16 v[16:19], v[56:59], v[76:79], v[16:19]
  ds_read_b128 v[48:51], v82 offset:0
  ds_read_b64_tr_b16 v[36:37], v105 offset:0
  v_mfma_f32_16x16x32_bf16 v[4:7], v[60:63], v[72:75], v[4:7]
  ds_read_b64_tr_b16 v[38:39], v105 offset:2048
  ds_read_b128 v[52:55], v82 offset:256
  v_mfma_f32_16x16x32_bf16 v[20:23], v[60:63], v[76:79], v[20:23]
  ds_read_b64_tr_b16 v[40:41], v108 offset:0
  ds_read_b64_tr_b16 v[42:43], v108 offset:2048
  v_mfma_f32_16x16x32_bf16 v[8:11], v[64:67], v[72:75], v[8:11]
  ds_read_b64_tr_b16 v[44:45], v111 offset:0
  ds_read_b64_tr_b16 v[46:47], v111 offset:2048
  v_mfma_f32_16x16x32_bf16 v[24:27], v[64:67], v[76:79], v[24:27]
  s_add_u32 m0, s68, 0x8000
  s_nop 0
  buffer_load_dwordx4 v96, s[44:47], s64 offen offset:0 lds
  v_mfma_f32_16x16x32_bf16 v[12:15], v[68:71], v[72:75], v[12:15]
  v_mfma_f32_16x16x32_bf16 v[28:31], v[68:71], v[76:79], v[28:31]
  buffer_load_dwordx4 v97, s[44:47], s64 offen offset:1024 lds
  s_add_u32 m0, s68, 0xc000
  s_waitcnt lgkmcnt(7)
  v_mfma_f32_16x16x32_bf16 v[0:3], v[32:35], v[48:51], v[0:3]
  ds_read_b64_tr_b16 v[56:57], v102 offset:8192
  ds_read_b64_tr_b16 v[58:59], v102 offset:10240
  s_waitcnt lgkmcnt(6)
  v_mfma_f32_16x16x32_bf16 v[16:19], v[32:35], v[52:55], v[16:19]
  ds_read_b128 v[72:75], v82 offset:2048
  ds_read_b64_tr_b16 v[60:61], v105 offset:8192
  v_mfma_f32_16x16x32_bf16 v[4:7], v[36:39], v[48:51], v[4:7]
  ds_read_b64_tr_b16 v[62:63], v105 offset:10240
  ds_read_b128 v[76:79], v82 offset:2304
  v_mfma_f32_16x16x32_bf16 v[20:23], v[36:39], v[52:55], v[20:23]
  ds_read_b64_tr_b16 v[64:65], v108 offset:8192
  ds_read_b64_tr_b16 v[66:67], v108 offset:10240
  s_waitcnt lgkmcnt(10)
  v_mfma_f32_16x16x32_bf16 v[8:11], v[40:43], v[48:51], v[8:11]
  ds_read_b64_tr_b16 v[68:69], v111 offset:8192
  ds_read_b64_tr_b16 v[70:71], v111 offset:10240
  v_mfma_f32_16x16x32_bf16 v[24:27], v[40:43], v[52:55], v[24:27]
  buffer_load_dwordx4 v98, s[32:35], s67 offen offset:0 sc1 lds
  s_waitcnt lgkmcnt(10)
  v_mfma_f32_16x16x32_bf16 v[12:15], v[44:47], v[48:51], v[12:15]
  v_mfma_f32_16x16x32_bf16 v[28:31], v[44:47], v[52:55], v[28:31]
  buffer_load_dwordx4 v98, s[32:35], s67 offen offset:1024 sc1 lds
  s_add_u32 s64, s64, 0x10000
  s_add_u32 s67, s67, 4096
  s_waitcnt vmcnt(12) lgkmcnt(0)
  v_mfma_f32_16x16x32_bf16 v[0:3], v[56:59], v[72:75], v[0:3]
  s_barrier
  ds_read_b64_tr_b16 v[32:33], v100 offset:0
  ds_read_b64_tr_b16 v[34:35], v100 offset:2048
  v_mfma_f32_16x16x32_bf16 v[16:19], v[56:59], v[76:79], v[16:19]
  ds_read_b128 v[48:51], v80 offset:0
  ds_read_b64_tr_b16 v[36:37], v103 offset:0
  v_mfma_f32_16x16x32_bf16 v[4:7], v[60:63], v[72:75], v[4:7]
  ds_read_b64_tr_b16 v[38:39], v103 offset:2048
  ds_read_b128 v[52:55], v80 offset:256
  v_mfma_f32_16x16x32_bf16 v[20:23], v[60:63], v[76:79], v[20:23]
  ds_read_b64_tr_b16 v[40:41], v106 offset:0
  ds_read_b64_tr_b16 v[42:43], v106 offset:2048
  v_mfma_f32_16x16x32_bf16 v[8:11], v[64:67], v[72:75], v[8:11]
  ds_read_b64_tr_b16 v[44:45], v109 offset:0
  ds_read_b64_tr_b16 v[46:47], v109 offset:2048
  v_mfma_f32_16x16x32_bf16 v[24:27], v[64:67], v[76:79], v[24:27]
  s_add_u32 m0, s68, 0x20000
  s_nop 0
  buffer_load_dwordx4 v96, s[44:47], s64 offen offset:0 lds
  v_mfma_f32_16x16x32_bf16 v[12:15], v[68:71], v[72:75], v[12:15]
  v_mfma_f32_16x16x32_bf16 v[28:31], v[68:71], v[76:79], v[28:31]
  buffer_load_dwordx4 v97, s[44:47], s64 offen offset:1024 lds
  s_add_u32 m0, s68, 0x24000
  s_waitcnt lgkmcnt(7)
  v_mfma_f32_16x16x32_bf16 v[0:3], v[32:35], v[48:51], v[0:3]
  ds_read_b64_tr_b16 v[56:57], v100 offset:8192
  ds_read_b64_tr_b16 v[58:59], v100 offset:10240
  s_waitcnt lgkmcnt(6)
  v_mfma_f32_16x16x32_bf16 v[16:19], v[32:35], v[52:55], v[16:19]
  ds_read_b128 v[72:75], v80 offset:2048
  ds_read_b64_tr_b16 v[60:61], v103 offset:8192
  v_mfma_f32_16x16x32_bf16 v[4:7], v[36:39], v[48:51], v[4:7]
  ds_read_b64_tr_b16 v[62:63], v103 offset:10240
  ds_read_b128 v[76:79], v80 offset:2304
  v_mfma_f32_16x16x32_bf16 v[20:23], v[36:39], v[52:55], v[20:23]
  ds_read_b64_tr_b16 v[64:65], v106 offset:8192
  ds_read_b64_tr_b16 v[66:67], v106 offset:10240
  s_waitcnt lgkmcnt(10)
  v_mfma_f32_16x16x32_bf16 v[8:11], v[40:43], v[48:51], v[8:11]
  ds_read_b64_tr_b16 v[68:69], v109 offset:8192
  ds_read_b64_tr_b16 v[70:71], v109 offset:10240
  v_mfma_f32_16x16x32_bf16 v[24:27], v[40:43], v[52:55], v[24:27]
  buffer_load_dwordx4 v98, s[32:35], s67 offen offset:0 sc1 lds
  s_waitcnt lgkmcnt(10)
  v_mfma_f32_16x16x32_bf16 v[12:15], v[44:47], v[48:51], v[12:15]
  v_mfma_f32_16x16x32_bf16 v[28:31], v[44:47], v[52:55], v[28:31]
  buffer_load_dwordx4 v98, s[32:35], s67 offen offset:1024 sc1 lds
  s_add_u32 s64, s64, 0x10000
  s_add_u32 s67, s67, 4096
  s_waitcnt vmcnt(12) lgkmcnt(0)
  v_mfma_f32_16x16x32_bf16 v[0:3], v[56:59], v[72:75], v[0:3]
  s_barrier
  ds_read_b64_tr_b16 v[32:33], v101 offset:0
  ds_read_b64_tr_b16 v[34:35], v101 offset:2048
  v_mfma_f32_16x16x32_bf16 v[16:19], v[56:59], v[76:79], v[16:19]
  ds_read_b128 v[48:51], v81 offset:0
  ds_read_b64_tr_b16 v[36:37], v104 offset:0
  v_mfma_f32_16x16x32_bf16 v[4:7], v[60:63], v[72:75], v[4:7]
  ds_read_b64_tr_b16 v[38:39], v104 offset:2048
  ds_read_b128 v[52:55], v81 offset:256
  v_mfma_f32_16x16x32_bf16 v[20:23], v[60:63], v[76:79], v[20:23]
  ds_read_b64_tr_b16 v[40:41], v107 offset:0
  ds_read_b64_tr_b16 v[42:43], v107 offset:2048
  v_mfma_f32_16x16x32_bf16 v[8:11], v[64:67], v[72:75], v[8:11]
  ds_read_b64_tr_b16 v[44:45], v110 offset:0
  ds_read_b64_tr_b16 v[46:47], v110 offset:2048
  v_mfma_f32_16x16x32_bf16 v[24:27], v[64:67], v[76:79], v[24:27]
  s_add_u32 m0, s68, 0x0
  s_nop 0
  buffer_load_dwordx4 v96, s[44:47], s64 offen offset:0 lds
  v_mfma_f32_16x16x32_bf16 v[12:15], v[68:71], v[72:75], v[12:15]
  v_mfma_f32_16x16x32_bf16 v[28:31], v[68:71], v[76:79], v[28:31]
  buffer_load_dwordx4 v97, s[44:47], s64 offen offset:1024 lds
  s_add_u32 m0, s68, 0x4000
  s_waitcnt lgkmcnt(7)
  v_mfma_f32_16x16x32_bf16 v[0:3], v[32:35], v[48:51], v[0:3]
  ds_read_b64_tr_b16 v[56:57], v101 offset:8192
  ds_read_b64_tr_b16 v[58:59], v101 offset:10240
  s_waitcnt lgkmcnt(6)
  v_mfma_f32_16x16x32_bf16 v[16:19], v[32:35], v[52:55], v[16:19]
  ds_read_b128 v[72:75], v81 offset:2048
  ds_read_b64_tr_b16 v[60:61], v104 offset:8192
  v_mfma_f32_16x16x32_bf16 v[4:7], v[36:39], v[48:51], v[4:7]
  ds_read_b64_tr_b16 v[62:63], v104 offset:10240
  ds_read_b128 v[76:79], v81 offset:2304
  v_mfma_f32_16x16x32_bf16 v[20:23], v[36:39], v[52:55], v[20:23]
  ds_read_b64_tr_b16 v[64:65], v107 offset:8192
  ds_read_b64_tr_b16 v[66:67], v107 offset:10240
  s_waitcnt lgkmcnt(10)
  v_mfma_f32_16x16x32_bf16 v[8:11], v[40:43], v[48:51], v[8:11]
  ds_read_b64_tr_b16 v[68:69], v110 offset:8192
  ds_read_b64_tr_b16 v[70:71], v110 offset:10240
  v_mfma_f32_16x16x32_bf16 v[24:27], v[40:43], v[52:55], v[24:27]
  buffer_load_dwordx4 v98, s[32:35], s67 offen offset:0 sc1 lds
  s_waitcnt lgkmcnt(10)
  v_mfma_f32_16x16x32_bf16 v[12:15], v[44:47], v[48:51], v[12:15]
  v_mfma_f32_16x16x32_bf16 v[28:31], v[44:47], v[52:55], v[28:31]
  buffer_load_dwordx4 v98, s[32:35], s67 offen offset:1024 sc1 lds
  s_add_u32 s64, s64, 0x10000
  s_add_u32 s67, s67, 4096
  s_waitcnt vmcnt(12) lgkmcnt(0)
  v_mfma_f32_16x16x32_bf16 v[0:3], v[56:59], v[72:75], v[0:3]
  s_barrier
  ds_read_b64_tr_b16 v[32:33], v101 offset:32768
  ds_read_b64_tr_b16 v[34:35], v101 offset:34816
  v_mfma_f32_16x16x32_bf16 v[16:19], v[56:59], v[76:79], v[16:19]
  ds_read_b128 v[48:51], v81 offset:32768
  ds_read_b64_tr_b16 v[36:37], v104 offset:32768
  v_mfma_f32_16x16x32_bf16 v[4:7], v[60:63], v[72:75], v[4:7]
  ds_read_b64_tr_b16 v[38:39], v104 offset:34816
  ds_read_b128 v[52:55], v81 offset:33024
  v_mfma_f32_16x16x32_bf16 v[20:23], v[60:63], v[76:79], v[20:23]
  ds_read_b64_tr_b16 v[40:41], v107 offset:32768
  ds_read_b64_tr_b16 v[42:43], v107 offset:34816
  v_mfma_f32_16x16x32_bf16 v[8:11], v[64:67], v[72:75], v[8:11]
  ds_read_b64_tr_b16 v[44:45], v110 offset:32768
  ds_read_b64_tr_b16 v[46:47], v110 offset:34816
  v_mfma_f32_16x16x32_bf16 v[24:27], v[64:67], v[76:79], v[24:27]
  s_add_u32 m0, s68, 0x10000
  s_nop 0
  buffer_load_dwordx4 v96, s[44:47], s64 offen offset:0 lds
  v_mfma_f32_16x16x32_bf16 v[12:15], v[68:71], v[72:75], v[12:15]
  v_mfma_f32_16x16x32_bf16 v[28:31], v[68:71], v[76:79], v[28:31]
  buffer_load_dwordx4 v97, s[44:47], s64 offen offset:1024 lds
  s_add_u32 m0, s68, 0x14000
  s_waitcnt lgkmcnt(7)
  v_mfma_f32_16x16x32_bf16 v[0:3], v[32:35], v[48:51], v[0:3]
  ds_read_b64_tr_b16 v[56:57], v101 offset:40960
  ds_read_b64_tr_b16 v[58:59], v101 offset:43008
  s_waitcnt lgkmcnt(6)
  v_mfma_f32_16x16x32_bf16 v[16:19], v[32:35], v[52:55], v[16:19]
  ds_read_b128 v[72:75], v81 offset:34816
  ds_read_b64_tr_b16 v[60:61], v104 offset:40960
  v_mfma_f32_16x16x32_bf16 v[4:7], v[36:39], v[48:51], v[4:7]
  ds_read_b64_tr_b16 v[62:63], v104 offset:43008
  ds_read_b128 v[76:79], v81 offset:35072
  v_mfma_f32_16x16x32_bf16 v[20:23], v[36:39], v[52:55], v[20:23]
  ds_read_b64_tr_b16 v[64:65], v107 offset:40960
  ds_read_b64_tr_b16 v[66:67], v107 offset:43008
  s_waitcnt lgkmcnt(10)
  v_mfma_f32_16x16x32_bf16 v[8:11], v[40:43], v[48:51], v[8:11]
  ds_read_b64_tr_b16 v[68:69], v110 offset:40960
  ds_read_b64_tr_b16 v[70:71], v110 offset:43008
  v_mfma_f32_16x16x32_bf16 v[24:27], v[40:43], v[52:55], v[24:27]
  buffer_load_dwordx4 v98, s[32:35], s67 offen offset:0 sc1 lds
  s_waitcnt lgkmcnt(10)
  v_mfma_f32_16x16x32_bf16 v[12:15], v[44:47], v[48:51], v[12:15]
  v_mfma_f32_16x16x32_bf16 v[28:31], v[44:47], v[52:55], v[28:31]
  buffer_load_dwordx4 v98, s[32:35], s67 offen offset:1024 sc1 lds
  s_add_u32 s64, s64, 0x10000
  s_add_u32 s67, s67, 4096
  s_waitcnt vmcnt(12) lgkmcnt(0)
  v_mfma_f32_16x16x32_bf16 v[0:3], v[56:59], v[72:75], v[0:3]
  s_barrier
  ds_read_b64_tr_b16 v[32:33], v100 offset:32768
  ds_read_b64_tr_b16 v[34:35], v100 offset:34816
  v_mfma_f32_16x16x32_bf16 v[16:19], v[56:59], v[76:79], v[16:19]
  ds_read_b128 v[48:51], v80 offset:32768
  ds_read_b64_tr_b16 v[36:37], v103 offset:32768
  v_mfma_f32_16x16x32_bf16 v[4:7], v[60:63], v[72:75], v[4:7]
  ds_read_b64_tr_b16 v[38:39], v103 offset:34816
  ds_read_b128 v[52:55], v80 offset:33024
  v_mfma_f32_16x16x32_bf16 v[20:23], v[60:63], v[76:79], v[20:23]
  ds_read_b64_tr_b16 v[40:41], v106 offset:32768
  ds_read_b64_tr_b16 v[42:43], v106 offset:34816
  v_mfma_f32_16x16x32_bf16 v[8:11], v[64:67], v[72:75], v[8:11]
  ds_read_b64_tr_b16 v[44:45], v109 offset:32768
  ds_read_b64_tr_b16 v[46:47], v109 offset:34816
  v_mfma_f32_16x16x32_bf16 v[24:27], v[64:67], v[76:79], v[24:27]
  s_add_u32 m0, s68, 0x18000
  s_nop 0
  buffer_load_dwordx4 v96, s[44:47], s64 offen offset:0 lds
  v_mfma_f32_16x16x32_bf16 v[12:15], v[68:71], v[72:75], v[12:15]
  v_mfma_f32_16x16x32_bf16 v[28:31], v[68:71], v[76:79], v[28:31]
  buffer_load_dwordx4 v97, s[44:47], s64 offen offset:1024 lds
  s_add_u32 m0, s68, 0x1c000
  s_waitcnt lgkmcnt(7)
  v_mfma_f32_16x16x32_bf16 v[0:3], v[32:35], v[48:51], v[0:3]
  ds_read_b64_tr_b16 v[56:57], v100 offset:40960
  ds_read_b64_tr_b16 v[58:59], v100 offset:43008
  s_waitcnt lgkmcnt(6)
  v_mfma_f32_16x16x32_bf16 v[16:19], v[32:35], v[52:55], v[16:19]
  ds_read_b128 v[72:75], v80 offset:34816
  ds_read_b64_tr_b16 v[60:61], v103 offset:40960
  v_mfma_f32_16x16x32_bf16 v[4:7], v[36:39], v[48:51], v[4:7]
  ds_read_b64_tr_b16 v[62:63], v103 offset:43008
  ds_read_b128 v[76:79], v80 offset:35072
  v_mfma_f32_16x16x32_bf16 v[20:23], v[36:39], v[52:55], v[20:23]
  ds_read_b64_tr_b16 v[64:65], v106 offset:40960
  ds_read_b64_tr_b16 v[66:67], v106 offset:43008
  s_waitcnt lgkmcnt(10)
  v_mfma_f32_16x16x32_bf16 v[8:11], v[40:43], v[48:51], v[8:11]
  ds_read_b64_tr_b16 v[68:69], v109 offset:40960
  ds_read_b64_tr_b16 v[70:71], v109 offset:43008
  v_mfma_f32_16x16x32_bf16 v[24:27], v[40:43], v[52:55], v[24:27]
  buffer_load_dwordx4 v98, s[32:35], s67 offen offset:0 sc1 lds
  s_waitcnt lgkmcnt(10)
  v_mfma_f32_16x16x32_bf16 v[12:15], v[44:47], v[48:51], v[12:15]
  v_mfma_f32_16x16x32_bf16 v[28:31], v[44:47], v[52:55], v[28:31]
  buffer_load_dwordx4 v98, s[32:35], s67 offen offset:1024 sc1 lds
  s_add_u32 s64, s64, 0x10000
  s_add_u32 s67, s67, 4096
  s_waitcnt vmcnt(12) lgkmcnt(0)
  v_mfma_f32_16x16x32_bf16 v[0:3], v[56:59], v[72:75], v[0:3]
  s_barrier
  ds_read_b64_tr_b16 v[32:33], v102 offset:0
  ds_read_b64_tr_b16 v[34:35], v102 offset:2048
  v_mfma_f32_16x16x32_bf16 v[16:19], v[56:59], v[76:79], v[16:19]
  ds_read_b128 v[48:51], v82 offset:0
  ds_read_b64_tr_b16 v[36:37], v105 offset:0
  v_mfma_f32_16x16x32_bf16 v[4:7], v[60:63], v[72:75], v[4:7]
  ds_read_b64_tr_b16 v[38:39], v105 offset:2048
  ds_read_b128 v[52:55], v82 offset:256
  v_mfma_f32_16x16x32_bf16 v[20:23], v[60:63], v[76:79], v[20:23]
  ds_read_b64_tr_b16 v[40:41], v108 offset:0
  ds_read_b64_tr_b16 v[42:43], v108 offset:2048
  v_mfma_f32_16x16x32_bf16 v[8:11], v[64:67], v[72:75], v[8:11]
  ds_read_b64_tr_b16 v[44:45], v111 offset:0
  ds_read_b64_tr_b16 v[46:47], v111 offset:2048
  v_mfma_f32_16x16x32_bf16 v[24:27], v[64:67], v[76:79], v[24:27]
  s_add_u32 m0, s68, 0x8000
  s_nop 0
  buffer_load_dwordx4 v96, s[44:47], s64 offen offset:0 lds
  v_mfma_f32_16x16x32_bf16 v[12:15], v[68:71], v[72:75], v[12:15]
  v_mfma_f32_16x16x32_bf16 v[28:31], v[68:71], v[76:79], v[28:31]
  buffer_load_dwordx4 v97, s[44:47], s64 offen offset:1024 lds
  s_add_u32 m0, s68, 0xc000
  s_waitcnt lgkmcnt(7)
  v_mfma_f32_16x16x32_bf16 v[0:3], v[32:35], v[48:51], v[0:3]
  ds_read_b64_tr_b16 v[56:57], v102 offset:8192
  ds_read_b64_tr_b16 v[58:59], v102 offset:10240
  s_waitcnt lgkmcnt(6)
  v_mfma_f32_16x16x32_bf16 v[16:19], v[32:35], v[52:55], v[16:19]
  ds_read_b128 v[72:75], v82 offset:2048
  ds_read_b64_tr_b16 v[60:61], v105 offset:8192
  v_mfma_f32_16x16x32_bf16 v[4:7], v[36:39], v[48:51], v[4:7]
  ds_read_b64_tr_b16 v[62:63], v105 offset:10240
  ds_read_b128 v[76:79], v82 offset:2304
  v_mfma_f32_16x16x32_bf16 v[20:23], v[36:39], v[52:55], v[20:23]
  ds_read_b64_tr_b16 v[64:65], v108 offset:8192
  ds_read_b64_tr_b16 v[66:67], v108 offset:10240
  s_waitcnt lgkmcnt(10)
  v_mfma_f32_16x16x32_bf16 v[8:11], v[40:43], v[48:51], v[8:11]
  ds_read_b64_tr_b16 v[68:69], v111 offset:8192
  ds_read_b64_tr_b16 v[70:71], v111 offset:10240
  v_mfma_f32_16x16x32_bf16 v[24:27], v[40:43], v[52:55], v[24:27]
  buffer_load_dwordx4 v98, s[32:35], s67 offen offset:0 sc1 lds
  s_waitcnt lgkmcnt(10)
  v_mfma_f32_16x16x32_bf16 v[12:15], v[44:47], v[48:51], v[12:15]
  v_mfma_f32_16x16x32_bf16 v[28:31], v[44:47], v[52:55], v[28:31]
  buffer_load_dwordx4 v98, s[32:35], s67 offen offset:1024 sc1 lds
  s_add_u32 s64, s64, 0x10000
  s_add_u32 s67, s67, 4096
  s_waitcnt vmcnt(12) lgkmcnt(0)
  v_mfma_f32_16x16x32_bf16 v[0:3], v[56:59], v[72:75], v[0:3]
  s_barrier
  ds_read_b64_tr_b16 v[32:33], v100 offset:0
  ds_read_b64_tr_b16 v[34:35], v100 offset:2048
  v_mfma_f32_16x16x32_bf16 v[16:19], v[56:59], v[76:79], v[16:19]
  ds_read_b128 v[48:51], v80 offset:0
  ds_read_b64_tr_b16 v[36:37], v103 offset:0
  v_mfma_f32_16x16x32_bf16 v[4:7], v[60:63], v[72:75], v[4:7]
  ds_read_b64_tr_b16 v[38:39], v103 offset:2048
  ds_read_b128 v[52:55], v80 offset:256
  v_mfma_f32_16x16x32_bf16 v[20:23], v[60:63], v[76:79], v[20:23]
  ds_read_b64_tr_b16 v[40:41], v106 offset:0
  ds_read_b64_tr_b16 v[42:43], v106 offset:2048
  v_mfma_f32_16x16x32_bf16 v[8:11], v[64:67], v[72:75], v[8:11]
  ds_read_b64_tr_b16 v[44:45], v109 offset:0
  ds_read_b64_tr_b16 v[46:47], v109 offset:2048
  v_mfma_f32_16x16x32_bf16 v[24:27], v[64:67], v[76:79], v[24:27]
  s_add_u32 m0, s68, 0x20000
  s_nop 0
  buffer_load_dwordx4 v96, s[44:47], s64 offen offset:0 lds
  v_mfma_f32_16x16x32_bf16 v[12:15], v[68:71], v[72:75], v[12:15]
  v_mfma_f32_16x16x32_bf16 v[28:31], v[68:71], v[76:79], v[28:31]
  buffer_load_dwordx4 v97, s[44:47], s64 offen offset:1024 lds
  s_add_u32 m0, s68, 0x24000
  s_waitcnt lgkmcnt(7)
  v_mfma_f32_16x16x32_bf16 v[0:3], v[32:35], v[48:51], v[0:3]
  ds_read_b64_tr_b16 v[56:57], v100 offset:8192
  ds_read_b64_tr_b16 v[58:59], v100 offset:10240
  s_waitcnt lgkmcnt(6)
  v_mfma_f32_16x16x32_bf16 v[16:19], v[32:35], v[52:55], v[16:19]
  ds_read_b128 v[72:75], v80 offset:2048
  ds_read_b64_tr_b16 v[60:61], v103 offset:8192
  v_mfma_f32_16x16x32_bf16 v[4:7], v[36:39], v[48:51], v[4:7]
  ds_read_b64_tr_b16 v[62:63], v103 offset:10240
  ds_read_b128 v[76:79], v80 offset:2304
  v_mfma_f32_16x16x32_bf16 v[20:23], v[36:39], v[52:55], v[20:23]
  ds_read_b64_tr_b16 v[64:65], v106 offset:8192
  ds_read_b64_tr_b16 v[66:67], v106 offset:10240
  s_waitcnt lgkmcnt(10)
  v_mfma_f32_16x16x32_bf16 v[8:11], v[40:43], v[48:51], v[8:11]
  ds_read_b64_tr_b16 v[68:69], v109 offset:8192
  ds_read_b64_tr_b16 v[70:71], v109 offset:10240
  v_mfma_f32_16x16x32_bf16 v[24:27], v[40:43], v[52:55], v[24:27]
  buffer_load_dwordx4 v98, s[32:35], s67 offen offset:0 sc1 lds
  s_waitcnt lgkmcnt(10)
  v_mfma_f32_16x16x32_bf16 v[12:15], v[44:47], v[48:51], v[12:15]
  v_mfma_f32_16x16x32_bf16 v[28:31], v[44:47], v[52:55], v[28:31]
  buffer_load_dwordx4 v98, s[32:35], s67 offen offset:1024 sc1 lds
  s_add_u32 s64, s64, 0x10000
  s_add_u32 s67, s67, 4096
  s_waitcnt vmcnt(12) lgkmcnt(0)
  v_mfma_f32_16x16x32_bf16 v[0:3], v[56:59], v[72:75], v[0:3]
  s_barrier
  ds_read_b64_tr_b16 v[32:33], v101 offset:0
  ds_read_b64_tr_b16 v[34:35], v101 offset:2048
  v_mfma_f32_16x16x32_bf16 v[16:19], v[56:59], v[76:79], v[16:19]
  ds_read_b128 v[48:51], v81 offset:0
  ds_read_b64_tr_b16 v[36:37], v104 offset:0
  v_mfma_f32_16x16x32_bf16 v[4:7], v[60:63], v[72:75], v[4:7]
  ds_read_b64_tr_b16 v[38:39], v104 offset:2048
  ds_read_b128 v[52:55], v81 offset:256
  v_mfma_f32_16x16x32_bf16 v[20:23], v[60:63], v[76:79], v[20:23]
  ds_read_b64_tr_b16 v[40:41], v107 offset:0
  ds_read_b64_tr_b16 v[42:43], v107 offset:2048
  v_mfma_f32_16x16x32_bf16 v[8:11], v[64:67], v[72:75], v[8:11]
  ds_read_b64_tr_b16 v[44:45], v110 offset:0
  ds_read_b64_tr_b16 v[46:47], v110 offset:2048
  v_mfma_f32_16x16x32_bf16 v[24:27], v[64:67], v[76:79], v[24:27]
  v_mfma_f32_16x16x32_bf16 v[12:15], v[68:71], v[72:75], v[12:15]
  v_mfma_f32_16x16x32_bf16 v[28:31], v[68:71], v[76:79], v[28:31]
  s_waitcnt lgkmcnt(7)
  v_mfma_f32_16x16x32_bf16 v[0:3], v[32:35], v[48:51], v[0:3]
  ds_read_b64_tr_b16 v[56:57], v101 offset:8192
  ds_read_b64_tr_b16 v[58:59], v101 offset:10240
  s_waitcnt lgkmcnt(6)
  v_mfma_f32_16x16x32_bf16 v[16:19], v[32:35], v[52:55], v[16:19]
  ds_read_b128 v[72:75], v81 offset:2048
  ds_read_b64_tr_b16 v[60:61], v104 offset:8192
  v_mfma_f32_16x16x32_bf16 v[4:7], v[36:39], v[48:51], v[4:7]
  ds_read_b64_tr_b16 v[62:63], v104 offset:10240
  ds_read_b128 v[76:79], v81 offset:2304
  v_mfma_f32_16x16x32_bf16 v[20:23], v[36:39], v[52:55], v[20:23]
  ds_read_b64_tr_b16 v[64:65], v107 offset:8192
  ds_read_b64_tr_b16 v[66:67], v107 offset:10240
  s_waitcnt lgkmcnt(10)
  v_mfma_f32_16x16x32_bf16 v[8:11], v[40:43], v[48:51], v[8:11]
  ds_read_b64_tr_b16 v[68:69], v110 offset:8192
  ds_read_b64_tr_b16 v[70:71], v110 offset:10240
  v_mfma_f32_16x16x32_bf16 v[24:27], v[40:43], v[52:55], v[24:27]
  s_waitcnt lgkmcnt(10)
  v_mfma_f32_16x16x32_bf16 v[12:15], v[44:47], v[48:51], v[12:15]
  v_mfma_f32_16x16x32_bf16 v[28:31], v[44:47], v[52:55], v[28:31]
  s_waitcnt vmcnt(8) lgkmcnt(0)
  v_mfma_f32_16x16x32_bf16 v[0:3], v[56:59], v[72:75], v[0:3]
  s_barrier
  ds_read_b64_tr_b16 v[32:33], v101 offset:32768
  ds_read_b64_tr_b16 v[34:35], v101 offset:34816
  v_mfma_f32_16x16x32_bf16 v[16:19], v[56:59], v[76:79], v[16:19]
  ds_read_b128 v[48:51], v81 offset:32768
  ds_read_b64_tr_b16 v[36:37], v104 offset:32768
  v_mfma_f32_16x16x32_bf16 v[4:7], v[60:63], v[72:75], v[4:7]
  ds_read_b64_tr_b16 v[38:39], v104 offset:34816
  ds_read_b128 v[52:55], v81 offset:33024
  v_mfma_f32_16x16x32_bf16 v[20:23], v[60:63], v[76:79], v[20:23]
  ds_read_b64_tr_b16 v[40:41], v107 offset:32768
  ds_read_b64_tr_b16 v[42:43], v107 offset:34816
  v_mfma_f32_16x16x32_bf16 v[8:11], v[64:67], v[72:75], v[8:11]
  ds_read_b64_tr_b16 v[44:45], v110 offset:32768
  ds_read_b64_tr_b16 v[46:47], v110 offset:34816
  v_mfma_f32_16x16x32_bf16 v[24:27], v[64:67], v[76:79], v[24:27]
  v_mfma_f32_16x16x32_bf16 v[12:15], v[68:71], v[72:75], v[12:15]
  v_mfma_f32_16x16x32_bf16 v[28:31], v[68:71], v[76:79], v[28:31]
  s_waitcnt lgkmcnt(7)
  v_mfma_f32_16x16x32_bf16 v[0:3], v[32:35], v[48:51], v[0:3]
  ds_read_b64_tr_b16 v[56:57], v101 offset:40960
  ds_read_b64_tr_b16 v[58:59], v101 offset:43008
  s_waitcnt lgkmcnt(6)
  v_mfma_f32_16x16x32_bf16 v[16:19], v[32:35], v[52:55], v[16:19]
  ds_read_b128 v[72:75], v81 offset:34816
  ds_read_b64_tr_b16 v[60:61], v104 offset:40960
  v_mfma_f32_16x16x32_bf16 v[4:7], v[36:39], v[48:51], v[4:7]
  ds_read_b64_tr_b16 v[62:63], v104 offset:43008
  ds_read_b128 v[76:79], v81 offset:35072
  v_mfma_f32_16x16x32_bf16 v[20:23], v[36:39], v[52:55], v[20:23]
  ds_read_b64_tr_b16 v[64:65], v107 offset:40960
  ds_read_b64_tr_b16 v[66:67], v107 offset:43008
  s_waitcnt lgkmcnt(10)
  v_mfma_f32_16x16x32_bf16 v[8:11], v[40:43], v[48:51], v[8:11]
  ds_read_b64_tr_b16 v[68:69], v110 offset:40960
  ds_read_b64_tr_b16 v[70:71], v110 offset:43008
  v_mfma_f32_16x16x32_bf16 v[24:27], v[40:43], v[52:55], v[24:27]
  s_waitcnt lgkmcnt(10)
  v_mfma_f32_16x16x32_bf16 v[12:15], v[44:47], v[48:51], v[12:15]
  v_mfma_f32_16x16x32_bf16 v[28:31], v[44:47], v[52:55], v[28:31]
  s_waitcnt vmcnt(4) lgkmcnt(0)
  v_mfma_f32_16x16x32_bf16 v[0:3], v[56:59], v[72:75], v[0:3]
  s_barrier
  ds_read_b64_tr_b16 v[32:33], v100 offset:32768
  ds_read_b64_tr_b16 v[34:35], v100 offset:34816
  v_mfma_f32_16x16x32_bf16 v[16:19], v[56:59], v[76:79], v[16:19]
  ds_read_b128 v[48:51], v80 offset:32768
  ds_read_b64_tr_b16 v[36:37], v103 offset:32768
  v_mfma_f32_16x16x32_bf16 v[4:7], v[60:63], v[72:75], v[4:7]
  ds_read_b64_tr_b16 v[38:39], v103 offset:34816
  ds_read_b128 v[52:55], v80 offset:33024
  v_mfma_f32_16x16x32_bf16 v[20:23], v[60:63], v[76:79], v[20:23]
  ds_read_b64_tr_b16 v[40:41], v106 offset:32768
  ds_read_b64_tr_b16 v[42:43], v106 offset:34816
  v_mfma_f32_16x16x32_bf16 v[8:11], v[64:67], v[72:75], v[8:11]
  ds_read_b64_tr_b16 v[44:45], v109 offset:32768
  ds_read_b64_tr_b16 v[46:47], v109 offset:34816
  v_mfma_f32_16x16x32_bf16 v[24:27], v[64:67], v[76:79], v[24:27]
  v_mfma_f32_16x16x32_bf16 v[12:15], v[68:71], v[72:75], v[12:15]
  v_mfma_f32_16x16x32_bf16 v[28:31], v[68:71], v[76:79], v[28:31]
  s_waitcnt lgkmcnt(7)
  v_mfma_f32_16x16x32_bf16 v[0:3], v[32:35], v[48:51], v[0:3]
  ds_read_b64_tr_b16 v[56:57], v100 offset:40960
  ds_read_b64_tr_b16 v[58:59], v100 offset:43008
  s_waitcnt lgkmcnt(6)
  v_mfma_f32_16x16x32_bf16 v[16:19], v[32:35], v[52:55], v[16:19]
  ds_read_b128 v[72:75], v80 offset:34816
  ds_read_b64_tr_b16 v[60:61], v103 offset:40960
  v_mfma_f32_16x16x32_bf16 v[4:7], v[36:39], v[48:51], v[4:7]
  ds_read_b64_tr_b16 v[62:63], v103 offset:43008
  ds_read_b128 v[76:79], v80 offset:35072
  v_mfma_f32_16x16x32_bf16 v[20:23], v[36:39], v[52:55], v[20:23]
  ds_read_b64_tr_b16 v[64:65], v106 offset:40960
  ds_read_b64_tr_b16 v[66:67], v106 offset:43008
  s_waitcnt lgkmcnt(10)
  v_mfma_f32_16x16x32_bf16 v[8:11], v[40:43], v[48:51], v[8:11]
  ds_read_b64_tr_b16 v[68:69], v109 offset:40960
  ds_read_b64_tr_b16 v[70:71], v109 offset:43008
  v_mfma_f32_16x16x32_bf16 v[24:27], v[40:43], v[52:55], v[24:27]
  s_waitcnt lgkmcnt(10)
  v_mfma_f32_16x16x32_bf16 v[12:15], v[44:47], v[48:51], v[12:15]
  v_mfma_f32_16x16x32_bf16 v[28:31], v[44:47], v[52:55], v[28:31]
  s_waitcnt vmcnt(0) lgkmcnt(0)
  v_mfma_f32_16x16x32_bf16 v[0:3], v[56:59], v[72:75], v[0:3]
  s_barrier
  ds_read_b64_tr_b16 v[32:33], v102 offset:0
  ds_read_b64_tr_b16 v[34:35], v102 offset:2048
  v_mfma_f32_16x16x32_bf16 v[16:19], v[56:59], v[76:79], v[16:19]
  ds_read_b128 v[48:51], v82 offset:0
  ds_read_b64_tr_b16 v[36:37], v105 offset:0
  v_mfma_f32_16x16x32_bf16 v[4:7], v[60:63], v[72:75], v[4:7]
  ds_read_b64_tr_b16 v[38:39], v105 offset:2048
  ds_read_b128 v[52:55], v82 offset:256
  v_mfma_f32_16x16x32_bf16 v[20:23], v[60:63], v[76:79], v[20:23]
  ds_read_b64_tr_b16 v[40:41], v108 offset:0
  ds_read_b64_tr_b16 v[42:43], v108 offset:2048
  v_mfma_f32_16x16x32_bf16 v[8:11], v[64:67], v[72:75], v[8:11]
  ds_read_b64_tr_b16 v[44:45], v111 offset:0
  ds_read_b64_tr_b16 v[46:47], v111 offset:2048
  v_mfma_f32_16x16x32_bf16 v[24:27], v[64:67], v[76:79], v[24:27]
  v_mfma_f32_16x16x32_bf16 v[12:15], v[68:71], v[72:75], v[12:15]
  v_mfma_f32_16x16x32_bf16 v[28:31], v[68:71], v[76:79], v[28:31]
  s_waitcnt lgkmcnt(7)
  v_mfma_f32_16x16x32_bf16 v[0:3], v[32:35], v[48:51], v[0:3]
  ds_read_b64_tr_b16 v[56:57], v102 offset:8192
  ds_read_b64_tr_b16 v[58:59], v102 offset:10240
  s_waitcnt lgkmcnt(6)
  v_mfma_f32_16x16x32_bf16 v[16:19], v[32:35], v[52:55], v[16:19]
  ds_read_b128 v[72:75], v82 offset:2048
  ds_read_b64_tr_b16 v[60:61], v105 offset:8192
  v_mfma_f32_16x16x32_bf16 v[4:7], v[36:39], v[48:51], v[4:7]
  ds_read_b64_tr_b16 v[62:63], v105 offset:10240
  ds_read_b128 v[76:79], v82 offset:2304
  v_mfma_f32_16x16x32_bf16 v[20:23], v[36:39], v[52:55], v[20:23]
  ds_read_b64_tr_b16 v[64:65], v108 offset:8192
  ds_read_b64_tr_b16 v[66:67], v108 offset:10240
  s_waitcnt lgkmcnt(10)
  v_mfma_f32_16x16x32_bf16 v[8:11], v[40:43], v[48:51], v[8:11]
  ds_read_b64_tr_b16 v[68:69], v111 offset:8192
  ds_read_b64_tr_b16 v[70:71], v111 offset:10240
  v_mfma_f32_16x16x32_bf16 v[24:27], v[40:43], v[52:55], v[24:27]
  s_waitcnt lgkmcnt(10)
  v_mfma_f32_16x16x32_bf16 v[12:15], v[44:47], v[48:51], v[12:15]
  s_mov_b32 s42, 0x5a00000
  s_lshl_b32 s58, s70, 18
  s_add_u32 s58, s58, 0x4a00000
  s_and_b32 s63, s3, 1
  s_lshl_b32 s63, s63, 1
  s_add_u32 s63, s63, s57
  s_lshl_b32 s59, s63, 16
  s_add_u32 s59, s59, s58
  s_lshl_b32 s60, s69, 14
  s_add_u32 s59, s59, s60
  s_bfe_u32 s60, s3, 0x10001
  s_lshl_b32 s60, s60, 13
  s_add_u32 s59, s59, s60
  s_add_u32 s61, s59, 4096
  s_lshl_b32 s62, s69, 16
  s_add_u32 s58, s58, s62
  s_add_u32 s58, s58, s68
  v_add_u32 v90, s60, v254
  v_mfma_f32_16x16x32_bf16 v[28:31], v[44:47], v[52:55], v[28:31]
  s_waitcnt lgkmcnt(0)
  v_mfma_f32_16x16x32_bf16 v[0:3], v[56:59], v[72:75], v[0:3]
  s_barrier
  v_mfma_f32_16x16x32_bf16 v[16:19], v[56:59], v[76:79], v[16:19]
  v_mfma_f32_16x16x32_bf16 v[4:7], v[60:63], v[72:75], v[4:7]
  v_mfma_f32_16x16x32_bf16 v[20:23], v[60:63], v[76:79], v[20:23]
  v_mfma_f32_16x16x32_bf16 v[8:11], v[64:67], v[72:75], v[8:11]
  v_mfma_f32_16x16x32_bf16 v[24:27], v[64:67], v[76:79], v[24:27]
  v_mfma_f32_16x16x32_bf16 v[12:15], v[68:71], v[72:75], v[12:15]
  v_mfma_f32_16x16x32_bf16 v[28:31], v[68:71], v[76:79], v[28:31]
  s_branch .Lo_done
.Lo_odd:
  s_lshl_b32 s67, s69, 16
  s_mov_b32 s64, 0
  s_waitcnt lgkmcnt(7)
  v_mfma_f32_16x16x32_bf16 v[0:3], v[32:35], v[48:51], 0
  ds_read_b64_tr_b16 v[56:57], v102 offset:8192
  ds_read_b64_tr_b16 v[58:59], v102 offset:10240
  s_waitcnt lgkmcnt(6)
  v_mfma_f32_16x16x32_bf16 v[16:19], v[32:35], v[52:55], 0
  ds_read_b128 v[72:75], v82 offset:2048
  ds_read_b64_tr_b16 v[60:61], v105 offset:8192
  v_mfma_f32_16x16x32_bf16 v[4:7], v[36:39], v[48:51], 0
  ds_read_b64_tr_b16 v[62:63], v105 offset:10240
  ds_read_b128 v[76:79], v82 offset:2304
  v_mfma_f32_16x16x32_bf16 v[20:23], v[36:39], v[52:55], 0
  ds_read_b64_tr_b16 v[64:65], v108 offset:8192
  ds_read_b64_tr_b16 v[66:67], v108 offset:10240
  s_waitcnt lgkmcnt(10)
  v_mfma_f32_16x16x32_bf16 v[8:11], v[40:43], v[48:51], 0
  ds_read_b64_tr_b16 v[68:69], v111 offset:8192
  ds_read_b64_tr_b16 v[70:71], v111 offset:10240
  v_mfma_f32_16x16x32_bf16 v[24:27], v[40:43], v[52:55], 0
  s_waitcnt lgkmcnt(10)
  v_mfma_f32_16x16x32_bf16 v[12:15], v[44:47], v[48:51], 0
  v_mfma_f32_16x16x32_bf16 v[28:31], v[44:47], v[52:55], 0
  s_waitcnt vmcnt(2) lgkmcnt(0)
  v_mfma_f32_16x16x32_bf16 v[0:3], v[56:59], v[72:75], v[0:3]
  s_barrier
  ds_read_b64_tr_b16 v[32:33], v100 offset:0
  ds_read_b64_tr_b16 v[34:35], v100 offset:2048
  v_mfma_f32_16x16x32_bf16 v[16:19], v[56:59], v[76:79], v[16:19]
  ds_read_b128 v[48:51], v80 offset:0
  ds_read_b64_tr_b16 v[36:37], v103 offset:0
  v_mfma_f32_16x16x32_bf16 v[4:7], v[60:63], v[72:75], v[4:7]
  ds_read_b64_tr_b16 v[38:39], v103 offset:2048
  ds_read_b128 v[52:55], v80 offset:256
  v_mfma_f32_16x16x32_bf16 v[20:23], v[60:63], v[76:79], v[20:23]
  ds_read_b64_tr_b16 v[40:41], v106 offset:0
  ds_read_b64_tr_b16 v[42:43], v106 offset:2048
  v_mfma_f32_16x16x32_bf16 v[8:11], v[64:67], v[72:75], v[8:11]
  ds_read_b64_tr_b16 v[44:45], v109 offset:0
  ds_read_b64_tr_b16 v[46:47], v109 offset:2048
  v_mfma_f32_16x16x32_bf16 v[24:27], v[64:67], v[76:79], v[24:27]
  v_mfma_f32_16x16x32_bf16 v[12:15], v[68:71], v[72:75], v[12:15]
  v_mfma_f32_16x16x32_bf16 v[28:31], v[68:71], v[76:79], v[28:31]
  s_waitcnt lgkmcnt(7)
  v_mfma_f32_16x16x32_bf16 v[0:3], v[32:35], v[48:51], v[0:3]
  ds_read_b64_tr_b16 v[56:57], v100 offset:8192
  ds_read_b64_tr_b16 v[58:59], v100 offset:10240
  s_waitcnt lgkmcnt(6)
  v_mfma_f32_16x16x32_bf16 v[16:19], v[32:35], v[52:55], v[16:19]
  ds_read_b128 v[72:75], v80 offset:2048
  ds_read_b64_tr_b16 v[60:61], v103 offset:8192
  v_mfma_f32_16x16x32_bf16 v[4:7], v[36:39], v[48:51], v[4:7]
  ds_read_b64_tr_b16 v[62:63], v103 offset:10240
  ds_read_b128 v[76:79], v80 offset:2304
  v_mfma_f32_16x16x32_bf16 v[20:23], v[36:39], v[52:55], v[20:23]
  ds_read_b64_tr_b16 v[64:65], v106 offset:8192
  ds_read_b64_tr_b16 v[66:67], v106 offset:10240
  s_waitcnt lgkmcnt(10)
  v_mfma_f32_16x16x32_bf16 v[8:11], v[40:43], v[48:51], v[8:11]
  ds_read_b64_tr_b16 v[68:69], v109 offset:8192
  ds_read_b64_tr_b16 v[70:71], v109 offset:10240
  v_mfma_f32_16x16x32_bf16 v[24:27], v[40:43], v[52:55], v[24:27]
  s_waitcnt lgkmcnt(10)
  v_mfma_f32_16x16x32_bf16 v[12:15], v[44:47], v[48:51], v[12:15]
  v_mfma_f32_16x16x32_bf16 v[28:31], v[44:47], v[52:55], v[28:31]
  s_waitcnt vmcnt(2) lgkmcnt(0)
  s_cmp_lg_u32 s3, 0
  s_cbranch_scc1 .Lok_ctx4
  v_readfirstlane_b32 s86, v250
  s_nop 0
  s_cmp_lt_u32 s86, 8
  s_cbranch_scc1 .Lspin_ctx4
.Lok_ctx4:
  v_mfma_f32_16x16x32_bf16 v[0:3], v[56:59], v[72:75], v[0:3]
  s_barrier
  ds_read_b64_tr_b16 v[32:33], v101 offset:0
  ds_read_b64_tr_b16 v[34:35], v101 offset:2048
  v_mfma_f32_16x16x32_bf16 v[16:19], v[56:59], v[76:79], v[16:19]
  ds_read_b128 v[48:51], v81 offset:0
  ds_read_b64_tr_b16 v[36:37], v104 offset:0
  v_mfma_f32_16x16x32_bf16 v[4:7], v[60:63], v[72:75], v[4:7]
  ds_read_b64_tr_b16 v[38:39], v104 offset:2048
  ds_read_b128 v[52:55], v81 offset:256
  s_add_u32 m0, s68, 0x8000
  s_nop 0
  buffer_load_dwordx4 v96, s[44:47], s64 offen offset:0 lds
  buffer_load_dwordx4 v97, s[44:47], s64 offen offset:1024 lds
  s_add_u32 m0, s68, 0xc000
  v_mfma_f32_16x16x32_bf16 v[20:23], v[60:63], v[76:79], v[20:23]
  ds_read_b64_tr_b16 v[40:41], v107 offset:0
  ds_read_b64_tr_b16 v[42:43], v107 offset:2048
  buffer_load_dwordx4 v98, s[32:35], s67 offen offset:0 sc1 lds
  buffer_load_dwordx4 v98, s[32:35], s67 offen offset:1024 sc1 lds
  s_add_u32 s64, s64, 0x10000
  v_mfma_f32_16x16x32_bf16 v[8:11], v[64:67], v[72:75], v[8:11]
  ds_read_b64_tr_b16 v[44:45], v110 offset:0
  ds_read_b64_tr_b16 v[46:47], v110 offset:2048
  s_add_u32 s67, s67, 4096
  s_add_u32 m0, s68, 0x20000
  s_nop 0
  buffer_load_dwordx4 v96, s[44:47], s64 offen offset:0 lds
  v_mfma_f32_16x16x32_bf16 v[24:27], v[64:67], v[76:79], v[24:27]
  buffer_load_dwordx4 v97, s[44:47], s64 offen offset:1024 lds
  s_add_u32 m0, s68, 0x24000
  s_nop 0
  buffer_load_dwordx4 v98, s[32:35], s67 offen offset:0 sc1 lds
  buffer_load_dwordx4 v98, s[32:35], s67 offen offset:1024 sc1 lds
  v_mfma_f32_16x16x32_bf16 v[12:15], v[68:71], v[72:75], v[12:15]
  s_add_u32 s64, s64, 0x10000
  s_add_u32 s67, s67, 4096
  s_add_u32 m0, s68, 0x0
  v_mfma_f32_16x16x32_bf16 v[28:31], v[68:71], v[76:79], v[28:31]
  buffer_load_dwordx4 v96, s[44:47], s64 offen offset:0 lds
  buffer_load_dwordx4 v97, s[44:47], s64 offen offset:1024 lds
  s_add_u32 m0, s68, 0x4000
  s_waitcnt lgkmcnt(7)
  v_mfma_f32_16x16x32_bf16 v[0:3], v[32:35], v[48:51], v[0:3]
  ds_read_b64_tr_b16 v[56:57], v101 offset:8192
  ds_read_b64_tr_b16 v[58:59], v101 offset:10240
  s_waitcnt lgkmcnt(6)
  v_mfma_f32_16x16x32_bf16 v[16:19], v[32:35], v[52:55], v[16:19]
  ds_read_b128 v[72:75], v81 offset:2048
  ds_read_b64_tr_b16 v[60:61], v104 offset:8192
  v_mfma_f32_16x16x32_bf16 v[4:7], v[36:39], v[48:51], v[4:7]
  ds_read_b64_tr_b16 v[62:63], v104 offset:10240
  ds_read_b128 v[76:79], v81 offset:2304
  v_mfma_f32_16x16x32_bf16 v[20:23], v[36:39], v[52:55], v[20:23]
  ds_read_b64_tr_b16 v[64:65], v107 offset:8192
  ds_read_b64_tr_b16 v[66:67], v107 offset:10240
  s_waitcnt lgkmcnt(10)
  v_mfma_f32_16x16x32_bf16 v[8:11], v[40:43], v[48:51], v[8:11]
  ds_read_b64_tr_b16 v[68:69], v110 offset:8192
  ds_read_b64_tr_b16 v[70:71], v110 offset:10240
  v_mfma_f32_16x16x32_bf16 v[24:27], v[40:43], v[52:55], v[24:27]
  buffer_load_dwordx4 v98, s[32:35], s67 offen offset:0 sc1 lds
  s_waitcnt lgkmcnt(10)
  v_mfma_f32_16x16x32_bf16 v[12:15], v[44:47], v[48:51], v[12:15]
  v_mfma_f32_16x16x32_bf16 v[28:31], v[44:47], v[52:55], v[28:31]
  buffer_load_dwordx4 v98, s[32:35], s67 offen offset:1024 sc1 lds
  s_add_u32 s64, s64, 0x10000
  s_add_u32 s67, s67, 4096
  s_waitcnt vmcnt(14) lgkmcnt(0)
  v_mfma_f32_16x16x32_bf16 v[0:3], v[56:59], v[72:75], v[0:3]
  s_barrier
  ds_read_b64_tr_b16 v[32:33], v101 offset:32768
  ds_read_b64_tr_b16 v[34:35], v101 offset:34816
  v_mfma_f32_16x16x32_bf16 v[16:19], v[56:59], v[76:79], v[16:19]
  ds_read_b128 v[48:51], v81 offset:32768
  ds_read_b64_tr_b16 v[36:37], v104 offset:32768
  v_mfma_f32_16x16x32_bf16 v[4:7], v[60:63], v[72:75], v[4:7]
  ds_read_b64_tr_b16 v[38:39], v104 offset:34816
  ds_read_b128 v[52:55], v81 offset:33024
  v_mfma_f32_16x16x32_bf16 v[20:23], v[60:63], v[76:79], v[20:23]
  ds_read_b64_tr_b16 v[40:41], v107 offset:32768
  ds_read_b64_tr_b16 v[42:43], v107 offset:34816
  v_mfma_f32_16x16x32_bf16 v[8:11], v[64:67], v[72:75], v[8:11]
  ds_read_b64_tr_b16 v[44:45], v110 offset:32768
  ds_read_b64_tr_b16 v[46:47], v110 offset:34816
  v_mfma_f32_16x16x32_bf16 v[24:27], v[64:67], v[76:79], v[24:27]
  s_add_u32 m0, s68, 0x10000
  s_nop 0
  buffer_load_dwordx4 v96, s[44:47], s64 offen offset:0 lds
  v_mfma_f32_16x16x32_bf16 v[12:15], v[68:71], v[72:75], v[12:15]
  v_mfma_f32_16x16x32_bf16 v[28:31], v[68:71], v[76:79], v[28:31]
  buffer_load_dwordx4 v97, s[44:47], s64 offen offset:1024 lds
  s_add_u32 m0, s68, 0x14000
  s_waitcnt lgkmcnt(7)
  v_mfma_f32_16x16x32_bf16 v[0:3], v[32:35], v[48:51], v[0:3]
  ds_read_b64_tr_b16 v[56:57], v101 offset:40960
  ds_read_b64_tr_b16 v[58:59], v101 offset:43008
  s_waitcnt lgkmcnt(6)
  v_mfma_f32_16x16x32_bf16 v[16:19], v[32:35], v[52:55], v[16:19]
  ds_read_b128 v[72:75], v81 offset:34816
  ds_read_b64_tr_b16 v[60:61], v104 offset:40960
  v_mfma_f32_16x16x32_bf16 v[4:7], v[36:39], v[48:51], v[4:7]
  ds_read_b64_tr_b16 v[62:63], v104 offset:43008
  ds_read_b128 v[76:79], v81 offset:35072
  v_mfma_f32_16x16x32_bf16 v[20:23], v[36:39], v[52:55], v[20:23]
  ds_read_b64_tr_b16 v[64:65], v107 offset:40960
  ds_read_b64_tr_b16 v[66:67], v107 offset:43008
  s_waitcnt lgkmcnt(10)
  v_mfma_f32_16x16x32_bf16 v[8:11], v[40:43], v[48:51], v[8:11]
  ds_read_b64_tr_b16 v[68:69], v110 offset:40960
  ds_read_b64_tr_b16 v[70:71], v110 offset:43008
  v_mfma_f32_16x16x32_bf16 v[24:27], v[40:43], v[52:55], v[24:27]
  buffer_load_dwordx4 v98, s[32:35], s67 offen offset:0 sc1 lds
  s_waitcnt lgkmcnt(10)
  v_mfma_f32_16x16x32_bf16 v[12:15], v[44:47], v[48:51], v[12:15]
  v_mfma_f32_16x16x32_bf16 v[28:31], v[44:47], v[52:55], v[28:31]
  buffer_load_dwordx4 v98, s[32:35], s67 offen offset:1024 sc1 lds
  s_add_u32 s64, s64, 0x10000
  s_add_u32 s67, s67, 4096
  s_waitcnt vmcnt(12) lgkmcnt(0)
  v_mfma_f32_16x16x32_bf16 v[0:3], v[56:59], v[72:75], v[0:3]
  s_barrier
  ds_read_b64_tr_b16 v[32:33], v100 offset:32768
  ds_read_b64_tr_b16 v[34:35], v100 offset:34816
  v_mfma_f32_16x16x32_bf16 v[16:19], v[56:59], v[76:79], v[16:19]
  ds_read_b128 v[48:51], v80 offset:32768
  ds_read_b64_tr_b16 v[36:37], v103 offset:32768
  v_mfma_f32_16x16x32_bf16 v[4:7], v[60:63], v[72:75], v[4:7]
  ds_read_b64_tr_b16 v[38:39], v103 offset:34816
  ds_read_b128 v[52:55], v80 offset:33024
  v_mfma_f32_16x16x32_bf16 v[20:23], v[60:63], v[76:79], v[20:23]
  ds_read_b64_tr_b16 v[40:41], v106 offset:32768
  ds_read_b64_tr_b16 v[42:43], v106 offset:34816
  v_mfma_f32_16x16x32_bf16 v[8:11], v[64:67], v[72:75], v[8:11]
  ds_read_b64_tr_b16 v[44:45], v109 offset:32768
  ds_read_b64_tr_b16 v[46:47], v109 offset:34816
  v_mfma_f32_16x16x32_bf16 v[24:27], v[64:67], v[76:79], v[24:27]
  s_add_u32 m0, s68, 0x18000
  s_nop 0
  buffer_load_dwordx4 v96, s[44:47], s64 offen offset:0 lds
  v_mfma_f32_16x16x32_bf16 v[12:15], v[68:71], v[72:75], v[12:15]
  v_mfma_f32_16x16x32_bf16 v[28:31], v[68:71], v[76:79], v[28:31]
  buffer_load_dwordx4 v97, s[44:47], s64 offen offset:1024 lds
  s_add_u32 m0, s68, 0x1c000
  s_waitcnt lgkmcnt(7)
  v_mfma_f32_16x16x32_bf16 v[0:3], v[32:35], v[48:51], v[0:3]
  ds_read_b64_tr_b16 v[56:57], v100 offset:40960
  ds_read_b64_tr_b16 v[58:59], v100 offset:43008
  s_waitcnt lgkmcnt(6)
  v_mfma_f32_16x16x32_bf16 v[16:19], v[32:35], v[52:55], v[16:19]
  ds_read_b128 v[72:75], v80 offset:34816
  ds_read_b64_tr_b16 v[60:61], v103 offset:40960
  v_mfma_f32_16x16x32_bf16 v[4:7], v[36:39], v[48:51], v[4:7]
  ds_read_b64_tr_b16 v[62:63], v103 offset:43008
  ds_read_b128 v[76:79], v80 offset:35072
  v_mfma_f32_16x16x32_bf16 v[20:23], v[36:39], v[52:55], v[20:23]
  ds_read_b64_tr_b16 v[64:65], v106 offset:40960
  ds_read_b64_tr_b16 v[66:67], v106 offset:43008
  s_waitcnt lgkmcnt(10)
  v_mfma_f32_16x16x32_bf16 v[8:11], v[40:43], v[48:51], v[8:11]
  ds_read_b64_tr_b16 v[68:69], v109 offset:40960
  ds_read_b64_tr_b16 v[70:71], v109 offset:43008
  v_mfma_f32_16x16x32_bf16 v[24:27], v[40:43], v[52:55], v[24:27]
  buffer_load_dwordx4 v98, s[32:35], s67 offen offset:0 sc1 lds
  s_waitcnt lgkmcnt(10)
  v_mfma_f32_16x16x32_bf16 v[12:15], v[44:47], v[48:51], v[12:15]
  v_mfma_f32_16x16x32_bf16 v[28:31], v[44:47], v[52:55], v[28:31]
  buffer_load_dwordx4 v98, s[32:35], s67 offen offset:1024 sc1 lds
  s_add_u32 s64, s64, 0x10000
  s_add_u32 s67, s67, 4096
  s_waitcnt vmcnt(12) lgkmcnt(0)
  v_mfma_f32_16x16x32_bf16 v[0:3], v[56:59], v[72:75], v[0:3]
  s_barrier
  ds_read_b64_tr_b16 v[32:33], v102 offset:0
  ds_read_b64_tr_b16 v[34:35], v102 offset:2048
  v_mfma_f32_16x16x32_bf16 v[16:19], v[56:59], v[76:79], v[16:19]
  ds_read_b128 v[48:51], v82 offset:0
  ds_read_b64_tr_b16 v[36:37], v105 offset:0
  v_mfma_f32_16x16x32_bf16 v[4:7], v[60:63], v[72:75], v[4:7]
  ds_read_b64_tr_b16 v[38:39], v105 offset:2048
  ds_read_b128 v[52:55], v82 offset:256
  v_mfma_f32_16x16x32_bf16 v[20:23], v[60:63], v[76:79], v[20:23]
  ds_read_b64_tr_b16 v[40:41], v108 offset:0
  ds_read_b64_tr_b16 v[42:43], v108 offset:2048
  v_mfma_f32_16x16x32_bf16 v[8:11], v[64:67], v[72:75], v[8:11]
  ds_read_b64_tr_b16 v[44:45], v111 offset:0
  ds_read_b64_tr_b16 v[46:47], v111 offset:2048
  v_mfma_f32_16x16x32_bf16 v[24:27], v[64:67], v[76:79], v[24:27]
  s_add_u32 m0, s68, 0x8000
  s_nop 0
  buffer_load_dwordx4 v96, s[44:47], s64 offen offset:0 lds
  v_mfma_f32_16x16x32_bf16 v[12:15], v[68:71], v[72:75], v[12:15]
  v_mfma_f32_16x16x32_bf16 v[28:31], v[68:71], v[76:79], v[28:31]
  buffer_load_dwordx4 v97, s[44:47], s64 offen offset:1024 lds
  s_add_u32 m0, s68, 0xc000
  s_waitcnt lgkmcnt(7)
  v_mfma_f32_16x16x32_bf16 v[0:3], v[32:35], v[48:51], v[0:3]
  ds_read_b64_tr_b16 v[56:57], v102 offset:8192
  ds_read_b64_tr_b16 v[58:59], v102 offset:10240
  s_waitcnt lgkmcnt(6)
  v_mfma_f32_16x16x32_bf16 v[16:19], v[32:35], v[52:55], v[16:19]
  ds_read_b128 v[72:75], v82 offset:2048
  ds_read_b64_tr_b16 v[60:61], v105 offset:8192
  v_mfma_f32_16x16x32_bf16 v[4:7], v[36:39], v[48:51], v[4:7]
  ds_read_b64_tr_b16 v[62:63], v105 offset:10240
  ds_read_b128 v[76:79], v82 offset:2304
  v_mfma_f32_16x16x32_bf16 v[20:23], v[36:39], v[52:55], v[20:23]
  ds_read_b64_tr_b16 v[64:65], v108 offset:8192
  ds_read_b64_tr_b16 v[66:67], v108 offset:10240
  s_waitcnt lgkmcnt(10)
  v_mfma_f32_16x16x32_bf16 v[8:11], v[40:43], v[48:51], v[8:11]
  ds_read_b64_tr_b16 v[68:69], v111 offset:8192
  ds_read_b64_tr_b16 v[70:71], v111 offset:10240
  v_mfma_f32_16x16x32_bf16 v[24:27], v[40:43], v[52:55], v[24:27]
  buffer_load_dwordx4 v98, s[32:35], s67 offen offset:0 sc1 lds
  s_waitcnt lgkmcnt(10)
  v_mfma_f32_16x16x32_bf16 v[12:15], v[44:47], v[48:51], v[12:15]
  v_mfma_f32_16x16x32_bf16 v[28:31], v[44:47], v[52:55], v[28:31]
  buffer_load_dwordx4 v98, s[32:35], s67 offen offset:1024 sc1 lds
  s_add_u32 s64, s64, 0x10000
  s_add_u32 s67, s67, 4096
  s_waitcnt vmcnt(12) lgkmcnt(0)
  v_mfma_f32_16x16x32_bf16 v[0:3], v[56:59], v[72:75], v[0:3]
  s_barrier
  ds_read_b64_tr_b16 v[32:33], v100 offset:0
  ds_read_b64_tr_b16 v[34:35], v100 offset:2048
  v_mfma_f32_16x16x32_bf16 v[16:19], v[56:59], v[76:79], v[16:19]
  ds_read_b128 v[48:51], v80 offset:0
  ds_read_b64_tr_b16 v[36:37], v103 offset:0
  v_mfma_f32_16x16x32_bf16 v[4:7], v[60:63], v[72:75], v[4:7]
  ds_read_b64_tr_b16 v[38:39], v103 offset:2048
  ds_read_b128 v[52:55], v80 offset:256
  v_mfma_f32_16x16x32_bf16 v[20:23], v[60:63], v[76:79], v[20:23]
  ds_read_b64_tr_b16 v[40:41], v106 offset:0
  ds_read_b64_tr_b16 v[42:43], v106 offset:2048
  v_mfma_f32_16x16x32_bf16 v[8:11], v[64:67], v[72:75], v[8:11]
  ds_read_b64_tr_b16 v[44:45], v109 offset:0
  ds_read_b64_tr_b16 v[46:47], v109 offset:2048
  v_mfma_f32_16x16x32_bf16 v[24:27], v[64:67], v[76:79], v[24:27]
  s_add_u32 m0, s68, 0x20000
  s_nop 0
  buffer_load_dwordx4 v96, s[44:47], s64 offen offset:0 lds
  v_mfma_f32_16x16x32_bf16 v[12:15], v[68:71], v[72:75], v[12:15]
  v_mfma_f32_16x16x32_bf16 v[28:31], v[68:71], v[76:79], v[28:31]
  buffer_load_dwordx4 v97, s[44:47], s64 offen offset:1024 lds
  s_add_u32 m0, s68, 0x24000
  s_waitcnt lgkmcnt(7)
  v_mfma_f32_16x16x32_bf16 v[0:3], v[32:35], v[48:51], v[0:3]
  ds_read_b64_tr_b16 v[56:57], v100 offset:8192
  ds_read_b64_tr_b16 v[58:59], v100 offset:10240
  s_waitcnt lgkmcnt(6)
  v_mfma_f32_16x16x32_bf16 v[16:19], v[32:35], v[52:55], v[16:19]
  ds_read_b128 v[72:75], v80 offset:2048
  ds_read_b64_tr_b16 v[60:61], v103 offset:8192
  v_mfma_f32_16x16x32_bf16 v[4:7], v[36:39], v[48:51], v[4:7]
  ds_read_b64_tr_b16 v[62:63], v103 offset:10240
  ds_read_b128 v[76:79], v80 offset:2304
  v_mfma_f32_16x16x32_bf16 v[20:23], v[36:39], v[52:55], v[20:23]
  ds_read_b64_tr_b16 v[64:65], v106 offset:8192
  ds_read_b64_tr_b16 v[66:67], v106 offset:10240
  s_waitcnt lgkmcnt(10)
  v_mfma_f32_16x16x32_bf16 v[8:11], v[40:43], v[48:51], v[8:11]
  ds_read_b64_tr_b16 v[68:69], v109 offset:8192
  ds_read_b64_tr_b16 v[70:71], v109 offset:10240
  v_mfma_f32_16x16x32_bf16 v[24:27], v[40:43], v[52:55], v[24:27]
  buffer_load_dwordx4 v98, s[32:35], s67 offen offset:0 sc1 lds
  s_waitcnt lgkmcnt(10)
  v_mfma_f32_16x16x32_bf16 v[12:15], v[44:47], v[48:51], v[12:15]
  v_mfma_f32_16x16x32_bf16 v[28:31], v[44:47], v[52:55], v[28:31]
  buffer_load_dwordx4 v98, s[32:35], s67 offen offset:1024 sc1 lds
  s_add_u32 s64, s64, 0x10000
  s_add_u32 s67, s67, 4096
  s_waitcnt vmcnt(12) lgkmcnt(0)
  v_mfma_f32_16x16x32_bf16 v[0:3], v[56:59], v[72:75], v[0:3]
  s_barrier
  ds_read_b64_tr_b16 v[32:33], v101 offset:0
  ds_read_b64_tr_b16 v[34:35], v101 offset:2048
  v_mfma_f32_16x16x32_bf16 v[16:19], v[56:59], v[76:79], v[16:19]
  ds_read_b128 v[48:51], v81 offset:0
  ds_read_b64_tr_b16 v[36:37], v104 offset:0
  v_mfma_f32_16x16x32_bf16 v[4:7], v[60:63], v[72:75], v[4:7]
  ds_read_b64_tr_b16 v[38:39], v104 offset:2048
  ds_read_b128 v[52:55], v81 offset:256
  v_mfma_f32_16x16x32_bf16 v[20:23], v[60:63], v[76:79], v[20:23]
  ds_read_b64_tr_b16 v[40:41], v107 offset:0
  ds_read_b64_tr_b16 v[42:43], v107 offset:2048
  v_mfma_f32_16x16x32_bf16 v[8:11], v[64:67], v[72:75], v[8:11]
  ds_read_b64_tr_b16 v[44:45], v110 offset:0
  ds_read_b64_tr_b16 v[46:47], v110 offset:2048
  v_mfma_f32_16x16x32_bf16 v[24:27], v[64:67], v[76:79], v[24:27]
  s_add_u32 m0, s68, 0x0
  s_nop 0
  buffer_load_dwordx4 v96, s[44:47], s64 offen offset:0 lds
  v_mfma_f32_16x16x32_bf16 v[12:15], v[68:71], v[72:75], v[12:15]
  v_mfma_f32_16x16x32_bf16 v[28:31], v[68:71], v[76:79], v[28:31]
  buffer_load_dwordx4 v97, s[44:47], s64 offen offset:1024 lds
  s_add_u32 m0, s68, 0x4000
  s_waitcnt lgkmcnt(7)
  v_mfma_f32_16x16x32_bf16 v[0:3], v[32:35], v[48:51], v[0:3]
  ds_read_b64_tr_b16 v[56:57], v101 offset:8192
  ds_read_b64_tr_b16 v[58:59], v101 offset:10240
  s_waitcnt lgkmcnt(6)
  v_mfma_f32_16x16x32_bf16 v[16:19], v[32:35], v[52:55], v[16:19]
  ds_read_b128 v[72:75], v81 offset:2048
  ds_read_b64_tr_b16 v[60:61], v104 offset:8192
  v_mfma_f32_16x16x32_bf16 v[4:7], v[36:39], v[48:51], v[4:7]
  ds_read_b64_tr_b16 v[62:63], v104 offset:10240
  ds_read_b128 v[76:79], v81 offset:2304
  v_mfma_f32_16x16x32_bf16 v[20:23], v[36:39], v[52:55], v[20:23]
  ds_read_b64_tr_b16 v[64:65], v107 offset:8192
  ds_read_b64_tr_b16 v[66:67], v107 offset:10240
  s_waitcnt lgkmcnt(10)
  v_mfma_f32_16x16x32_bf16 v[8:11], v[40:43], v[48:51], v[8:11]
  ds_read_b64_tr_b16 v[68:69], v110 offset:8192
  ds_read_b64_tr_b16 v[70:71], v110 offset:10240
  v_mfma_f32_16x16x32_bf16 v[24:27], v[40:43], v[52:55], v[24:27]
  buffer_load_dwordx4 v98, s[32:35], s67 offen offset:0 sc1 lds
  s_waitcnt lgkmcnt(10)
  v_mfma_f32_16x16x32_bf16 v[12:15], v[44:47], v[48:51], v[12:15]
  v_mfma_f32_16x16x32_bf16 v[28:31], v[44:47], v[52:55], v[28:31]
  buffer_load_dwordx4 v98, s[32:35], s67 offen offset:1024 sc1 lds
  s_add_u32 s64, s64, 0x10000
  s_add_u32 s67, s67, 4096
  s_waitcnt vmcnt(12) lgkmcnt(0)
  v_mfma_f32_16x16x32_bf16 v[0:3], v[56:59], v[72:75], v[0:3]
  s_barrier
  ds_read_b64_tr_b16 v[32:33], v101 offset:32768
  ds_read_b64_tr_b16 v[34:35], v101 offset:34816
  v_mfma_f32_16x16x32_bf16 v[16:19], v[56:59], v[76:79], v[16:19]
  ds_read_b128 v[48:51], v81 offset:32768
  ds_read_b64_tr_b16 v[36:37], v104 offset:32768
  v_mfma_f32_16x16x32_bf16 v[4:7], v[60:63], v[72:75], v[4:7]
  ds_read_b64_tr_b16 v[38:39], v104 offset:34816
  ds_read_b128 v[52:55], v81 offset:33024
  v_mfma_f32_16x16x32_bf16 v[20:23], v[60:63], v[76:79], v[20:23]
  ds_read_b64_tr_b16 v[40:41], v107 offset:32768
  ds_read_b64_tr_b16 v[42:43], v107 offset:34816
  v_mfma_f32_16x16x32_bf16 v[8:11], v[64:67], v[72:75], v[8:11]
  ds_read_b64_tr_b16 v[44:45], v110 offset:32768
  ds_read_b64_tr_b16 v[46:47], v110 offset:34816
  v_mfma_f32_16x16x32_bf16 v[24:27], v[64:67], v[76:79], v[24:27]
  s_add_u32 m0, s68, 0x10000
  s_nop 0
  buffer_load_dwordx4 v96, s[44:47], s64 offen offset:0 lds
  v_mfma_f32_16x16x32_bf16 v[12:15], v[68:71], v[72:75], v[12:15]
  v_mfma_f32_16x16x32_bf16 v[28:31], v[68:71], v[76:79], v[28:31]
  buffer_load_dwordx4 v97, s[44:47], s64 offen offset:1024 lds
  s_add_u32 m0, s68, 0x14000
  s_waitcnt lgkmcnt(7)
  v_mfma_f32_16x16x32_bf16 v[0:3], v[32:35], v[48:51], v[0:3]
  ds_read_b64_tr_b16 v[56:57], v101 offset:40960
  ds_read_b64_tr_b16 v[58:59], v101 offset:43008
  s_waitcnt lgkmcnt(6)
  v_mfma_f32_16x16x32_bf16 v[16:19], v[32:35], v[52:55], v[16:19]
  ds_read_b128 v[72:75], v81 offset:34816
  ds_read_b64_tr_b16 v[60:61], v104 offset:40960
  v_mfma_f32_16x16x32_bf16 v[4:7], v[36:39], v[48:51], v[4:7]
  ds_read_b64_tr_b16 v[62:63], v104 offset:43008
  ds_read_b128 v[76:79], v81 offset:35072
  v_mfma_f32_16x16x32_bf16 v[20:23], v[36:39], v[52:55], v[20:23]
  ds_read_b64_tr_b16 v[64:65], v107 offset:40960
  ds_read_b64_tr_b16 v[66:67], v107 offset:43008
  s_waitcnt lgkmcnt(10)
  v_mfma_f32_16x16x32_bf16 v[8:11], v[40:43], v[48:51], v[8:11]
  ds_read_b64_tr_b16 v[68:69], v110 offset:40960
  ds_read_b64_tr_b16 v[70:71], v110 offset:43008
  v_mfma_f32_16x16x32_bf16 v[24:27], v[40:43], v[52:55], v[24:27]
  buffer_load_dwordx4 v98, s[32:35], s67 offen offset:0 sc1 lds
  s_waitcnt lgkmcnt(10)
  v_mfma_f32_16x16x32_bf16 v[12:15], v[44:47], v[48:51], v[12:15]
  v_mfma_f32_16x16x32_bf16 v[28:31], v[44:47], v[52:55], v[28:31]
  buffer_load_dwordx4 v98, s[32:35], s67 offen offset:1024 sc1 lds
  s_add_u32 s64, s64, 0x10000
  s_add_u32 s67, s67, 4096
  s_waitcnt vmcnt(12) lgkmcnt(0)
  v_mfma_f32_16x16x32_bf16 v[0:3], v[56:59], v[72:75], v[0:3]
  s_barrier
  ds_read_b64_tr_b16 v[32:33], v100 offset:32768
  ds_read_b64_tr_b16 v[34:35], v100 offset:34816
  v_mfma_f32_16x16x32_bf16 v[16:19], v[56:59], v[76:79], v[16:19]
  ds_read_b128 v[48:51], v80 offset:32768
  ds_read_b64_tr_b16 v[36:37], v103 offset:32768
  v_mfma_f32_16x16x32_bf16 v[4:7], v[60:63], v[72:75], v[4:7]
  ds_read_b64_tr_b16 v[38:39], v103 offset:34816
  ds_read_b128 v[52:55], v80 offset:33024
  v_mfma_f32_16x16x32_bf16 v[20:23], v[60:63], v[76:79], v[20:23]
  ds_read_b64_tr_b16 v[40:41], v106 offset:32768
  ds_read_b64_tr_b16 v[42:43], v106 offset:34816
  v_mfma_f32_16x16x32_bf16 v[8:11], v[64:67], v[72:75], v[8:11]
  ds_read_b64_tr_b16 v[44:45], v109 offset:32768
  ds_read_b64_tr_b16 v[46:47], v109 offset:34816
  v_mfma_f32_16x16x32_bf16 v[24:27], v[64:67], v[76:79], v[24:27]
  s_add_u32 m0, s68, 0x18000
  s_nop 0
  buffer_load_dwordx4 v96, s[44:47], s64 offen offset:0 lds
  v_mfma_f32_16x16x32_bf16 v[12:15], v[68:71], v[72:75], v[12:15]
  v_mfma_f32_16x16x32_bf16 v[28:31], v[68:71], v[76:79], v[28:31]
  buffer_load_dwordx4 v97, s[44:47], s64 offen offset:1024 lds
  s_add_u32 m0, s68, 0x1c000
  s_waitcnt lgkmcnt(7)
  v_mfma_f32_16x16x32_bf16 v[0:3], v[32:35], v[48:51], v[0:3]
  ds_read_b64_tr_b16 v[56:57], v100 offset:40960
  ds_read_b64_tr_b16 v[58:59], v100 offset:43008
  s_waitcnt lgkmcnt(6)
  v_mfma_f32_16x16x32_bf16 v[16:19], v[32:35], v[52:55], v[16:19]
  ds_read_b128 v[72:75], v80 offset:34816
  ds_read_b64_tr_b16 v[60:61], v103 offset:40960
  v_mfma_f32_16x16x32_bf16 v[4:7], v[36:39], v[48:51], v[4:7]
  ds_read_b64_tr_b16 v[62:63], v103 offset:43008
  ds_read_b128 v[76:79], v80 offset:35072
  v_mfma_f32_16x16x32_bf16 v[20:23], v[36:39], v[52:55], v[20:23]
  ds_read_b64_tr_b16 v[64:65], v106 offset:40960
  ds_read_b64_tr_b16 v[66:67], v106 offset:43008
  s_waitcnt lgkmcnt(10)
  v_mfma_f32_16x16x32_bf16 v[8:11], v[40:43], v[48:51], v[8:11]
  ds_read_b64_tr_b16 v[68:69], v109 offset:40960
  ds_read_b64_tr_b16 v[70:71], v109 offset:43008
  v_mfma_f32_16x16x32_bf16 v[24:27], v[40:43], v[52:55], v[24:27]
  buffer_load_dwordx4 v98, s[32:35], s67 offen offset:0 sc1 lds
  s_waitcnt lgkmcnt(10)
  v_mfma_f32_16x16x32_bf16 v[12:15], v[44:47], v[48:51], v[12:15]
  v_mfma_f32_16x16x32_bf16 v[28:31], v[44:47], v[52:55], v[28:31]
  buffer_load_dwordx4 v98, s[32:35], s67 offen offset:1024 sc1 lds
  s_add_u32 s64, s64, 0x10000
  s_add_u32 s67, s67, 4096
  s_waitcnt vmcnt(12) lgkmcnt(0)
  v_mfma_f32_16x16x32_bf16 v[0:3], v[56:59], v[72:75], v[0:3]
  s_barrier
  ds_read_b64_tr_b16 v[32:33], v102 offset:0
  ds_read_b64_tr_b16 v[34:35], v102 offset:2048
  v_mfma_f32_16x16x32_bf16 v[16:19], v[56:59], v[76:79], v[16:19]
  ds_read_b128 v[48:51], v82 offset:0
  ds_read_b64_tr_b16 v[36:37], v105 offset:0
  v_mfma_f32_16x16x32_bf16 v[4:7], v[60:63], v[72:75], v[4:7]
  ds_read_b64_tr_b16 v[38:39], v105 offset:2048
  ds_read_b128 v[52:55], v82 offset:256
  v_mfma_f32_16x16x32_bf16 v[20:23], v[60:63], v[76:79], v[20:23]
  ds_read_b64_tr_b16 v[40:41], v108 offset:0
  ds_read_b64_tr_b16 v[42:43], v108 offset:2048
  v_mfma_f32_16x16x32_bf16 v[8:11], v[64:67], v[72:75], v[8:11]
  ds_read_b64_tr_b16 v[44:45], v111 offset:0
  ds_read_b64_tr_b16 v[46:47], v111 offset:2048
  v_mfma_f32_16x16x32_bf16 v[24:27], v[64:67], v[76:79], v[24:27]
  s_add_u32 m0, s68, 0x8000
  s_nop 0
  buffer_load_dwordx4 v96, s[44:47], s64 offen offset:0 lds
  v_mfma_f32_16x16x32_bf16 v[12:15], v[68:71], v[72:75], v[12:15]
  v_mfma_f32_16x16x32_bf16 v[28:31], v[68:71], v[76:79], v[28:31]
  buffer_load_dwordx4 v97, s[44:47], s64 offen offset:1024 lds
  s_add_u32 m0, s68, 0xc000
  s_waitcnt lgkmcnt(7)
  v_mfma_f32_16x16x32_bf16 v[0:3], v[32:35], v[48:51], v[0:3]
  ds_read_b64_tr_b16 v[56:57], v102 offset:8192
  ds_read_b64_tr_b16 v[58:59], v102 offset:10240
  s_waitcnt lgkmcnt(6)
  v_mfma_f32_16x16x32_bf16 v[16:19], v[32:35], v[52:55], v[16:19]
  ds_read_b128 v[72:75], v82 offset:2048
  ds_read_b64_tr_b16 v[60:61], v105 offset:8192
  v_mfma_f32_16x16x32_bf16 v[4:7], v[36:39], v[48:51], v[4:7]
  ds_read_b64_tr_b16 v[62:63], v105 offset:10240
  ds_read_b128 v[76:79], v82 offset:2304
  v_mfma_f32_16x16x32_bf16 v[20:23], v[36:39], v[52:55], v[20:23]
  ds_read_b64_tr_b16 v[64:65], v108 offset:8192
  ds_read_b64_tr_b16 v[66:67], v108 offset:10240
  s_waitcnt lgkmcnt(10)
  v_mfma_f32_16x16x32_bf16 v[8:11], v[40:43], v[48:51], v[8:11]
  ds_read_b64_tr_b16 v[68:69], v111 offset:8192
  ds_read_b64_tr_b16 v[70:71], v111 offset:10240
  v_mfma_f32_16x16x32_bf16 v[24:27], v[40:43], v[52:55], v[24:27]
  buffer_load_dwordx4 v98, s[32:35], s67 offen offset:0 sc1 lds
  s_waitcnt lgkmcnt(10)
  v_mfma_f32_16x16x32_bf16 v[12:15], v[44:47], v[48:51], v[12:15]
  v_mfma_f32_16x16x32_bf16 v[28:31], v[44:47], v[52:55], v[28:31]
  buffer_load_dwordx4 v98, s[32:35], s67 offen offset:1024 sc1 lds
  s_add_u32 s64, s64, 0x10000
  s_add_u32 s67, s67, 4096
  s_waitcnt vmcnt(12) lgkmcnt(0)
  v_mfma_f32_16x16x32_bf16 v[0:3], v[56:59], v[72:75], v[0:3]
  s_barrier
  ds_read_b64_tr_b16 v[32:33], v100 offset:0
  ds_read_b64_tr_b16 v[34:35], v100 offset:2048
  v_mfma_f32_16x16x32_bf16 v[16:19], v[56:59], v[76:79], v[16:19]
  ds_read_b128 v[48:51], v80 offset:0
  ds_read_b64_tr_b16 v[36:37], v103 offset:0
  v_mfma_f32_16x16x32_bf16 v[4:7], v[60:63], v[72:75], v[4:7]
  ds_read_b64_tr_b16 v[38:39], v103 offset:2048
  ds_read_b128 v[52:55], v80 offset:256
  v_mfma_f32_16x16x32_bf16 v[20:23], v[60:63], v[76:79], v[20:23]
  ds_read_b64_tr_b16 v[40:41], v106 offset:0
  ds_read_b64_tr_b16 v[42:43], v106 offset:2048
  v_mfma_f32_16x16x32_bf16 v[8:11], v[64:67], v[72:75], v[8:11]
  ds_read_b64_tr_b16 v[44:45], v109 offset:0
  ds_read_b64_tr_b16 v[46:47], v109 offset:2048
  v_mfma_f32_16x16x32_bf16 v[24:27], v[64:67], v[76:79], v[24:27]
  s_add_u32 m0, s68, 0x20000
  s_nop 0
  buffer_load_dwordx4 v96, s[44:47], s64 offen offset:0 lds
  v_mfma_f32_16x16x32_bf16 v[12:15], v[68:71], v[72:75], v[12:15]
  v_mfma_f32_16x16x32_bf16 v[28:31], v[68:71], v[76:79], v[28:31]
  buffer_load_dwordx4 v97, s[44:47], s64 offen offset:1024 lds
  s_add_u32 m0, s68, 0x24000
  s_waitcnt lgkmcnt(7)
  v_mfma_f32_16x16x32_bf16 v[0:3], v[32:35], v[48:51], v[0:3]
  ds_read_b64_tr_b16 v[56:57], v100 offset:8192
  ds_read_b64_tr_b16 v[58:59], v100 offset:10240
  s_waitcnt lgkmcnt(6)
  v_mfma_f32_16x16x32_bf16 v[16:19], v[32:35], v[52:55], v[16:19]
  ds_read_b128 v[72:75], v80 offset:2048
  ds_read_b64_tr_b16 v[60:61], v103 offset:8192
  v_mfma_f32_16x16x32_bf16 v[4:7], v[36:39], v[48:51], v[4:7]
  ds_read_b64_tr_b16 v[62:63], v103 offset:10240
  ds_read_b128 v[76:79], v80 offset:2304
  v_mfma_f32_16x16x32_bf16 v[20:23], v[36:39], v[52:55], v[20:23]
  ds_read_b64_tr_b16 v[64:65], v106 offset:8192
  ds_read_b64_tr_b16 v[66:67], v106 offset:10240
  s_waitcnt lgkmcnt(10)
  v_mfma_f32_16x16x32_bf16 v[8:11], v[40:43], v[48:51], v[8:11]
  ds_read_b64_tr_b16 v[68:69], v109 offset:8192
  ds_read_b64_tr_b16 v[70:71], v109 offset:10240
  v_mfma_f32_16x16x32_bf16 v[24:27], v[40:43], v[52:55], v[24:27]
  buffer_load_dwordx4 v98, s[32:35], s67 offen offset:0 sc1 lds
  s_waitcnt lgkmcnt(10)
  v_mfma_f32_16x16x32_bf16 v[12:15], v[44:47], v[48:51], v[12:15]
  v_mfma_f32_16x16x32_bf16 v[28:31], v[44:47], v[52:55], v[28:31]
  buffer_load_dwordx4 v98, s[32:35], s67 offen offset:1024 sc1 lds
  s_add_u32 s64, s64, 0x10000
  s_add_u32 s67, s67, 4096
  s_waitcnt vmcnt(12) lgkmcnt(0)
  v_mfma_f32_16x16x32_bf16 v[0:3], v[56:59], v[72:75], v[0:3]
  s_barrier
  ds_read_b64_tr_b16 v[32:33], v101 offset:0
  ds_read_b64_tr_b16 v[34:35], v101 offset:2048
  v_mfma_f32_16x16x32_bf16 v[16:19], v[56:59], v[76:79], v[16:19]
  ds_read_b128 v[48:51], v81 offset:0
  ds_read_b64_tr_b16 v[36:37], v104 offset:0
  v_mfma_f32_16x16x32_bf16 v[4:7], v[60:63], v[72:75], v[4:7]
  ds_read_b64_tr_b16 v[38:39], v104 offset:2048
  ds_read_b128 v[52:55], v81 offset:256
  v_mfma_f32_16x16x32_bf16 v[20:23], v[60:63], v[76:79], v[20:23]
  ds_read_b64_tr_b16 v[40:41], v107 offset:0
  ds_read_b64_tr_b16 v[42:43], v107 offset:2048
  v_mfma_f32_16x16x32_bf16 v[8:11], v[64:67], v[72:75], v[8:11]
  ds_read_b64_tr_b16 v[44:45], v110 offset:0
  ds_read_b64_tr_b16 v[46:47], v110 offset:2048
  v_mfma_f32_16x16x32_bf16 v[24:27], v[64:67], v[76:79], v[24:27]
  s_add_u32 m0, s68, 0x0
  s_nop 0
  buffer_load_dwordx4 v96, s[44:47], s64 offen offset:0 lds
  v_mfma_f32_16x16x32_bf16 v[12:15], v[68:71], v[72:75], v[12:15]
  v_mfma_f32_16x16x32_bf16 v[28:31], v[68:71], v[76:79], v[28:31]
  buffer_load_dwordx4 v97, s[44:47], s64 offen offset:1024 lds
  s_add_u32 m0, s68, 0x4000
  s_waitcnt lgkmcnt(7)
  v_mfma_f32_16x16x32_bf16 v[0:3], v[32:35], v[48:51], v[0:3]
  ds_read_b64_tr_b16 v[56:57], v101 offset:8192
  ds_read_b64_tr_b16 v[58:59], v101 offset:10240
  s_waitcnt lgkmcnt(6)
  v_mfma_f32_16x16x32_bf16 v[16:19], v[32:35], v[52:55], v[16:19]
  ds_read_b128 v[72:75], v81 offset:2048
  ds_read_b64_tr_b16 v[60:61], v104 offset:8192
  v_mfma_f32_16x16x32_bf16 v[4:7], v[36:39], v[48:51], v[4:7]
  ds_read_b64_tr_b16 v[62:63], v104 offset:10240
  ds_read_b128 v[76:79], v81 offset:2304
  v_mfma_f32_16x16x32_bf16 v[20:23], v[36:39], v[52:55], v[20:23]
  ds_read_b64_tr_b16 v[64:65], v107 offset:8192
  ds_read_b64_tr_b16 v[66:67], v107 offset:10240
  s_waitcnt lgkmcnt(10)
  v_mfma_f32_16x16x32_bf16 v[8:11], v[40:43], v[48:51], v[8:11]
  ds_read_b64_tr_b16 v[68:69], v110 offset:8192
  ds_read_b64_tr_b16 v[70:71], v110 offset:10240
  v_mfma_f32_16x16x32_bf16 v[24:27], v[40:43], v[52:55], v[24:27]
  buffer_load_dwordx4 v98, s[32:35], s67 offen offset:0 sc1 lds
  s_waitcnt lgkmcnt(10)
  v_mfma_f32_16x16x32_bf16 v[12:15], v[44:47], v[48:51], v[12:15]
  v_mfma_f32_16x16x32_bf16 v[28:31], v[44:47], v[52:55], v[28:31]
  buffer_load_dwordx4 v98, s[32:35], s67 offen offset:1024 sc1 lds
  s_add_u32 s64, s64, 0x10000
  s_add_u32 s67, s67, 4096
  s_waitcnt vmcnt(12) lgkmcnt(0)
  v_mfma_f32_16x16x32_bf16 v[0:3], v[56:59], v[72:75], v[0:3]
  s_barrier
  ds_read_b64_tr_b16 v[32:33], v101 offset:32768
  ds_read_b64_tr_b16 v[34:35], v101 offset:34816
  v_mfma_f32_16x16x32_bf16 v[16:19], v[56:59], v[76:79], v[16:19]
  ds_read_b128 v[48:51], v81 offset:32768
  ds_read_b64_tr_b16 v[36:37], v104 offset:32768
  v_mfma_f32_16x16x32_bf16 v[4:7], v[60:63], v[72:75], v[4:7]
  ds_read_b64_tr_b16 v[38:39], v104 offset:34816
  ds_read_b128 v[52:55], v81 offset:33024
  v_mfma_f32_16x16x32_bf16 v[20:23], v[60:63], v[76:79], v[20:23]
  ds_read_b64_tr_b16 v[40:41], v107 offset:32768
  ds_read_b64_tr_b16 v[42:43], v107 offset:34816
  v_mfma_f32_16x16x32_bf16 v[8:11], v[64:67], v[72:75], v[8:11]
  ds_read_b64_tr_b16 v[44:45], v110 offset:32768
  ds_read_b64_tr_b16 v[46:47], v110 offset:34816
  v_mfma_f32_16x16x32_bf16 v[24:27], v[64:67], v[76:79], v[24:27]
  s_add_u32 m0, s68, 0x10000
  s_nop 0
  buffer_load_dwordx4 v96, s[44:47], s64 offen offset:0 lds
  v_mfma_f32_16x16x32_bf16 v[12:15], v[68:71], v[72:75], v[12:15]
  v_mfma_f32_16x16x32_bf16 v[28:31], v[68:71], v[76:79], v[28:31]
  buffer_load_dwordx4 v97, s[44:47], s64 offen offset:1024 lds
  s_add_u32 m0, s68, 0x14000
  s_waitcnt lgkmcnt(7)
  v_mfma_f32_16x16x32_bf16 v[0:3], v[32:35], v[48:51], v[0:3]
  ds_read_b64_tr_b16 v[56:57], v101 offset:40960
  ds_read_b64_tr_b16 v[58:59], v101 offset:43008
  s_waitcnt lgkmcnt(6)
  v_mfma_f32_16x16x32_bf16 v[16:19], v[32:35], v[52:55], v[16:19]
  ds_read_b128 v[72:75], v81 offset:34816
  ds_read_b64_tr_b16 v[60:61], v104 offset:40960
  v_mfma_f32_16x16x32_bf16 v[4:7], v[36:39], v[48:51], v[4:7]
  ds_read_b64_tr_b16 v[62:63], v104 offset:43008
  ds_read_b128 v[76:79], v81 offset:35072
  v_mfma_f32_16x16x32_bf16 v[20:23], v[36:39], v[52:55], v[20:23]
  ds_read_b64_tr_b16 v[64:65], v107 offset:40960
  ds_read_b64_tr_b16 v[66:67], v107 offset:43008
  s_waitcnt lgkmcnt(10)
  v_mfma_f32_16x16x32_bf16 v[8:11], v[40:43], v[48:51], v[8:11]
  ds_read_b64_tr_b16 v[68:69], v110 offset:40960
  ds_read_b64_tr_b16 v[70:71], v110 offset:43008
  v_mfma_f32_16x16x32_bf16 v[24:27], v[40:43], v[52:55], v[24:27]
  buffer_load_dwordx4 v98, s[32:35], s67 offen offset:0 sc1 lds
  s_waitcnt lgkmcnt(10)
  v_mfma_f32_16x16x32_bf16 v[12:15], v[44:47], v[48:51], v[12:15]
  v_mfma_f32_16x16x32_bf16 v[28:31], v[44:47], v[52:55], v[28:31]
  buffer_load_dwordx4 v98, s[32:35], s67 offen offset:1024 sc1 lds
  s_add_u32 s64, s64, 0x10000
  s_add_u32 s67, s67, 4096
  s_waitcnt vmcnt(12) lgkmcnt(0)
  v_mfma_f32_16x16x32_bf16 v[0:3], v[56:59], v[72:75], v[0:3]
  s_barrier
  ds_read_b64_tr_b16 v[32:33], v100 offset:32768
  ds_read_b64_tr_b16 v[34:35], v100 offset:34816
  v_mfma_f32_16x16x32_bf16 v[16:19], v[56:59], v[76:79], v[16:19]
  ds_read_b128 v[48:51], v80 offset:32768
  ds_read_b64_tr_b16 v[36:37], v103 offset:32768
  v_mfma_f32_16x16x32_bf16 v[4:7], v[60:63], v[72:75], v[4:7]
  ds_read_b64_tr_b16 v[38:39], v103 offset:34816
  ds_read_b128 v[52:55], v80 offset:33024
  v_mfma_f32_16x16x32_bf16 v[20:23], v[60:63], v[76:79], v[20:23]
  ds_read_b64_tr_b16 v[40:41], v106 offset:32768
  ds_read_b64_tr_b16 v[42:43], v106 offset:34816
  v_mfma_f32_16x16x32_bf16 v[8:11], v[64:67], v[72:75], v[8:11]
  ds_read_b64_tr_b16 v[44:45], v109 offset:32768
  ds_read_b64_tr_b16 v[46:47], v109 offset:34816
  v_mfma_f32_16x16x32_bf16 v[24:27], v[64:67], v[76:79], v[24:27]
  s_add_u32 m0, s68, 0x18000
  s_nop 0
  buffer_load_dwordx4 v96, s[44:47], s64 offen offset:0 lds
  v_mfma_f32_16x16x32_bf16 v[12:15], v[68:71], v[72:75], v[12:15]
  v_mfma_f32_16x16x32_bf16 v[28:31], v[68:71], v[76:79], v[28:31]
  buffer_load_dwordx4 v97, s[44:47], s64 offen offset:1024 lds
  s_add_u32 m0, s68, 0x1c000
  s_waitcnt lgkmcnt(7)
  v_mfma_f32_16x16x32_bf16 v[0:3], v[32:35], v[48:51], v[0:3]
  ds_read_b64_tr_b16 v[56:57], v100 offset:40960
  ds_read_b64_tr_b16 v[58:59], v100 offset:43008
  s_waitcnt lgkmcnt(6)
  v_mfma_f32_16x16x32_bf16 v[16:19], v[32:35], v[52:55], v[16:19]
  ds_read_b128 v[72:75], v80 offset:34816
  ds_read_b64_tr_b16 v[60:61], v103 offset:40960
  v_mfma_f32_16x16x32_bf16 v[4:7], v[36:39], v[48:51], v[4:7]
  ds_read_b64_tr_b16 v[62:63], v103 offset:43008
  ds_read_b128 v[76:79], v80 offset:35072
  v_mfma_f32_16x16x32_bf16 v[20:23], v[36:39], v[52:55], v[20:23]
  ds_read_b64_tr_b16 v[64:65], v106 offset:40960
  ds_read_b64_tr_b16 v[66:67], v106 offset:43008
  s_waitcnt lgkmcnt(10)
  v_mfma_f32_16x16x32_bf16 v[8:11], v[40:43], v[48:51], v[8:11]
  ds_read_b64_tr_b16 v[68:69], v109 offset:40960
  ds_read_b64_tr_b16 v[70:71], v109 offset:43008
  v_mfma_f32_16x16x32_bf16 v[24:27], v[40:43], v[52:55], v[24:27]
  buffer_load_dwordx4 v98, s[32:35], s67 offen offset:0 sc1 lds
  s_waitcnt lgkmcnt(10)
  v_mfma_f32_16x16x32_bf16 v[12:15], v[44:47], v[48:51], v[12:15]
  v_mfma_f32_16x16x32_bf16 v[28:31], v[44:47], v[52:55], v[28:31]
  buffer_load_dwordx4 v98, s[32:35], s67 offen offset:1024 sc1 lds
  s_add_u32 s64, s64, 0x10000
  s_add_u32 s67, s67, 4096
  s_waitcnt vmcnt(12) lgkmcnt(0)
  v_mfma_f32_16x16x32_bf16 v[0:3], v[56:59], v[72:75], v[0:3]
  s_barrier
  ds_read_b64_tr_b16 v[32:33], v102 offset:0
  ds_read_b64_tr_b16 v[34:35], v102 offset:2048
  v_mfma_f32_16x16x32_bf16 v[16:19], v[56:59], v[76:79], v[16:19]
  ds_read_b128 v[48:51], v82 offset:0
  ds_read_b64_tr_b16 v[36:37], v105 offset:0
  v_mfma_f32_16x16x32_bf16 v[4:7], v[60:63], v[72:75], v[4:7]
  ds_read_b64_tr_b16 v[38:39], v105 offset:2048
  ds_read_b128 v[52:55], v82 offset:256
  v_mfma_f32_16x16x32_bf16 v[20:23], v[60:63], v[76:79], v[20:23]
  ds_read_b64_tr_b16 v[40:41], v108 offset:0
  ds_read_b64_tr_b16 v[42:43], v108 offset:2048
  v_mfma_f32_16x16x32_bf16 v[8:11], v[64:67], v[72:75], v[8:11]
  ds_read_b64_tr_b16 v[44:45], v111 offset:0
  ds_read_b64_tr_b16 v[46:47], v111 offset:2048
  v_mfma_f32_16x16x32_bf16 v[24:27], v[64:67], v[76:79], v[24:27]
  s_add_u32 m0, s68, 0x8000
  s_nop 0
  buffer_load_dwordx4 v96, s[44:47], s64 offen offset:0 lds
  v_mfma_f32_16x16x32_bf16 v[12:15], v[68:71], v[72:75], v[12:15]
  v_mfma_f32_16x16x32_bf16 v[28:31], v[68:71], v[76:79], v[28:31]
  buffer_load_dwordx4 v97, s[44:47], s64 offen offset:1024 lds
  s_add_u32 m0, s68, 0xc000
  s_waitcnt lgkmcnt(7)
  v_mfma_f32_16x16x32_bf16 v[0:3], v[32:35], v[48:51], v[0:3]
  ds_read_b64_tr_b16 v[56:57], v102 offset:8192
  ds_read_b64_tr_b16 v[58:59], v102 offset:10240
  s_waitcnt lgkmcnt(6)
  v_mfma_f32_16x16x32_bf16 v[16:19], v[32:35], v[52:55], v[16:19]
  ds_read_b128 v[72:75], v82 offset:2048
  ds_read_b64_tr_b16 v[60:61], v105 offset:8192
  v_mfma_f32_16x16x32_bf16 v[4:7], v[36:39], v[48:51], v[4:7]
  ds_read_b64_tr_b16 v[62:63], v105 offset:10240
  ds_read_b128 v[76:79], v82 offset:2304
  v_mfma_f32_16x16x32_bf16 v[20:23], v[36:39], v[52:55], v[20:23]
  ds_read_b64_tr_b16 v[64:65], v108 offset:8192
  ds_read_b64_tr_b16 v[66:67], v108 offset:10240
  s_waitcnt lgkmcnt(10)
  v_mfma_f32_16x16x32_bf16 v[8:11], v[40:43], v[48:51], v[8:11]
  ds_read_b64_tr_b16 v[68:69], v111 offset:8192
  ds_read_b64_tr_b16 v[70:71], v111 offset:10240
  v_mfma_f32_16x16x32_bf16 v[24:27], v[40:43], v[52:55], v[24:27]
  buffer_load_dwordx4 v98, s[32:35], s67 offen offset:0 sc1 lds
  s_waitcnt lgkmcnt(10)
  v_mfma_f32_16x16x32_bf16 v[12:15], v[44:47], v[48:51], v[12:15]
  v_mfma_f32_16x16x32_bf16 v[28:31], v[44:47], v[52:55], v[28:31]
  buffer_load_dwordx4 v98, s[32:35], s67 offen offset:1024 sc1 lds
  s_add_u32 s64, s64, 0x10000
  s_add_u32 s67, s67, 4096
  s_waitcnt vmcnt(12) lgkmcnt(0)
  v_mfma_f32_16x16x32_bf16 v[0:3], v[56:59], v[72:75], v[0:3]
  s_barrier
  ds_read_b64_tr_b16 v[32:33], v100 offset:0
  ds_read_b64_tr_b16 v[34:35], v100 offset:2048
  v_mfma_f32_16x16x32_bf16 v[16:19], v[56:59], v[76:79], v[16:19]
  ds_read_b128 v[48:51], v80 offset:0
  ds_read_b64_tr_b16 v[36:37], v103 offset:0
  v_mfma_f32_16x16x32_bf16 v[4:7], v[60:63], v[72:75], v[4:7]
  ds_read_b64_tr_b16 v[38:39], v103 offset:2048
  ds_read_b128 v[52:55], v80 offset:256
  v_mfma_f32_16x16x32_bf16 v[20:23], v[60:63], v[76:79], v[20:23]
  ds_read_b64_tr_b16 v[40:41], v106 offset:0
  ds_read_b64_tr_b16 v[42:43], v106 offset:2048
  v_mfma_f32_16x16x32_bf16 v[8:11], v[64:67], v[72:75], v[8:11]
  ds_read_b64_tr_b16 v[44:45], v109 offset:0
  ds_read_b64_tr_b16 v[46:47], v109 offset:2048
  v_mfma_f32_16x16x32_bf16 v[24:27], v[64:67], v[76:79], v[24:27]
  v_mfma_f32_16x16x32_bf16 v[12:15], v[68:71], v[72:75], v[12:15]
  v_mfma_f32_16x16x32_bf16 v[28:31], v[68:71], v[76:79], v[28:31]
  s_waitcnt lgkmcnt(7)
  v_mfma_f32_16x16x32_bf16 v[0:3], v[32:35], v[48:51], v[0:3]
  ds_read_b64_tr_b16 v[56:57], v100 offset:8192
  ds_read_b64_tr_b16 v[58:59], v100 offset:10240
  s_waitcnt lgkmcnt(6)
  v_mfma_f32_16x16x32_bf16 v[16:19], v[32:35], v[52:55], v[16:19]
  ds_read_b128 v[72:75], v80 offset:2048
  ds_read_b64_tr_b16 v[60:61], v103 offset:8192
  v_mfma_f32_16x16x32_bf16 v[4:7], v[36:39], v[48:51], v[4:7]
  ds_read_b64_tr_b16 v[62:63], v103 offset:10240
  ds_read_b128 v[76:79], v80 offset:2304
  v_mfma_f32_16x16x32_bf16 v[20:23], v[36:39], v[52:55], v[20:23]
  ds_read_b64_tr_b16 v[64:65], v106 offset:8192
  ds_read_b64_tr_b16 v[66:67], v106 offset:10240
  s_waitcnt lgkmcnt(10)
  v_mfma_f32_16x16x32_bf16 v[8:11], v[40:43], v[48:51], v[8:11]
  ds_read_b64_tr_b16 v[68:69], v109 offset:8192
  ds_read_b64_tr_b16 v[70:71], v109 offset:10240
  v_mfma_f32_16x16x32_bf16 v[24:27], v[40:43], v[52:55], v[24:27]
  s_waitcnt lgkmcnt(10)
  v_mfma_f32_16x16x32_bf16 v[12:15], v[44:47], v[48:51], v[12:15]
  v_mfma_f32_16x16x32_bf16 v[28:31], v[44:47], v[52:55], v[28:31]
  s_waitcnt vmcnt(8) lgkmcnt(0)
  v_mfma_f32_16x16x32_bf16 v[0:3], v[56:59], v[72:75], v[0:3]
  s_barrier
  ds_read_b64_tr_b16 v[32:33], v101 offset:0
  ds_read_b64_tr_b16 v[34:35], v101 offset:2048
  v_mfma_f32_16x16x32_bf16 v[16:19], v[56:59], v[76:79], v[16:19]
  ds_read_b128 v[48:51], v81 offset:0
  ds_read_b64_tr_b16 v[36:37], v104 offset:0
  v_mfma_f32_16x16x32_bf16 v[4:7], v[60:63], v[72:75], v[4:7]
  ds_read_b64_tr_b16 v[38:39], v104 offset:2048
  ds_read_b128 v[52:55], v81 offset:256
  v_mfma_f32_16x16x32_bf16 v[20:23], v[60:63], v[76:79], v[20:23]
  ds_read_b64_tr_b16 v[40:41], v107 offset:0
  ds_read_b64_tr_b16 v[42:43], v107 offset:2048
  v_mfma_f32_16x16x32_bf16 v[8:11], v[64:67], v[72:75], v[8:11]
  ds_read_b64_tr_b16 v[44:45], v110 offset:0
  ds_read_b64_tr_b16 v[46:47], v110 offset:2048
  v_mfma_f32_16x16x32_bf16 v[24:27], v[64:67], v[76:79], v[24:27]
  v_mfma_f32_16x16x32_bf16 v[12:15], v[68:71], v[72:75], v[12:15]
  v_mfma_f32_16x16x32_bf16 v[28:31], v[68:71], v[76:79], v[28:31]
  s_waitcnt lgkmcnt(7)
  v_mfma_f32_16x16x32_bf16 v[0:3], v[32:35], v[48:51], v[0:3]
  ds_read_b64_tr_b16 v[56:57], v101 offset:8192
  ds_read_b64_tr_b16 v[58:59], v101 offset:10240
  s_waitcnt lgkmcnt(6)
  v_mfma_f32_16x16x32_bf16 v[16:19], v[32:35], v[52:55], v[16:19]
  ds_read_b128 v[72:75], v81 offset:2048
  ds_read_b64_tr_b16 v[60:61], v104 offset:8192
  v_mfma_f32_16x16x32_bf16 v[4:7], v[36:39], v[48:51], v[4:7]
  ds_read_b64_tr_b16 v[62:63], v104 offset:10240
  ds_read_b128 v[76:79], v81 offset:2304
  v_mfma_f32_16x16x32_bf16 v[20:23], v[36:39], v[52:55], v[20:23]
  ds_read_b64_tr_b16 v[64:65], v107 offset:8192
  ds_read_b64_tr_b16 v[66:67], v107 offset:10240
  s_waitcnt lgkmcnt(10)
  v_mfma_f32_16x16x32_bf16 v[8:11], v[40:43], v[48:51], v[8:11]
  ds_read_b64_tr_b16 v[68:69], v110 offset:8192
  ds_read_b64_tr_b16 v[70:71], v110 offset:10240
  v_mfma_f32_16x16x32_bf16 v[24:27], v[40:43], v[52:55], v[24:27]
  s_waitcnt lgkmcnt(10)
  v_mfma_f32_16x16x32_bf16 v[12:15], v[44:47], v[48:51], v[12:15]
  v_mfma_f32_16x16x32_bf16 v[28:31], v[44:47], v[52:55], v[28:31]
  s_waitcnt vmcnt(4) lgkmcnt(0)
  v_mfma_f32_16x16x32_bf16 v[0:3], v[56:59], v[72:75], v[0:3]
  s_barrier
  ds_read_b64_tr_b16 v[32:33], v101 offset:32768
  ds_read_b64_tr_b16 v[34:35], v101 offset:34816
  v_mfma_f32_16x16x32_bf16 v[16:19], v[56:59], v[76:79], v[16:19]
  ds_read_b128 v[48:51], v81 offset:32768
  ds_read_b64_tr_b16 v[36:37], v104 offset:32768
  v_mfma_f32_16x16x32_bf16 v[4:7], v[60:63], v[72:75], v[4:7]
  ds_read_b64_tr_b16 v[38:39], v104 offset:34816
  ds_read_b128 v[52:55], v81 offset:33024
  v_mfma_f32_16x16x32_bf16 v[20:23], v[60:63], v[76:79], v[20:23]
  ds_read_b64_tr_b16 v[40:41], v107 offset:32768
  ds_read_b64_tr_b16 v[42:43], v107 offset:34816
  v_mfma_f32_16x16x32_bf16 v[8:11], v[64:67], v[72:75], v[8:11]
  ds_read_b64_tr_b16 v[44:45], v110 offset:32768
  ds_read_b64_tr_b16 v[46:47], v110 offset:34816
  v_mfma_f32_16x16x32_bf16 v[24:27], v[64:67], v[76:79], v[24:27]
  v_mfma_f32_16x16x32_bf16 v[12:15], v[68:71], v[72:75], v[12:15]
  v_mfma_f32_16x16x32_bf16 v[28:31], v[68:71], v[76:79], v[28:31]
  s_waitcnt lgkmcnt(7)
  v_mfma_f32_16x16x32_bf16 v[0:3], v[32:35], v[48:51], v[0:3]
  ds_read_b64_tr_b16 v[56:57], v101 offset:40960
  ds_read_b64_tr_b16 v[58:59], v101 offset:43008
  s_waitcnt lgkmcnt(6)
  v_mfma_f32_16x16x32_bf16 v[16:19], v[32:35], v[52:55], v[16:19]
  ds_read_b128 v[72:75], v81 offset:34816
  ds_read_b64_tr_b16 v[60:61], v104 offset:40960
  v_mfma_f32_16x16x32_bf16 v[4:7], v[36:39], v[48:51], v[4:7]
  ds_read_b64_tr_b16 v[62:63], v104 offset:43008
  ds_read_b128 v[76:79], v81 offset:35072
  v_mfma_f32_16x16x32_bf16 v[20:23], v[36:39], v[52:55], v[20:23]
  ds_read_b64_tr_b16 v[64:65], v107 offset:40960
  ds_read_b64_tr_b16 v[66:67], v107 offset:43008
  s_waitcnt lgkmcnt(10)
  v_mfma_f32_16x16x32_bf16 v[8:11], v[40:43], v[48:51], v[8:11]
  ds_read_b64_tr_b16 v[68:69], v110 offset:40960
  ds_read_b64_tr_b16 v[70:71], v110 offset:43008
  v_mfma_f32_16x16x32_bf16 v[24:27], v[40:43], v[52:55], v[24:27]
  s_waitcnt lgkmcnt(10)
  v_mfma_f32_16x16x32_bf16 v[12:15], v[44:47], v[48:51], v[12:15]
  v_mfma_f32_16x16x32_bf16 v[28:31], v[44:47], v[52:55], v[28:31]
  s_waitcnt vmcnt(0) lgkmcnt(0)
  v_mfma_f32_16x16x32_bf16 v[0:3], v[56:59], v[72:75], v[0:3]
  s_barrier
  ds_read_b64_tr_b16 v[32:33], v100 offset:32768
  ds_read_b64_tr_b16 v[34:35], v100 offset:34816
  v_mfma_f32_16x16x32_bf16 v[16:19], v[56:59], v[76:79], v[16:19]
  ds_read_b128 v[48:51], v80 offset:32768
  ds_read_b64_tr_b16 v[36:37], v103 offset:32768
  v_mfma_f32_16x16x32_bf16 v[4:7], v[60:63], v[72:75], v[4:7]
  ds_read_b64_tr_b16 v[38:39], v103 offset:34816
  ds_read_b128 v[52:55], v80 offset:33024
  v_mfma_f32_16x16x32_bf16 v[20:23], v[60:63], v[76:79], v[20:23]
  ds_read_b64_tr_b16 v[40:41], v106 offset:32768
  ds_read_b64_tr_b16 v[42:43], v106 offset:34816
  v_mfma_f32_16x16x32_bf16 v[8:11], v[64:67], v[72:75], v[8:11]
  ds_read_b64_tr_b16 v[44:45], v109 offset:32768
  ds_read_b64_tr_b16 v[46:47], v109 offset:34816
  v_mfma_f32_16x16x32_bf16 v[24:27], v[64:67], v[76:79], v[24:27]
  v_mfma_f32_16x16x32_bf16 v[12:15], v[68:71], v[72:75], v[12:15]
  v_mfma_f32_16x16x32_bf16 v[28:31], v[68:71], v[76:79], v[28:31]
  s_waitcnt lgkmcnt(7)
  v_mfma_f32_16x16x32_bf16 v[0:3], v[32:35], v[48:51], v[0:3]
  ds_read_b64_tr_b16 v[56:57], v100 offset:40960
  ds_read_b64_tr_b16 v[58:59], v100 offset:43008
  s_waitcnt lgkmcnt(6)
  v_mfma_f32_16x16x32_bf16 v[16:19], v[32:35], v[52:55], v[16:19]
  ds_read_b128 v[72:75], v80 offset:34816
  ds_read_b64_tr_b16 v[60:61], v103 offset:40960
  v_mfma_f32_16x16x32_bf16 v[4:7], v[36:39], v[48:51], v[4:7]
  ds_read_b64_tr_b16 v[62:63], v103 offset:43008
  ds_read_b128 v[76:79], v80 offset:35072
  v_mfma_f32_16x16x32_bf16 v[20:23], v[36:39], v[52:55], v[20:23]
  ds_read_b64_tr_b16 v[64:65], v106 offset:40960
  ds_read_b64_tr_b16 v[66:67], v106 offset:43008
  s_waitcnt lgkmcnt(10)
  v_mfma_f32_16x16x32_bf16 v[8:11], v[40:43], v[48:51], v[8:11]
  ds_read_b64_tr_b16 v[68:69], v109 offset:40960
  ds_read_b64_tr_b16 v[70:71], v109 offset:43008
  v_mfma_f32_16x16x32_bf16 v[24:27], v[40:43], v[52:55], v[24:27]
  s_waitcnt lgkmcnt(10)
  v_mfma_f32_16x16x32_bf16 v[12:15], v[44:47], v[48:51], v[12:15]
  s_mov_b32 s42, 0x5a00000
  s_lshl_b32 s58, s70, 18
  s_add_u32 s58, s58, 0x4a00000
  s_and_b32 s63, s3, 1
  s_lshl_b32 s63, s63, 1
  s_add_u32 s63, s63, s57
  s_lshl_b32 s59, s63, 16
  s_add_u32 s59, s59, s58
  s_lshl_b32 s60, s69, 14
  s_add_u32 s59, s59, s60
  s_bfe_u32 s60, s3, 0x10001
  s_lshl_b32 s60, s60, 13
  s_add_u32 s59, s59, s60
  s_add_u32 s61, s59, 4096
  s_lshl_b32 s62, s69, 16
  s_add_u32 s58, s58, s62
  s_add_u32 s58, s58, s68
  v_add_u32 v90, s60, v254
  v_mfma_f32_16x16x32_bf16 v[28:31], v[44:47], v[52:55], v[28:31]
  s_waitcnt lgkmcnt(0)
  v_mfma_f32_16x16x32_bf16 v[0:3], v[56:59], v[72:75], v[0:3]
  s_barrier
  v_mfma_f32_16x16x32_bf16 v[16:19], v[56:59], v[76:79], v[16:19]
  v_mfma_f32_16x16x32_bf16 v[4:7], v[60:63], v[72:75], v[4:7]
  v_mfma_f32_16x16x32_bf16 v[20:23], v[60:63], v[76:79], v[20:23]
  v_mfma_f32_16x16x32_bf16 v[8:11], v[64:67], v[72:75], v[8:11]
  v_mfma_f32_16x16x32_bf16 v[24:27], v[64:67], v[76:79], v[24:27]
  v_mfma_f32_16x16x32_bf16 v[12:15], v[68:71], v[72:75], v[12:15]
  v_mfma_f32_16x16x32_bf16 v[28:31], v[68:71], v[76:79], v[28:31]
  s_branch .Lo_done
.Lo_done:
  s_nop 3
  s_cmp_eq_u32 s63, s69
  s_cbranch_scc1 .Lo_own
  buffer_store_dwordx4 v[0:3], v254, s[40:43], s59 offen offset:0 sc1
  buffer_store_dwordx4 v[4:7], v254, s[40:43], s59 offen offset:1024 sc1
  buffer_store_dwordx4 v[8:11], v254, s[40:43], s59 offen offset:2048 sc1
  buffer_store_dwordx4 v[12:15], v254, s[40:43], s59 offen offset:3072 sc1
  buffer_store_dwordx4 v[16:19], v254, s[40:43], s61 offen offset:0 sc1
  buffer_store_dwordx4 v[20:23], v254, s[40:43], s61 offen offset:1024 sc1
  buffer_store_dwordx4 v[24:27], v254, s[40:43], s61 offen offset:2048 sc1
  buffer_store_dwordx4 v[28:31], v254, s[40:43], s61 offen offset:3072 sc1
  s_branch .Lo_pub
.Lo_own:
  s_nop 7
  ds_write_b128 v90, v[0:3] offset:0
  ds_write_b128 v90, v[4:7] offset:1024
  ds_write_b128 v90, v[8:11] offset:2048
  ds_write_b128 v90, v[12:15] offset:3072
  ds_write_b128 v90, v[16:19] offset:4096
  ds_write_b128 v90, v[20:23] offset:5120
  ds_write_b128 v90, v[24:27] offset:6144
  ds_write_b128 v90, v[28:31] offset:7168
.Lo_pub:
  s_add_u32 s62, s70, 96
  v_add_u32 v91, s68, v254
  s_waitcnt vmcnt(0) lgkmcnt(0)
  s_barrier
  s_cmp_lg_u32 s3, 0
  s_cbranch_scc1 .Lo_arr
  s_lshl_b32 s88, s62, 7
  v_mov_b32 v251, s88
  s_mov_b64 exec, 1
  global_atomic_add v250, v251, v253, s[16:17] sc0
  s_mov_b64 exec, -1
.Lo_arr:
  ds_read_b128 v[32:35], v91 offset:0
  ds_read_b128 v[36:39], v91 offset:1024
  v_lshlrev_b32 v112, 16, v86
  v_and_b32 v113, 0xffff0000, v86
  v_lshlrev_b32 v114, 16, v87
  v_and_b32 v115, 0xffff0000, v87
  v_lshlrev_b32 v116, 16, v88
  v_and_b32 v117, 0xffff0000, v88
  v_lshlrev_b32 v118, 16, v89
  v_and_b32 v119, 0xffff0000, v89
  s_waitcnt lgkmcnt(1)
  v_add_f32 v112, v112, v32
  v_add_f32 v113, v113, v33
  v_add_f32 v114, v114, v34
  v_add_f32 v115, v115, v35
  s_waitcnt lgkmcnt(0)
  v_add_f32 v116, v116, v36
  v_add_f32 v117, v117, v37
  v_add_f32 v118, v118, v38
  v_add_f32 v119, v119, v39
  s_cmp_lg_u32 s3, 0
  s_cbranch_scc1 .Lok_red
  s_waitcnt vmcnt(0)
  v_readfirstlane_b32 s86, v250
  s_nop 0
  s_cmp_lt_u32 s86, 3
  s_cbranch_scc1 .Lspin_red
.Lok_red:
  s_barrier
  s_add_u32 s59, s69, 1
  s_and_b32 s59, s59, 3
  s_lshl_b32 s59, s59, 14
  s_add_u32 s59, s59, s58
  buffer_load_dwordx4 v[8:11], v254, s[40:43], s59 offen offset:0 sc1
  buffer_load_dwordx4 v[12:15], v254, s[40:43], s59 offen offset:1024 sc1
  s_add_u32 s59, s69, 2
  s_and_b32 s59, s59, 3
  s_lshl_b32 s59, s59, 14
  s_add_u32 s59, s59, s58
  buffer_load_dwordx4 v[16:19], v254, s[40:43], s59 offen offset:0 sc1
  buffer_load_dwordx4 v[20:23], v254, s[40:43], s59 offen offset:1024 sc1
  s_add_u32 s59, s69, 3
  s_and_b32 s59, s59, 3
  s_lshl_b32 s59, s59, 14
  s_add_u32 s59, s59, s58
  buffer_load_dwordx4 v[24:27], v254, s[40:43], s59 offen offset:0 sc1
  buffer_load_dwordx4 v[28:31], v254, s[40:43], s59 offen offset:1024 sc1
  s_waitcnt vmcnt(5)
  v_add_f32 v112, v112, v8
  v_add_f32 v113, v113, v9
  v_add_f32 v114, v114, v10
  v_add_f32 v115, v115, v11
  s_waitcnt vmcnt(4)
  v_add_f32 v116, v116, v12
  v_add_f32 v117, v117, v13
  v_add_f32 v118, v118, v14
  v_add_f32 v119, v119, v15
  s_waitcnt vmcnt(3)
  v_add_f32 v112, v112, v16
  v_add_f32 v113, v113, v17
  v_add_f32 v114, v114, v18
  v_add_f32 v115, v115, v19
  s_waitcnt vmcnt(2)
  v_add_f32 v116, v116, v20
  v_add_f32 v117, v117, v21
  v_add_f32 v118, v118, v22
  v_add_f32 v119, v119, v23
  s_waitcnt vmcnt(1)
  v_add_f32 v112, v112, v24
  v_add_f32 v113, v113, v25
  v_add_f32 v114, v114, v26
  v_add_f32 v115, v115, v27
  s_waitcnt vmcnt(0)
  v_add_f32 v116, v116, v28
  v_add_f32 v117, v117, v29
  v_add_f32 v118, v118, v30
  v_add_f32 v119, v119, v31
  v_cvt_pk_bf16_f32 v86, v112, v113
  v_cvt_pk_bf16_f32 v87, v114, v115
  v_cvt_pk_bf16_f32 v88, v116, v117
  v_cvt_pk_bf16_f32 v89, v118, v119
  buffer_store_dwordx2 v[86:87], v99, s[52:55], 0 offen
  buffer_store_dwordx2 v[88:89], v99, s[52:55], 0 offen offset:32
.Lend:
  s_endpgm
.Lspin_lnn:
  s_mov_b32 s88, 32768
.Lspin2_lnn:
  s_sleep 4
  s_mov_b64 exec, 1
  global_atomic_add v250, v251, v249, s[26:27] sc0
  s_mov_b64 exec, -1
  s_waitcnt vmcnt(0)
  s_sub_u32 s88, s88, 1
  s_cbranch_scc1 .Lok_lnn
  v_readfirstlane_b32 s86, v250
  s_nop 0
  s_cmp_lt_u32 s86, 256
  s_cbranch_scc1 .Lspin2_lnn
  s_branch .Lok_lnn
.Lspin_lns:
  s_mov_b32 s88, 32768
.Lspin2_lns:
  s_sleep 4
  s_mov_b64 exec, 1
  global_atomic_add v250, v251, v249, s[26:27] sc0
  s_mov_b64 exec, -1
  s_waitcnt vmcnt(0)
  s_sub_u32 s88, s88, 1
  s_cbranch_scc1 .Lok_lns
  v_readfirstlane_b32 s86, v250
  s_nop 0
  s_cmp_lt_u32 s86, 256
  s_cbranch_scc1 .Lspin2_lns
  s_branch .Lok_lns
.Lspin_kv:
  s_mov_b32 s88, 32768
.Lspin2_kv:
  s_sleep 4
  s_mov_b64 exec, 1
  global_atomic_add v250, v251, v249, s[16:17] sc0
  s_mov_b64 exec, -1
  s_waitcnt vmcnt(0)
  s_sub_u32 s88, s88, 1
  s_cbranch_scc1 .Lok_kv
  v_readfirstlane_b32 s86, v250
  s_nop 0
  s_cmp_lt_u32 s86, 16
  s_cbranch_scc1 .Lspin2_kv
  s_branch .Lok_kv
.Lspin_h:
  s_mov_b32 s88, 32768
.Lspin2_h:
  s_sleep 4
  s_mov_b64 exec, 1
  global_atomic_add v250, v251, v249, s[16:17] sc0
  s_mov_b64 exec, -1
  s_waitcnt vmcnt(0)
  s_sub_u32 s88, s88, 1
  s_cbranch_scc1 .Lok_h
  v_readfirstlane_b32 s86, v250
  s_nop 0
  s_cmp_lt_u32 s86, 14
  s_cbranch_scc1 .Lspin2_h
  s_branch .Lok_h
.Lspin_ctx10:
  s_mov_b32 s88, 32768
.Lspin2_ctx10:
  s_sleep 4
  s_mov_b64 exec, 1
  global_atomic_add v250, v251, v249, s[16:17] sc0
  s_mov_b64 exec, -1
  s_waitcnt vmcnt(0)
  s_sub_u32 s88, s88, 1
  s_cbranch_scc1 .Lok_ctx10
  v_readfirstlane_b32 s86, v250
  s_nop 0
  s_cmp_lt_u32 s86, 8
  s_cbranch_scc1 .Lspin2_ctx10
  s_branch .Lok_ctx10
.Lspin_ctx4:
  s_mov_b32 s88, 32768
.Lspin2_ctx4:
  s_sleep 4
  s_mov_b64 exec, 1
  global_atomic_add v250, v251, v249, s[16:17] sc0
  s_mov_b64 exec, -1
  s_waitcnt vmcnt(0)
  s_sub_u32 s88, s88, 1
  s_cbranch_scc1 .Lok_ctx4
  v_readfirstlane_b32 s86, v250
  s_nop 0
  s_cmp_lt_u32 s86, 8
  s_cbranch_scc1 .Lspin2_ctx4
  s_branch .Lok_ctx4
.Lspin_red:
  s_mov_b32 s88, 32768
.Lspin2_red:
  s_sleep 4
  s_mov_b64 exec, 1
  global_atomic_add v250, v251, v249, s[16:17] sc0
  s_mov_b64 exec, -1
  s_waitcnt vmcnt(0)
  s_sub_u32 s88, s88, 1
  s_cbranch_scc1 .Lok_red
  v_readfirstlane_b32 s86, v250
  s_nop 0
  s_cmp_lt_u32 s86, 4
  s_cbranch_scc1 .Lspin2_red
  s_branch .Lok_red
.Lcode_end:
.section .rodata,"a"
.p2align 6
.amdhsa_kernel parallel_sum__compressed_kv_cla__swiglu_ffn__prompt_kernel
  .amdhsa_next_free_vgpr 256
  .amdhsa_next_free_sgpr 89
  .amdhsa_accum_offset 256
  .amdhsa_group_segment_fixed_size 0
  .amdhsa_kernarg_size 104
  .amdhsa_user_sgpr_count 2
  .amdhsa_user_sgpr_kernarg_segment_ptr 1
  .amdhsa_system_sgpr_workgroup_id_x 1
  .amdhsa_float_denorm_mode_32 3
  .amdhsa_float_denorm_mode_16_64 3
.end_amdhsa_kernel
```
